```python
import torch

def _softmax(x, axis=-1):
    return torch.softmax(x, dim=axis)
def _gelu(x):
    return torch.nn.functional.gelu(x, approximate="tanh")
def _silu(x):
    return torch.nn.functional.silu(x)
def _sigmoid(x):
    return torch.sigmoid(x)
def _layernorm(x, axis=-1, eps=1e-5):
    m = x.mean(dim=axis, keepdim=True)
    v = x.var(dim=axis, keepdim=True, unbiased=False)
    return (x - m) / torch.sqrt(v + eps)
def _scatter_add(tgt, idx, src, axis=0):
    return tgt.clone().index_add_(axis, idx, src)
def _segment_sum(src, seg, n):
    out = torch.zeros((n,) + src.shape[1:], dtype=src.dtype)
    return out.index_add_(0, seg, src)
def _pad(x, pw):
    flat = tuple(v for pair in reversed(pw) for v in pair)
    return torch.nn.functional.pad(x, flat)

kernel_name = 'interleave_layers__grouped_kv_mqa__dense_activation_gelu__prompt'

def setup_inputs():

    _w = (lambda a: (lambda t: t.to(torch.bfloat16) if t.is_floating_point() else t)(torch.as_tensor(a)))
    def _A_setup():
        B, S, D, H = 1, 2048, 512, 32
        Dh = D // H
        return {
            "x": _w((lambda *s: torch.randn(*s, dtype=torch.bfloat16) * 0.05)(B, S, D)),
            "wq": _w((lambda *s: torch.randn(*s, dtype=torch.bfloat16) * 0.05)(D, H * Dh)),
            "wk": _w((lambda *s: torch.randn(*s, dtype=torch.bfloat16) * 0.05)(D, Dh)),
            "wv": _w((lambda *s: torch.randn(*s, dtype=torch.bfloat16) * 0.05)(D, Dh)),
            "wo": _w((lambda *s: torch.randn(*s, dtype=torch.bfloat16) * 0.05)(H * Dh, D)),
        }
    _A_in = _A_setup()

    def _B_setup():
        B, S, D, F = 1, 2048, 512, 1792
        return {
            "x": _w((lambda *s: torch.randn(*s, dtype=torch.bfloat16) * 0.05)(B, S, D)),
            "w1": _w((lambda *s: torch.randn(*s, dtype=torch.bfloat16) * 0.8)(D, F) * (D ** -0.5)),
            "b1": _w((lambda *s: torch.randn(*s, dtype=torch.bfloat16) * 12.8)(F) * 0.01),
            "w2": _w((lambda *s: torch.randn(*s, dtype=torch.bfloat16) * 0.2)(F, D) * (F ** -0.5)),
            "b2": _w((lambda *s: torch.randn(*s, dtype=torch.bfloat16) * 1.6)(D) * 0.01),
        }
    _B_in = _B_setup()

    return {
        "A_x": _A_in["x"],
        "A_wq": _A_in["wq"],
        "A_wk": _A_in["wk"],
        "A_wv": _A_in["wv"],
        "A_wo": _A_in["wo"],
        "B_x": _B_in["x"],
        "B_w1": _B_in["w1"],
        "B_b1": _B_in["b1"],
        "B_w2": _B_in["w2"],
        "B_b2": _B_in["b2"],
    }

def reference(A_x, A_wq, A_wk, A_wv, A_wo, B_x, B_w1, B_b1, B_w2, B_b2):
    def _A_ref(x, wq, wk, wv, wo):
        B, S, D = x.shape
        H = 32
        Dh = D // H
        q = (lambda x, *d: x.permute(*d))((x @ wq).reshape(B, S, H, Dh), 0, 2, 1, 3)
        k = x @ wk
        v = x @ wv
        scores = torch.einsum("bhqd,bkd->bhqk", q, k) * (Dh ** -0.5)
        p = _softmax(scores, axis=-1)
        o = torch.einsum("bhqk,bkd->bhqd", p, v)
        return (lambda x, *d: x.permute(*d))(o, 0, 2, 1, 3).reshape(B, S, H * Dh) @ wo

    def _B_ref(x, w1, b1, w2, b2):
        h = torch.einsum("bsd,df->bsf", x, w1) + b1
        h = _gelu(h)
        return torch.einsum("bsf,fd->bsd", h, w2) + b2

    x = A_x
    x = x + _A_ref(_layernorm(x, axis=-1), A_wq, A_wk, A_wv, A_wo)
    x = x + _B_ref(_layernorm(x, axis=-1), B_w1, B_b1, B_w2, B_b2)
    x = x + _A_ref(_layernorm(x, axis=-1), A_wq, A_wk, A_wv, A_wo)
    x = x + _B_ref(_layernorm(x, axis=-1), B_w1, B_b1, B_w2, B_b2)
    return x
```

```asm
; @launch grid=(256,1,1) block=(256,1,1) lds=163840
.amdgcn_target "amdgcn-amd-amdhsa--gfx950"
.text
.globl interleave_layers__grouped_kv_mqa__dense_activation_gelu__prompt_kernel
.p2align 8
.type interleave_layers__grouped_kv_mqa__dense_activation_gelu__prompt_kernel,@function
interleave_layers__grouped_kv_mqa__dense_activation_gelu__prompt_kernel:
    s_cmp_ge_u32 s2, 256
    s_cbranch_scc1 L_end
    s_load_dwordx16 s[28:43], s[0:1], 0
    s_load_dwordx8 s[44:51], s[0:1], 64
    s_load_dwordx2 s[52:53], s[0:1], 96
    v_lshrrev_b32 v36, 6, v0
    v_and_b32 v0, 63, v0
    v_readfirstlane_b32 s56, v36
    s_and_b32 s54, s2, 7
    s_lshl_b32 s54, s54, 2
    s_lshr_b32 s62, s2, 6
    s_add_u32 s54, s54, s62
    s_lshr_b32 s55, s2, 3
    s_and_b32 s55, s55, 7
    s_and_b32 s56, s56, 3
    v_lshlrev_b32 v1, 4, v0
    v_lshrrev_b32 v40, 4, v0
    v_and_b32 v41, 15, v0
    v_add_u32 v42, 0, v40
    v_xor_b32 v43, v42, v41
    v_add_u32 v42, 0, v40
    v_lshlrev_b32 v42, 10, v42
    v_lshl_add_u32 v36, v43, 4, v42
    v_add_u32 v42, 4, v40
    v_xor_b32 v43, v42, v41
    v_add_u32 v42, 3, v40
    v_lshlrev_b32 v42, 10, v42
    v_lshl_add_u32 v37, v43, 4, v42
    v_add_u32 v42, 8, v40
    v_xor_b32 v43, v42, v41
    v_add_u32 v42, 6, v40
    v_lshlrev_b32 v42, 10, v42
    v_lshl_add_u32 v38, v43, 4, v42
    v_add_u32 v42, 12, v40
    v_xor_b32 v43, v42, v41
    v_add_u32 v42, 9, v40
    v_lshlrev_b32 v42, 10, v42
    v_lshl_add_u32 v39, v43, 4, v42
    s_lshl_b32 s76, s56, 10
    s_lshl_b32 s75, s56, 13
    s_lshl_b32 s63, s56, 12
    s_add_u32 m0, s63, 0x24000
    s_lshl_b32 s64, s54, 16
    s_lshl_b32 s65, s56, 8
    s_add_u32 s64, s64, s65
    s_lshl_b32 s65, s56, 14
    s_lshr_b32 s66, s55, 1
    s_waitcnt lgkmcnt(0)
    s_load_dwordx2 s[60:61], s[52:53], 0
    s_bitcmp1_b32 s55, 0
    s_cselect_b64 s[24:25], s[34:35], s[32:33]
    s_mov_b32 s26, 16384
    s_mov_b32 s27, 0x20000
    s_mov_b32 s20, s28
    s_mov_b32 s21, s29
    s_mov_b32 s22, 0x200000
    s_mov_b32 s23, 0x20000
    buffer_load_dwordx4 v1, s[24:27], s63 offen lds
    buffer_load_dwordx4 v1, s[24:27], s63 offen offset:1024 lds
    buffer_load_dwordx4 v1, s[24:27], s63 offen offset:2048 lds
    buffer_load_dwordx4 v1, s[24:27], s63 offen offset:3072 lds
    s_xor_b32 s67, s66, 0
    s_lshl_b32 s68, s67, 12
    s_add_u32 m0, s68, s65
    s_lshl_b32 s67, s67, 14
    s_add_u32 s67, s67, s64
    buffer_load_dwordx4 v36, s[20:23], s67 offen lds
    buffer_load_dwordx4 v37, s[20:23], s67 offen offset:1024 lds
    buffer_load_dwordx4 v38, s[20:23], s67 offen offset:2048 lds
    buffer_load_dwordx4 v39, s[20:23], s67 offen offset:3072 lds
    s_mov_b32 s16, s30
    s_mov_b32 s17, s31
    s_mov_b32 s18, 0x80000
    s_mov_b32 s19, 0x20000
    s_add_u32 s98, s65, 0x10000
    s_lshl_b32 s67, s56, 17
    s_lshl_b32 s68, s55, 7
    s_add_u32 s67, s67, s68
    s_lshr_b32 s68, s56, 1
    s_lshl_b32 s68, s68, 6
    s_add_u32 s96, s67, s68
    s_xor_b32 s68, s68, 64
    s_add_u32 s97, s67, s68
    s_lshr_b32 s67, s2, 3
    s_lshl_b32 s67, s67, 14
    s_add_u32 s67, s67, s63
    v_lshlrev_b32 v40, 6, v0
    buffer_load_dword v30, v40, s[16:19], s67 offen
    s_lshl_b32 s74, s55, 2
    s_add_u32 s74, s74, s56
    s_lshl_b32 s67, s74, 5
    s_lshl_b32 s94, s54, 16
    s_add_u32 s94, s94, s67
    s_getpc_b64 s[68:69]
    s_lshl_b32 s67, s74, 11
    s_add_u32 s68, s68, s67
    s_addc_u32 s69, s69, 0
    v_and_b32 v44, 15, v0
    v_lshlrev_b32 v44, 7, v44
    v_mov_b32 v45, s69
    v_add_co_u32 v44, vcc, s68, v44
    s_nop 1
    v_addc_co_u32 v45, vcc, 0, v45, vcc
    s_cmp_ge_u32 s67, (L_end-L_nopf-2048)
    s_cbranch_scc1 L_nopf
    global_load_dword v29, v[44:45], off
L_nopf:
    s_lshl_b32 s77, s74, 7
    s_add_u32 s77, s77, 0x0
    s_add_u32 s78, s76, 0x0
    s_lshl_b32 s74, s74, 10
    s_mov_b32 s4, s52
    s_mov_b32 s5, s53
    s_mov_b32 s6, 0x800000
    s_mov_b32 s7, 0x20000
    s_mul_i32 s67, s54, 0x60000
    s_add_u32 s67, s67, 0x800000
    s_add_u32 s8, s52, s67
    s_addc_u32 s9, s53, 0
    s_mov_b32 s10, 0x58000
    s_mov_b32 s11, 0x20000
    s_add_u32 s12, s52, 0x40000
    s_addc_u32 s13, s53, 0
    s_mov_b32 s14, 0x20000
    s_mov_b32 s15, 0x20000
    s_mov_b32 s57, 0
    s_mov_b32 s58, 1
    s_mov_b32 s71, 0x3f803f80
    s_lshr_b32 s67, s54, 3
    s_and_b32 s68, s54, 7
    s_lshl_b32 s79, s67, 6
    s_lshl_b32 s69, s68, 2
    s_add_u32 s79, s79, s69
    s_add_u32 s95, s69, s67
    s_lshr_b32 s69, s55, 2
    s_lshl_b32 s69, s69, 5
    s_add_u32 s79, s79, s69
    s_lshl1_add_u32 s95, s69, s95
    s_and_b32 s69, s55, 3
    s_add_u32 s79, s79, s69
    s_lshl_b32 s79, s79, 7
    s_add_u32 s79, s79, 0x10000
    s_add_u32 s80, s75, 0x10000
    s_lshl_b32 s95, s95, 10
    s_and_b32 s67, s66, 1
    s_lshl_b32 s67, s67, 8
    s_and_b32 s68, s55, 1
    s_lshl_b32 s67, s67, s68
    s_lshl_b32 s68, s68, 15
    s_add_u32 s95, s95, s67
    s_add_u32 s95, s95, s68
    s_xor_b32 s81, s75, 0
    s_xor_b32 s82, s75, 8192
    s_xor_b32 s83, s75, 16384
    s_xor_b32 s84, s75, 24576
    s_mul_i32 s67, s55, 7
    s_lshl_b32 s68, s56, 1
    s_add_u32 s67, s67, s68
    s_mul_i32 s85, s67, 33792
    s_add_u32 s85, s85, 0x100000
    s_lshl_b32 s91, s67, 11
    s_add_u32 s91, s91, 0x20000
    s_cmp_eq_u32 s56, 3
    s_cselect_b32 s68, 0x10000000, 0
    s_add_u32 s86, s85, 33792
    s_add_u32 s86, s86, s68
    s_add_u32 s92, s91, 2048
    s_add_u32 s92, s92, s68
    s_mul_i32 s93, s56, 28672
    s_lshr_b32 s68, s56, 1
    s_lshl_b32 s67, s55, 1
    s_add_u32 s67, s67, s68
    s_lshl_b32 s87, s67, 15
    s_add_u32 s87, s87, s75
    s_add_u32 s87, s87, 0x500000
    s_mul_i32 s89, s67, 114688
    s_add_u32 s89, s89, s93
    s_add_u32 s89, s89, 0x300000
    s_xor_b32 s67, s67, 1
    s_lshl_b32 s88, s67, 15
    s_add_u32 s88, s88, s75
    s_add_u32 s88, s88, 0x500000
    s_mul_i32 s90, s67, 114688
    s_add_u32 s90, s90, s93
    s_add_u32 s90, s90, 0x300000
    s_add_u32 s93, s93, 0x20000
    s_and_b32 s67, s56, 1
    s_lshl_b32 s67, s67, 8
    v_xor_b32 v2, s67, v1
    v_lshlrev_b32 v3, 7, v0
    v_add_u32 v6, s98, v1
    v_xor_b32 v7, 0x4000, v6
    v_xor_b32 v8, 0x8000, v6
    v_add_u32 v8, 2048, v8
    v_xor_b32 v9, 0xc000, v6
    v_add_u32 v9, 4096, v9
    v_mov_b32 v10, 0xdddddddd
    s_lshl_b32 s32, s55, 8
    s_add_u32 s32, s32, s56
    s_lshl_b32 s32, s32, 2
    s_add_u32 s32, s32, 0x2000
    s_lshl_b32 s33, s56, 11
    s_add_u32 s33, s33, 0x2000
    v_mov_b32 v104, s71
    v_mov_b32 v105, s71
    v_mov_b32 v106, s71
    v_mov_b32 v107, s71
    v_lshrrev_b32 v108, 2, v0
    v_xor_b32 v108, v108, v0
    v_and_b32 v108, 4, v108
    v_and_or_b32 v108, v0, 8, v108
    v_cmp_eq_u32 vcc, 0, v108
    s_nop 1
    v_cndmask_b32 v108, 0, v104, vcc
    v_cndmask_b32 v109, 0, v104, vcc
    v_cndmask_b32 v110, 0, v104, vcc
    v_cndmask_b32 v111, 0, v104, vcc
    v_add_u32 v72, 0x20000, v1
    v_lshl_add_u32 v73, s56, 12, v72
    v_and_b32 v75, 15, v0
    v_lshrrev_b32 v76, 4, v0
    v_and_b32 v40, 3, v0
    v_lshrrev_b32 v78, 5, v0
    s_bitcmp1_b32 s55, 0
    s_cbranch_scc1 L_kvv_1
    v_lshrrev_b32 v74, 2, v75
    v_lshlrev_b32 v74, 8, v74
    v_lshl_or_b32 v74, v75, 4, v74
    v_lshl_or_b32 v74, v40, 2, v74
    s_mov_b32 s68, 0
    v_lshlrev_b32 v78, 9, v78
    v_lshl_or_b32 v78, v75, 4, v78
    s_branch L_kvj_2
L_kvv_1:
    v_mul_u32_u24 v74, 0x140, v76
    s_mov_b32 s68, 20
    v_lshlrev_b32 v78, 8, v78
    v_lshl_or_b32 v78, v40, 4, v78
    v_bfe_u32 v40, v75, 2, 1
    v_lshl_or_b32 v78, v40, 7, v78
    v_bfe_u32 v40, v75, 3, 1
    v_lshl_or_b32 v78, v40, 6, v78
L_kvj_2:
    v_and_b32 v40, 1, v76
    v_lshl_or_b32 v78, v40, 3, v78
    v_add_u32 v74, 0x20c00, v74
    v_add_u32 v75, s68, v74
    v_add_u32 v76, s68, v75
    v_add_u32 v77, s68, v76
    v_and_b32 v40, 15, v0
    v_lshrrev_b32 v41, 4, v0
    v_xor_b32 v41, v41, v40
    v_lshlrev_b32 v41, 4, v41
    v_lshl_or_b32 v79, v40, 8, v41
    s_lshl_b32 s67, s66, 12
    s_add_u32 s67, s67, s65
    v_add_u32 v79, s67, v79
    s_mov_b32 s100, 0x10000000
    s_mov_b32 s27, 0x20000
    s_cmp_ge_u32 s54, 14
    s_cbranch_scc1 L_sw2_3
    s_mov_b64 s[24:25], s[40:41]
    s_mov_b32 s26, 1835008
    s_mov_b32 s62, 3584
    s_and_b32 s63, s54, 1
    s_mul_i32 s67, s55, 7
    s_lshr_b32 s68, s54, 1
    s_bitcmp1_b32 s55, 0
    s_addc_u32 s68, s68, 0
    s_cmp_eq_u32 s68, 7
    s_cselect_b32 s68, 0, s68
    s_add_u32 s67, s67, s68
    s_mul_i32 s99, s67, 33792
    s_add_u32 s99, s99, 0x100000
    s_lshl_b32 s68, s63, 3
    s_add_u32 s68, s68, s99
    s_add_u32 s68, s68, 32768
    s_cmp_eq_u32 s56, 0
    s_cselect_b32 s100, s68, s100
    s_branch L_swj_5
L_sw2_3:
    s_mov_b32 s62, 1024
    s_lshl_b32 s67, s55, 1
    s_cmp_ge_u32 s54, 28
    s_cbranch_scc1 L_swo_4
    s_mov_b64 s[24:25], s[44:45]
    s_mov_b32 s26, 1835008
    s_bitcmp1_b32 s54, 0
    s_addc_u32 s67, s67, 0
    s_lshr_b32 s63, s54, 1
    s_sub_u32 s63, s63, 7
    s_mul_i32 s99, s67, 114688
    s_add_u32 s99, s99, 0x300000
    s_branch L_swj_5
L_swo_4:
    s_mov_b64 s[24:25], s[36:37]
    s_mov_b32 s26, 0x80000
    s_and_b32 s63, s54, 1
    s_bitcmp1_b32 s54, 1
    s_addc_u32 s67, s67, 0
    s_lshl_b32 s99, s67, 15
    s_add_u32 s99, s99, 0x500000
L_swj_5:
    s_lshl_b32 s63, s63, 2
    s_add_u32 s63, s63, s56
    s_lshl_b32 s68, s63, 12
    s_add_u32 s99, s99, s68
    s_lshl_b32 s63, s63, 6
    s_mul_i32 s63, s63, s62
    s_lshl_b32 s67, s67, 6
    s_add_u32 s63, s63, s67
    v_lshrrev_b32 v45, 2, v0
    v_mul_lo_u32 v45, v45, s62
    v_and_or_b32 v45, v1, 48, v45
    s_lshl_b32 s62, s62, 4
    v_and_b32 v46, 0x13, v0
    v_bfe_u32 v44, v0, 2, 1
    v_lshl_or_b32 v46, v44, 3, v46
    v_bfe_u32 v44, v0, 3, 1
    v_lshl_or_b32 v46, v44, 2, v46
    v_lshrrev_b32 v44, 5, v0
    v_lshl_or_b32 v46, v44, 15, v46
    v_lshlrev_b32 v46, 1, v46
    v_add_u32 v46, s67, v46
    s_lshl_b32 s101, s55, 12
    s_add_u32 s101, s101, 0x20000
    v_lshrrev_b32 v42, 4, v0
    v_lshlrev_b32 v42, 8, v42
    v_and_b32 v40, 15, v0
    v_lshl_or_b32 v42, v40, 3, v42
    s_lshl_b32 s67, s56, 12
    s_add_u32 s67, s67, 0x24000
    v_add_u32 v42, s67, v42
    s_waitcnt vmcnt(5)
    ds_read_b64_tr_b16 v[56:57], v42 offset:0
    ds_read_b64_tr_b16 v[58:59], v42 offset:128
    ds_read_b64_tr_b16 v[60:61], v42 offset:1024
    ds_read_b64_tr_b16 v[62:63], v42 offset:1152
    ds_read_b64_tr_b16 v[64:65], v42 offset:2048
    ds_read_b64_tr_b16 v[66:67], v42 offset:2176
    ds_read_b64_tr_b16 v[68:69], v42 offset:3072
    ds_read_b64_tr_b16 v[70:71], v42 offset:3200
    s_waitcnt vmcnt(1)
    ds_read_b128 v[240:243], v79
    v_xor_b32 v40, 64, v79
    ds_read_b128 v[244:247], v40
    v_xor_b32 v40, 128, v79
    ds_read_b128 v[248:251], v40
    v_xor_b32 v40, 192, v79
    ds_read_b128 v[252:255], v40
    s_waitcnt lgkmcnt(0)
    s_bitcmp1_b32 s55, 0
    s_cbranch_scc1 L_kvv_6
    v_mfma_f32_16x16x32_bf16 v[100:103], v[240:243], v[240:243], 0
    v_mfma_f32_16x16x32_bf16 v[88:91], v[56:59], v[240:243], 0
    v_mfma_f32_16x16x32_bf16 v[92:95], v[104:107], v[240:243], 0
    v_mfma_f32_16x16x32_bf16 v[96:99], v[56:59], v[104:107], 0
    v_mfma_f32_16x16x32_bf16 v[100:103], v[244:247], v[244:247], v[100:103]
    v_mfma_f32_16x16x32_bf16 v[88:91], v[60:63], v[244:247], v[88:91]
    v_mfma_f32_16x16x32_bf16 v[92:95], v[104:107], v[244:247], v[92:95]
    v_mfma_f32_16x16x32_bf16 v[96:99], v[60:63], v[104:107], v[96:99]
    v_mfma_f32_16x16x32_bf16 v[100:103], v[248:251], v[248:251], v[100:103]
    v_mfma_f32_16x16x32_bf16 v[88:91], v[64:67], v[248:251], v[88:91]
    v_mfma_f32_16x16x32_bf16 v[92:95], v[104:107], v[248:251], v[92:95]
    v_mfma_f32_16x16x32_bf16 v[96:99], v[64:67], v[104:107], v[96:99]
    v_mfma_f32_16x16x32_bf16 v[100:103], v[252:255], v[252:255], v[100:103]
    v_mfma_f32_16x16x32_bf16 v[88:91], v[68:71], v[252:255], v[88:91]
    v_mfma_f32_16x16x32_bf16 v[92:95], v[104:107], v[252:255], v[92:95]
    v_mfma_f32_16x16x32_bf16 v[96:99], v[68:71], v[104:107], v[96:99]
    s_branch L_kvj_7
L_kvv_6:
    v_mfma_f32_16x16x32_bf16 v[100:103], v[240:243], v[240:243], 0
    v_mfma_f32_16x16x32_bf16 v[88:91], v[240:243], v[56:59], 0
    v_mfma_f32_16x16x32_bf16 v[92:95], v[240:243], v[104:107], 0
    v_mfma_f32_16x16x32_bf16 v[96:99], v[104:107], v[56:59], 0
    v_mfma_f32_16x16x32_bf16 v[100:103], v[244:247], v[244:247], v[100:103]
    v_mfma_f32_16x16x32_bf16 v[88:91], v[244:247], v[60:63], v[88:91]
    v_mfma_f32_16x16x32_bf16 v[92:95], v[244:247], v[104:107], v[92:95]
    v_mfma_f32_16x16x32_bf16 v[96:99], v[104:107], v[60:63], v[96:99]
    v_mfma_f32_16x16x32_bf16 v[100:103], v[248:251], v[248:251], v[100:103]
    v_mfma_f32_16x16x32_bf16 v[88:91], v[248:251], v[64:67], v[88:91]
    v_mfma_f32_16x16x32_bf16 v[92:95], v[248:251], v[104:107], v[92:95]
    v_mfma_f32_16x16x32_bf16 v[96:99], v[104:107], v[64:67], v[96:99]
    v_mfma_f32_16x16x32_bf16 v[100:103], v[252:255], v[252:255], v[100:103]
    v_mfma_f32_16x16x32_bf16 v[88:91], v[252:255], v[68:71], v[88:91]
    v_mfma_f32_16x16x32_bf16 v[92:95], v[252:255], v[104:107], v[92:95]
    v_mfma_f32_16x16x32_bf16 v[96:99], v[104:107], v[68:71], v[96:99]
L_kvj_7:
    ds_write_b128 v73, v[100:103] offset:3072
    s_cmp_lg_u32 s56, 0
    s_cbranch_scc0 L_sk_8
    ds_write_b128 v73, v[88:91]
    s_nop 0
    ds_write_b128 v73, v[92:95] offset:1024
    s_nop 1
    ds_write_b128 v73, v[96:99] offset:2048
L_sk_8:
    s_waitcnt lgkmcnt(0)
    s_barrier
    s_add_u32 s60, s60, 16
    s_addc_u32 s61, s61, 0
    s_and_b32 s60, s60, -16
    s_getreg_b32 s67, hwreg(HW_REG_XCC_ID, 0, 4)
    s_or_b32 s59, s60, s67
    s_xor_b32 s67, s66, 1
    s_lshl_b32 s68, s67, 12
    s_add_u32 m0, s68, s65
    s_lshl_b32 s67, s67, 14
    s_add_u32 s67, s67, s64
    buffer_load_dwordx4 v36, s[20:23], s67 offen lds
    buffer_load_dwordx4 v37, s[20:23], s67 offen offset:1024 lds
    buffer_load_dwordx4 v38, s[20:23], s67 offen offset:2048 lds
    buffer_load_dwordx4 v39, s[20:23], s67 offen offset:3072 lds
    s_xor_b32 s67, s66, 2
    s_lshl_b32 s68, s67, 12
    s_add_u32 m0, s68, s65
    s_lshl_b32 s67, s67, 14
    s_add_u32 s67, s67, s64
    buffer_load_dwordx4 v36, s[20:23], s67 offen lds
    buffer_load_dwordx4 v37, s[20:23], s67 offen offset:1024 lds
    buffer_load_dwordx4 v38, s[20:23], s67 offen offset:2048 lds
    buffer_load_dwordx4 v39, s[20:23], s67 offen offset:3072 lds
    s_xor_b32 s67, s66, 3
    s_lshl_b32 s68, s67, 12
    s_add_u32 m0, s68, s65
    s_lshl_b32 s67, s67, 14
    s_add_u32 s67, s67, s64
    buffer_load_dwordx4 v36, s[20:23], s67 offen lds
    buffer_load_dwordx4 v37, s[20:23], s67 offen offset:1024 lds
    buffer_load_dwordx4 v38, s[20:23], s67 offen offset:2048 lds
    buffer_load_dwordx4 v39, s[20:23], s67 offen offset:3072 lds
    v_lshrrev_b32 v40, 2, v0
    v_lshlrev_b32 v40, 10, v40
    v_and_or_b32 v40, v1, 48, v40
    v_and_b32 v229, 31, v0
    v_lshrrev_b32 v228, 5, v0
    v_xor_b32 v228, v228, v229
    v_and_b32 v228, 15, v228
    v_lshlrev_b32 v228, 4, v228
    v_lshl_or_b32 v228, v229, 8, v228
    v_add_u32 v228, s65, v228
    v_mov_b32 v4, s60
    v_mov_b32 v5, s61
    s_cmp_eq_u32 s56, 0
    s_cbranch_scc0 L_sk_9
    ds_read_b32 v176, v74 offset:0
    ds_read_b32 v177, v75 offset:0
    ds_read_b32 v178, v76 offset:0
    ds_read_b32 v179, v77 offset:0
    ds_read_b32 v180, v74 offset:4096
    ds_read_b32 v181, v75 offset:4096
    ds_read_b32 v182, v76 offset:4096
    ds_read_b32 v183, v77 offset:4096
    ds_read_b128 v[192:195], v72 offset:5120
    ds_read_b32 v184, v74 offset:8192
    ds_read_b32 v185, v75 offset:8192
    ds_read_b32 v186, v76 offset:8192
    ds_read_b32 v187, v77 offset:8192
    ds_read_b128 v[196:199], v72 offset:9216
    ds_read_b32 v188, v74 offset:12288
    ds_read_b32 v189, v75 offset:12288
    ds_read_b32 v190, v76 offset:12288
    ds_read_b32 v191, v77 offset:12288
    ds_read_b128 v[200:203], v72 offset:13312
    ds_read_b128 v[204:207], v72 offset:4096
    ds_read_b128 v[216:219], v72 offset:6144
    ds_read_b128 v[208:211], v72 offset:8192
    ds_read_b128 v[220:223], v72 offset:10240
    ds_read_b128 v[212:215], v72 offset:12288
    ds_read_b128 v[224:227], v72 offset:14336
    s_waitcnt lgkmcnt(15)
    v_pk_add_f32 v[176:177], v[176:177], v[180:181]
    s_waitcnt lgkmcnt(15)
    v_pk_add_f32 v[178:179], v[178:179], v[182:183]
    s_waitcnt lgkmcnt(15)
    v_pk_add_f32 v[92:93], v[92:93], v[192:193]
    v_pk_add_f32 v[94:95], v[94:95], v[194:195]
    s_waitcnt lgkmcnt(14)
    v_pk_add_f32 v[176:177], v[176:177], v[184:185]
    s_waitcnt lgkmcnt(12)
    v_pk_add_f32 v[178:179], v[178:179], v[186:187]
    s_waitcnt lgkmcnt(11)
    v_pk_add_f32 v[92:93], v[92:93], v[196:197]
    v_pk_add_f32 v[94:95], v[94:95], v[198:199]
    s_waitcnt lgkmcnt(9)
    v_pk_add_f32 v[176:177], v[176:177], v[188:189]
    s_waitcnt lgkmcnt(7)
    v_pk_add_f32 v[178:179], v[178:179], v[190:191]
    s_waitcnt lgkmcnt(6)
    v_pk_add_f32 v[92:93], v[92:93], v[200:201]
    v_pk_add_f32 v[94:95], v[94:95], v[202:203]
    v_mul_f32 v92, 0x3b000000, v92
    v_mul_f32 v93, 0x3b000000, v93
    v_mul_f32 v94, 0x3b000000, v94
    v_mul_f32 v95, 0x3b000000, v95
    v_mul_f32 v176, 0x3b000000, v176
    v_mul_f32 v177, 0x3b000000, v177
    v_mul_f32 v178, 0x3b000000, v178
    v_mul_f32 v179, 0x3b000000, v179
    v_fma_f32 v176, -v92, v92, v176
    v_fma_f32 v177, -v93, v93, v177
    v_fma_f32 v178, -v94, v94, v178
    v_fma_f32 v179, -v95, v95, v179
    v_max_f32 v176, 0, v176
    v_max_f32 v177, 0, v177
    v_max_f32 v178, 0, v178
    v_max_f32 v179, 0, v179
    v_add_f32 v176, 0x3727c5ac, v176
    v_add_f32 v177, 0x3727c5ac, v177
    v_add_f32 v178, 0x3727c5ac, v178
    v_add_f32 v179, 0x3727c5ac, v179
    v_rsq_f32 v176, v176
    v_rsq_f32 v177, v177
    v_rsq_f32 v178, v178
    v_rsq_f32 v179, v179
    s_waitcnt lgkmcnt(5)
    v_pk_add_f32 v[88:89], v[88:89], v[204:205]
    v_pk_add_f32 v[90:91], v[90:91], v[206:207]
    s_waitcnt lgkmcnt(4)
    v_pk_add_f32 v[96:97], v[96:97], v[216:217]
    v_pk_add_f32 v[98:99], v[98:99], v[218:219]
    s_waitcnt lgkmcnt(3)
    v_pk_add_f32 v[88:89], v[88:89], v[208:209]
    v_pk_add_f32 v[90:91], v[90:91], v[210:211]
    s_waitcnt lgkmcnt(2)
    v_pk_add_f32 v[96:97], v[96:97], v[220:221]
    v_pk_add_f32 v[98:99], v[98:99], v[222:223]
    s_waitcnt lgkmcnt(1)
    v_pk_add_f32 v[88:89], v[88:89], v[212:213]
    v_pk_add_f32 v[90:91], v[90:91], v[214:215]
    s_waitcnt lgkmcnt(0)
    v_pk_add_f32 v[96:97], v[96:97], v[224:225]
    v_pk_add_f32 v[98:99], v[98:99], v[226:227]
    v_mov_b32 v12, v96
    v_mov_b32 v13, v97
    v_mov_b32 v14, v98
    v_mov_b32 v15, v99
    v_fma_f32 v88, -v92, v12, v88
    v_fma_f32 v89, -v93, v13, v89
    v_fma_f32 v90, -v94, v14, v90
    v_fma_f32 v91, -v95, v15, v91
    v_mul_f32 v88, v88, v176
    v_mul_f32 v89, v89, v177
    v_mul_f32 v90, v90, v178
    v_mul_f32 v91, v91, v179
    v_cvt_pk_bf16_f32 v88, v88, v89
    v_cvt_pk_bf16_f32 v89, v90, v91
    buffer_store_dwordx2 v[88:89], v78, s[12:15], s95 offen sc1
L_sk_9:
    s_add_u32 m0, s98, 0
    s_add_u32 s69, s96, 0
    buffer_load_dwordx4 v40, s[16:19], s69 offen lds
    s_add_u32 m0, s98, 1024
    s_add_u32 s69, s97, 0
    buffer_load_dwordx4 v40, s[16:19], s69 offen lds
    s_add_u32 m0, s98, 2048
    s_add_u32 s69, s96, 16384
    buffer_load_dwordx4 v40, s[16:19], s69 offen lds
    s_add_u32 m0, s98, 3072
    s_add_u32 s69, s97, 16384
    buffer_load_dwordx4 v40, s[16:19], s69 offen lds
    s_waitcnt vmcnt(4)
    ds_read_b128 v[112:115], v228 offset:0
    ds_read_b128 v[144:147], v228 offset:8192
    v_xor_b32 v229, 32, v228
    ds_read_b128 v[116:119], v229 offset:0
    ds_read_b128 v[148:151], v229 offset:8192
    v_xor_b32 v229, 64, v228
    ds_read_b128 v[120:123], v229 offset:0
    ds_read_b128 v[152:155], v229 offset:8192
    v_xor_b32 v229, 96, v228
    ds_read_b128 v[124:127], v229 offset:0
    ds_read_b128 v[156:159], v229 offset:8192
    v_xor_b32 v229, 128, v228
    ds_read_b128 v[128:131], v229 offset:0
    ds_read_b128 v[160:163], v229 offset:8192
    v_xor_b32 v229, 160, v228
    ds_read_b128 v[132:135], v229 offset:0
    ds_read_b128 v[164:167], v229 offset:8192
    v_xor_b32 v229, 192, v228
    ds_read_b128 v[136:139], v229 offset:0
    ds_read_b128 v[168:171], v229 offset:8192
    v_xor_b32 v229, 224, v228
    ds_read_b128 v[140:143], v229 offset:0
    ds_read_b128 v[172:175], v229 offset:8192
    s_add_u32 m0, s98, 4096
    s_add_u32 s69, s96, 32768
    buffer_load_dwordx4 v40, s[16:19], s69 offen lds
    s_add_u32 m0, s98, 5120
    s_add_u32 s69, s97, 32768
    buffer_load_dwordx4 v40, s[16:19], s69 offen lds
    v_mov_b32 v96, 0
    v_mov_b32 v97, 0
    s_waitcnt lgkmcnt(15)
    v_dot2c_f32_bf16 v96, v112, v112
    s_waitcnt lgkmcnt(14)
    v_dot2c_f32_bf16 v97, v144, v144
    v_dot2c_f32_bf16 v96, v113, v113
    v_dot2c_f32_bf16 v97, v145, v145
    s_add_u32 m0, s98, 6144
    s_add_u32 s69, s96, 49152
    buffer_load_dwordx4 v40, s[16:19], s69 offen lds
    v_dot2c_f32_bf16 v96, v114, v114
    v_dot2c_f32_bf16 v97, v146, v146
    v_dot2c_f32_bf16 v96, v115, v115
    v_dot2c_f32_bf16 v97, v147, v147
    s_waitcnt lgkmcnt(13)
    v_dot2c_f32_bf16 v96, v116, v116
    s_waitcnt lgkmcnt(12)
    v_dot2c_f32_bf16 v97, v148, v148
    s_add_u32 m0, s98, 7168
    s_add_u32 s69, s97, 49152
    buffer_load_dwordx4 v40, s[16:19], s69 offen lds
    v_dot2c_f32_bf16 v96, v117, v117
    v_dot2c_f32_bf16 v97, v149, v149
    v_dot2c_f32_bf16 v96, v118, v118
    v_dot2c_f32_bf16 v97, v150, v150
    v_dot2c_f32_bf16 v96, v119, v119
    v_dot2c_f32_bf16 v97, v151, v151
    s_cmp_eq_u32 s56, 0
    s_cbranch_scc0 L_sk_10
    v_mov_b32 v98, s59
    v_mov_b32 v99, s61
    s_waitcnt vmcnt(8)
    s_mov_b64 exec, 1
    buffer_store_dwordx2 v[98:99], v3, s[4:7], s79 offen sc1
    s_mov_b64 exec, -1
L_sk_10:
    s_add_u32 m0, s98, 8192
    s_add_u32 s69, s96, 65536
    buffer_load_dwordx4 v40, s[16:19], s69 offen lds
    s_waitcnt lgkmcnt(11)
    v_dot2c_f32_bf16 v96, v120, v120
    s_waitcnt lgkmcnt(10)
    v_dot2c_f32_bf16 v97, v152, v152
    v_dot2c_f32_bf16 v96, v121, v121
    v_dot2c_f32_bf16 v97, v153, v153
    v_dot2c_f32_bf16 v96, v122, v122
    v_dot2c_f32_bf16 v97, v154, v154
    s_add_u32 m0, s98, 9216
    s_add_u32 s69, s97, 65536
    buffer_load_dwordx4 v40, s[16:19], s69 offen lds
    v_dot2c_f32_bf16 v96, v123, v123
    v_dot2c_f32_bf16 v97, v155, v155
    s_waitcnt lgkmcnt(9)
    v_dot2c_f32_bf16 v96, v124, v124
    s_waitcnt lgkmcnt(8)
    v_dot2c_f32_bf16 v97, v156, v156
    v_dot2c_f32_bf16 v96, v125, v125
    v_dot2c_f32_bf16 v97, v157, v157
    s_add_u32 m0, s98, 10240
    s_add_u32 s69, s96, 81920
    buffer_load_dwordx4 v40, s[16:19], s69 offen lds
    v_dot2c_f32_bf16 v96, v126, v126
    v_dot2c_f32_bf16 v97, v158, v158
    v_dot2c_f32_bf16 v96, v127, v127
    v_dot2c_f32_bf16 v97, v159, v159
    s_waitcnt lgkmcnt(7)
    v_dot2c_f32_bf16 v96, v128, v128
    s_waitcnt lgkmcnt(6)
    v_dot2c_f32_bf16 v97, v160, v160
    s_add_u32 m0, s98, 11264
    s_add_u32 s69, s97, 81920
    buffer_load_dwordx4 v40, s[16:19], s69 offen lds
    v_dot2c_f32_bf16 v96, v129, v129
    v_dot2c_f32_bf16 v97, v161, v161
    v_dot2c_f32_bf16 v96, v130, v130
    v_dot2c_f32_bf16 v97, v162, v162
    v_dot2c_f32_bf16 v96, v131, v131
    v_dot2c_f32_bf16 v97, v163, v163
    s_add_u32 m0, s98, 12288
    s_add_u32 s69, s96, 98304
    buffer_load_dwordx4 v40, s[16:19], s69 offen lds
    s_waitcnt lgkmcnt(5)
    v_dot2c_f32_bf16 v96, v132, v132
    s_waitcnt lgkmcnt(4)
    v_dot2c_f32_bf16 v97, v164, v164
    v_dot2c_f32_bf16 v96, v133, v133
    v_dot2c_f32_bf16 v97, v165, v165
    v_dot2c_f32_bf16 v96, v134, v134
    v_dot2c_f32_bf16 v97, v166, v166
    s_add_u32 m0, s98, 13312
    s_add_u32 s69, s97, 98304
    buffer_load_dwordx4 v40, s[16:19], s69 offen lds
    v_dot2c_f32_bf16 v96, v135, v135
    v_dot2c_f32_bf16 v97, v167, v167
    s_waitcnt lgkmcnt(3)
    v_dot2c_f32_bf16 v96, v136, v136
    s_waitcnt lgkmcnt(2)
    v_dot2c_f32_bf16 v97, v168, v168
    v_dot2c_f32_bf16 v96, v137, v137
    v_dot2c_f32_bf16 v97, v169, v169
    s_add_u32 m0, s98, 14336
    s_add_u32 s69, s96, 114688
    buffer_load_dwordx4 v40, s[16:19], s69 offen lds
    v_dot2c_f32_bf16 v96, v138, v138
    v_dot2c_f32_bf16 v97, v170, v170
    v_dot2c_f32_bf16 v96, v139, v139
    v_dot2c_f32_bf16 v97, v171, v171
    s_waitcnt lgkmcnt(1)
    v_dot2c_f32_bf16 v96, v140, v140
    s_waitcnt lgkmcnt(0)
    v_dot2c_f32_bf16 v97, v172, v172
    s_add_u32 m0, s98, 15360
    s_add_u32 s69, s97, 114688
    buffer_load_dwordx4 v40, s[16:19], s69 offen lds
    v_dot2c_f32_bf16 v96, v141, v141
    v_dot2c_f32_bf16 v97, v173, v173
    v_dot2c_f32_bf16 v96, v142, v142
    v_dot2c_f32_bf16 v97, v174, v174
    v_dot2c_f32_bf16 v96, v143, v143
    v_dot2c_f32_bf16 v97, v175, v175
    v_lshrrev_b32 v40, 5, v0
    v_lshlrev_b32 v40, 4, v40
    v_and_b32 v41, 31, v0
    v_lshl_add_u32 v41, v41, 10, v40
    s_add_u32 s68, s94, 0x8000
    buffer_load_dwordx4 v[248:251], v41, s[20:23], s94 offen
    buffer_load_dwordx4 v[252:255], v41, s[20:23], s68 offen
    v_mfma_f32_16x16x32_bf16 v[88:91], v[108:111], v[112:115], 0
    v_mfma_f32_16x16x32_bf16 v[92:95], v[108:111], v[144:147], 0
    v_mfma_f32_16x16x32_bf16 v[88:91], v[108:111], v[116:119], v[88:91]
    v_mfma_f32_16x16x32_bf16 v[92:95], v[108:111], v[148:151], v[92:95]
    v_mfma_f32_16x16x32_bf16 v[88:91], v[108:111], v[120:123], v[88:91]
    v_mfma_f32_16x16x32_bf16 v[92:95], v[108:111], v[152:155], v[92:95]
    v_mfma_f32_16x16x32_bf16 v[88:91], v[108:111], v[124:127], v[88:91]
    v_mfma_f32_16x16x32_bf16 v[92:95], v[108:111], v[156:159], v[92:95]
    v_mfma_f32_16x16x32_bf16 v[88:91], v[108:111], v[128:131], v[88:91]
    v_mfma_f32_16x16x32_bf16 v[92:95], v[108:111], v[160:163], v[92:95]
    v_mfma_f32_16x16x32_bf16 v[88:91], v[108:111], v[132:135], v[88:91]
    v_mfma_f32_16x16x32_bf16 v[92:95], v[108:111], v[164:167], v[92:95]
    v_mfma_f32_16x16x32_bf16 v[88:91], v[108:111], v[136:139], v[88:91]
    v_mfma_f32_16x16x32_bf16 v[92:95], v[108:111], v[168:171], v[92:95]
    v_mfma_f32_16x16x32_bf16 v[88:91], v[108:111], v[140:143], v[88:91]
    v_mfma_f32_16x16x32_bf16 v[92:95], v[108:111], v[172:175], v[92:95]
    v_lshrrev_b32 v42, 5, v0
    v_lshlrev_b32 v42, 9, v42
    v_bfe_u32 v43, v0, 2, 2
    v_lshl_or_b32 v42, v43, 6, v42
    v_bfe_u32 v43, v2, 8, 1
    v_lshl_or_b32 v42, v43, 5, v42
    v_and_b32 v43, 1, v0
    v_lshl_or_b32 v42, v43, 4, v42
    v_bfe_u32 v43, v0, 1, 1
    v_lshl_or_b32 v42, v43, 3, v42
    v_add_u32 v42, s98, v42
    v_and_b32 v66, 0xf80, v3
    v_lshl_add_u32 v73, s56, 2, v72
    v_permlane32_swap_b32 v88, v96
    v_add_f32 v88, v88, v96
    ds_write_b32 v73, v88 offset:0
    v_permlane32_swap_b32 v92, v97
    v_add_f32 v92, v92, v97
    ds_write_b32 v73, v92 offset:1024
    s_waitcnt vmcnt(16)
    ds_read_b64_tr_b16 a[0:1], v42 offset:0
    ds_read_b64_tr_b16 a[2:3], v42 offset:256
    ds_read_b64_tr_b16 a[4:5], v42 offset:1024
    ds_read_b64_tr_b16 a[6:7], v42 offset:1280
    s_waitcnt vmcnt(14)
    ds_read_b64_tr_b16 a[8:9], v42 offset:2048
    ds_read_b64_tr_b16 a[10:11], v42 offset:2304
    ds_read_b64_tr_b16 a[12:13], v42 offset:3072
    ds_read_b64_tr_b16 a[14:15], v42 offset:3328
    s_waitcnt lgkmcnt(6)
    v_mfma_f32_32x32x16_bf16 v[208:223], a[0:3], v[112:115], 0
    s_waitcnt vmcnt(12)
    ds_read_b64_tr_b16 a[16:17], v42 offset:4096
    ds_read_b64_tr_b16 a[18:19], v42 offset:4352
    ds_read_b64_tr_b16 a[20:21], v42 offset:5120
    ds_read_b64_tr_b16 a[22:23], v42 offset:5376
    s_waitcnt lgkmcnt(8)
    v_mfma_f32_32x32x16_bf16 v[224:239], a[4:7], v[112:115], 0
    s_waitcnt lgkmcnt(0)
    s_barrier
    ds_read_b128 v[88:91], v72 offset:0
    ds_read_b128 v[92:95], v72 offset:1024
    v_mfma_f32_16x16x32_bf16 v[56:59], a[0:3], v[108:111], 0
    buffer_load_dwordx4 a[64:67], v45, s[24:27], s63 offen
    s_add_u32 s63, s63, s62
    buffer_load_dwordx4 a[68:71], v45, s[24:27], s63 offen
    s_add_u32 s63, s63, s62
    buffer_load_dwordx4 a[72:75], v45, s[24:27], s63 offen
    s_add_u32 s63, s63, s62
    buffer_load_dwordx4 a[76:79], v45, s[24:27], s63 offen
    s_mov_b32 s24, s42
    s_mov_b32 s25, s43
    s_mov_b32 s26, 0xe00
    s_mov_b32 s27, 0x20000
    buffer_load_ushort v28, v46, s[24:27], 0 offen
    s_mov_b32 s24, s46
    s_mov_b32 s25, s47
    s_mov_b32 s26, 0x400
    s_mov_b32 s27, 0x20000
    s_lshr_b32 s67, s74, 5
    buffer_load_dwordx4 v[24:27], v40, s[24:27], s67 offen
    v_lshlrev_b32 v45, 20, v0
    v_and_b32 v46, 0x380, v3
    v_mfma_f32_16x16x32_bf16 v[60:63], a[4:7], v[108:111], 0
    v_mfma_f32_32x32x16_bf16 v[208:223], a[8:11], v[116:119], v[208:223]
    s_waitcnt vmcnt(16)
    ds_read_b64_tr_b16 a[24:25], v42 offset:6144
    ds_read_b64_tr_b16 a[26:27], v42 offset:6400
    ds_read_b64_tr_b16 a[28:29], v42 offset:7168
    ds_read_b64_tr_b16 a[30:31], v42 offset:7424
    v_mfma_f32_32x32x16_bf16 v[224:239], a[12:15], v[116:119], v[224:239]
    v_mfma_f32_16x16x32_bf16 v[56:59], a[8:11], v[108:111], v[56:59]
    v_mfma_f32_16x16x32_bf16 v[60:63], a[12:15], v[108:111], v[60:63]
    v_bfe_u32 v74, v0, 2, 1
    v_mfma_f32_32x32x16_bf16 v[208:223], a[16:19], v[120:123], v[208:223]
    s_waitcnt vmcnt(14)
    ds_read_b64_tr_b16 a[32:33], v42 offset:8192
    ds_read_b64_tr_b16 a[34:35], v42 offset:8448
    ds_read_b64_tr_b16 a[36:37], v42 offset:9216
    ds_read_b64_tr_b16 a[38:39], v42 offset:9472
    v_mfma_f32_32x32x16_bf16 v[224:239], a[20:23], v[120:123], v[224:239]
    v_xor_b32 v75, s56, v74
    v_lshl_or_b32 v74, v75, 2, v74
    v_lshlrev_b32 v74, 6, v74
    v_and_or_b32 v74, v0, 48, v74
    v_mfma_f32_16x16x32_bf16 v[56:59], a[16:19], v[108:111], v[56:59]
    v_add_u32 v74, 0x20c00, v74
    v_xor_b32 v75, 0x280, v74
    v_lshrrev_b32 v76, 5, v0
    v_lshlrev_b32 v76, 4, v76
    v_mfma_f32_16x16x32_bf16 v[60:63], a[20:23], v[108:111], v[60:63]
    v_lshl_add_u32 v76, s56, 8, v76
    v_add_u32 v76, 0x20c00, v76
    v_and_b32 v105, 11, v0
    v_cmp_eq_u32 vcc, 0, v105
    v_add_u32 v77, s76, v72
    s_waitcnt lgkmcnt(6)
    v_mfma_f32_32x32x16_bf16 v[208:223], a[24:27], v[124:127], v[208:223]
    s_waitcnt vmcnt(12)
    ds_read_b64_tr_b16 a[40:41], v42 offset:10240
    ds_read_b64_tr_b16 a[42:43], v42 offset:10496
    ds_read_b64_tr_b16 a[44:45], v42 offset:11264
    ds_read_b64_tr_b16 a[46:47], v42 offset:11520
    s_waitcnt lgkmcnt(8)
    v_mfma_f32_32x32x16_bf16 v[224:239], a[28:31], v[124:127], v[224:239]
    v_cndmask_b32 v105, 0, v104, vcc
    v_cndmask_b32 v106, 0, v104, vcc
    v_cndmask_b32 v107, 0, v104, vcc
    v_mfma_f32_16x16x32_bf16 v[56:59], a[24:27], v[108:111], v[56:59]
    v_cndmask_b32 v104, 0, v104, vcc
    ds_write_b128 v77, v[104:107] offset:4096
    v_mfma_f32_16x16x32_bf16 v[60:63], a[28:31], v[108:111], v[60:63]
    v_and_b32 v70, 16, v0
    v_cmp_eq_u32 vcc, 0, v70
    v_lshrrev_b32 v70, 5, v0
    v_lshlrev_b32 v70, 8, v70
    v_add_u32 v70, 0x8000, v70
    v_mov_b32 v71, 0x21000
    v_cndmask_b32 v11, v71, v70, vcc
    v_mov_b32 v70, 0x1000
    v_cndmask_b32 v38, 0, v70, vcc
    s_waitcnt lgkmcnt(7)
    v_mfma_f32_32x32x16_bf16 v[208:223], a[32:35], v[128:131], v[208:223]
    s_waitcnt vmcnt(10)
    ds_read_b64_tr_b16 a[48:49], v42 offset:12288
    ds_read_b64_tr_b16 a[50:51], v42 offset:12544
    ds_read_b64_tr_b16 a[52:53], v42 offset:13312
    ds_read_b64_tr_b16 a[54:55], v42 offset:13568
    s_waitcnt lgkmcnt(9)
    v_mfma_f32_32x32x16_bf16 v[224:239], a[36:39], v[128:131], v[224:239]
    v_mfma_f32_16x16x32_bf16 v[56:59], a[32:35], v[108:111], v[56:59]
    v_and_b32 v70, 0xf0, v1
    v_or_b32 v11, v11, v70
    v_and_b32 v65, 0x180, v3
    v_bfe_u32 v70, v0, 2, 1
    v_mfma_f32_16x16x32_bf16 v[60:63], a[36:39], v[108:111], v[60:63]
    v_lshl_or_b32 v65, v70, 12, v65
    v_add_u32 v39, 0x10000, v1
    v_add_f32 v88, v88, v89
    v_add_f32 v90, v90, v91
    s_waitcnt lgkmcnt(7)
    v_mfma_f32_32x32x16_bf16 v[208:223], a[40:43], v[132:135], v[208:223]
    s_waitcnt vmcnt(8)
    ds_read_b64_tr_b16 a[56:57], v42 offset:14336
    ds_read_b64_tr_b16 a[58:59], v42 offset:14592
    ds_read_b64_tr_b16 a[60:61], v42 offset:15360
    ds_read_b64_tr_b16 a[62:63], v42 offset:15616
    s_waitcnt lgkmcnt(9)
    v_mfma_f32_32x32x16_bf16 v[224:239], a[44:47], v[132:135], v[224:239]
    s_and_b32 s67, s54, 15
    s_lshl_b32 s67, s67, 10
    v_add_u32 v42, s67, v42
    ds_read_b64_tr_b16 v[32:33], v42 offset:0
    ds_read_b64_tr_b16 v[34:35], v42 offset:256
    s_lshl_b32 s96, s74, 4
    s_add_u32 s96, s96, 0x580000
    s_add_u32 s67, s67, s96
    s_cmp_ge_u32 s54, 16
    s_cselect_b32 s66, 0x10000000, s67
    v_mfma_f32_16x16x32_bf16 v[56:59], a[40:43], v[108:111], v[56:59]
    v_add_f32 v88, v88, v90
    v_mfma_f32_16x16x32_bf16 v[60:63], a[44:47], v[108:111], v[60:63]
    v_mul_f32 v96, 0x3b000000, v88
    v_mul_f32 v88, 0x3b000000, v88
    s_nop 1
    v_permlane32_swap_b32 v96, v88
    v_fma_f32 v88, -v96, v96, v88
    v_max_f32 v88, 0, v88
    s_waitcnt lgkmcnt(8)
    v_mfma_f32_32x32x16_bf16 v[208:223], a[48:51], v[136:139], v[208:223]
    s_add_u32 s65, s80, 0
    buffer_load_dwordx2 v[36:37], v66, s[4:7], s65 offen sc1
    v_add_f32 v88, 0x3727c5ac, v88
    s_waitcnt lgkmcnt(6)
    v_mfma_f32_32x32x16_bf16 v[224:239], a[52:55], v[136:139], v[224:239]
    v_rsq_f32 v97, v88
    v_add_f32 v92, v92, v93
    v_add_f32 v94, v94, v95
    v_add_f32 v92, v92, v94
    v_mul_f32 v98, 0x3b000000, v92
    v_mfma_f32_16x16x32_bf16 v[56:59], a[48:51], v[108:111], v[56:59]
    v_mul_f32 v92, 0x3b000000, v92
    s_nop 1
    v_permlane32_swap_b32 v98, v92
    v_fma_f32 v92, -v98, v98, v92
    v_max_f32 v92, 0, v92
    v_mfma_f32_16x16x32_bf16 v[60:63], a[52:55], v[108:111], v[60:63]
    v_add_f32 v92, 0x3727c5ac, v92
    v_rsq_f32 v99, v92
    s_waitcnt vmcnt(8)
    v_lshlrev_b32 v48, 16, v248
    v_and_b32 v49, 0xffff0000, v248
    s_waitcnt lgkmcnt(4)
    v_mfma_f32_32x32x16_bf16 v[208:223], a[56:59], v[140:143], v[208:223]
    v_lshlrev_b32 v50, 16, v249
    v_and_b32 v51, 0xffff0000, v249
    v_lshlrev_b32 v52, 16, v250
    v_and_b32 v53, 0xffff0000, v250
    v_lshlrev_b32 v54, 16, v251
    s_waitcnt lgkmcnt(2)
    v_mfma_f32_32x32x16_bf16 v[224:239], a[60:63], v[140:143], v[224:239]
    v_and_b32 v55, 0xffff0000, v251
    s_waitcnt vmcnt(7)
    v_lshlrev_b32 v80, 16, v252
    v_and_b32 v81, 0xffff0000, v252
    v_lshlrev_b32 v82, 16, v253
    v_mfma_f32_16x16x32_bf16 v[56:59], a[56:59], v[108:111], v[56:59]
    v_and_b32 v83, 0xffff0000, v253
    v_lshlrev_b32 v84, 16, v254
    v_and_b32 v85, 0xffff0000, v254
    v_lshlrev_b32 v86, 16, v255
    v_and_b32 v87, 0xffff0000, v255
    v_mfma_f32_16x16x32_bf16 v[60:63], a[60:63], v[108:111], v[60:63]
    v_mfma_f32_32x32x16_bf16 v[176:191], a[0:3], v[144:147], 0
    ds_write_b128 v6, v[216:219] offset:0
    ds_write_b128 v6, v[220:223] offset:1024
    v_mfma_f32_32x32x16_bf16 v[192:207], a[4:7], v[144:147], 0
    ds_write_b128 v6, v[224:227] offset:2048
    ds_write_b128 v6, v[228:231] offset:3072
    v_mfma_f32_32x32x16_bf16 v[176:191], a[8:11], v[148:151], v[176:191]
    ds_write_b128 v6, v[232:235] offset:4096
    ds_write_b128 v6, v[236:239] offset:5120
    v_mfma_f32_32x32x16_bf16 v[192:207], a[12:15], v[148:151], v[192:207]
    s_mov_b32 exec_lo, 0x110011
    s_mov_b32 exec_hi, 0x110011
    ds_write_b128 v74, v[56:59]
    ds_write_b128 v75, v[60:63]
    s_mov_b64 exec, -1
    v_mfma_f32_32x32x16_bf16 v[176:191], a[16:19], v[152:155], v[176:191]
    v_mfma_f32_32x32x16_bf16 v[192:207], a[20:23], v[152:155], v[192:207]
    s_waitcnt lgkmcnt(0)
    s_barrier
    ds_read_b128 v[16:19], v76 offset:0
    ds_read_b128 v[20:23], v76 offset:32
    ds_read_b128 v[112:115], v76 offset:64
    ds_read_b128 v[116:119], v76 offset:96
    v_mfma_f32_32x32x16_bf16 v[176:191], a[24:27], v[156:159], v[176:191]
    ds_read_b128 v[120:123], v76 offset:128
    ds_read_b128 v[124:127], v76 offset:160
    ds_read_b128 v[128:131], v76 offset:192
    ds_read_b128 v[132:135], v76 offset:224
    v_mfma_f32_32x32x16_bf16 v[192:207], a[28:31], v[156:159], v[192:207]
    ds_read_b128 v[216:219], v7 offset:0
    ds_read_b128 v[220:223], v7 offset:1024
    ds_read_b128 v[224:227], v8 offset:0
    v_mfma_f32_32x32x16_bf16 v[176:191], a[32:35], v[160:163], v[176:191]
    ds_read_b128 v[228:231], v8 offset:1024
    ds_read_b128 v[232:235], v9 offset:0
    ds_read_b128 v[236:239], v9 offset:1024
    v_mfma_f32_32x32x16_bf16 v[192:207], a[36:39], v[160:163], v[192:207]
    s_waitcnt lgkmcnt(11)
    v_pk_add_f32 v[16:17], v[16:17], v[112:113]
    v_pk_add_f32 v[18:19], v[18:19], v[114:115]
    s_waitcnt lgkmcnt(10)
    v_pk_add_f32 v[20:21], v[20:21], v[116:117]
    v_pk_add_f32 v[22:23], v[22:23], v[118:119]
    s_waitcnt lgkmcnt(9)
    v_pk_add_f32 v[16:17], v[16:17], v[120:121]
    v_mfma_f32_32x32x16_bf16 v[176:191], a[40:43], v[164:167], v[176:191]
    v_pk_add_f32 v[18:19], v[18:19], v[122:123]
    s_waitcnt lgkmcnt(8)
    v_pk_add_f32 v[20:21], v[20:21], v[124:125]
    v_pk_add_f32 v[22:23], v[22:23], v[126:127]
    s_waitcnt lgkmcnt(7)
    v_pk_add_f32 v[16:17], v[16:17], v[128:129]
    v_mfma_f32_32x32x16_bf16 v[192:207], a[44:47], v[164:167], v[192:207]
    v_pk_add_f32 v[18:19], v[18:19], v[130:131]
    s_waitcnt lgkmcnt(6)
    v_pk_add_f32 v[20:21], v[20:21], v[132:133]
    v_pk_add_f32 v[22:23], v[22:23], v[134:135]
    v_mul_f32 v97, 0x3eb8aa3b, v97
    s_waitcnt lgkmcnt(5)
    v_pk_add_f32 v[208:209], v[208:209], v[216:217]
    v_mfma_f32_32x32x16_bf16 v[176:191], a[48:51], v[168:171], v[176:191]
    v_pk_add_f32 v[210:211], v[210:211], v[218:219]
    s_waitcnt lgkmcnt(4)
    v_pk_add_f32 v[212:213], v[212:213], v[220:221]
    v_pk_add_f32 v[214:215], v[214:215], v[222:223]
    s_waitcnt lgkmcnt(3)
    v_pk_add_f32 v[208:209], v[208:209], v[224:225]
    v_pk_add_f32 v[210:211], v[210:211], v[226:227]
    v_mfma_f32_32x32x16_bf16 v[192:207], a[52:55], v[168:171], v[192:207]
    s_waitcnt lgkmcnt(2)
    v_pk_add_f32 v[212:213], v[212:213], v[228:229]
    v_pk_add_f32 v[214:215], v[214:215], v[230:231]
    s_waitcnt lgkmcnt(1)
    v_pk_add_f32 v[208:209], v[208:209], v[232:233]
    v_pk_add_f32 v[210:211], v[210:211], v[234:235]
    s_waitcnt lgkmcnt(0)
    v_pk_add_f32 v[212:213], v[212:213], v[236:237]
    v_mfma_f32_32x32x16_bf16 v[176:191], a[56:59], v[172:175], v[176:191]
    v_pk_add_f32 v[214:215], v[214:215], v[238:239]
    v_fma_f32 v208, -v96, v16, v208
    v_fma_f32 v209, -v96, v17, v209
    v_fma_f32 v210, -v96, v18, v210
    v_mfma_f32_32x32x16_bf16 v[192:207], a[60:63], v[172:175], v[192:207]
    v_fma_f32 v211, -v96, v19, v211
    v_fma_f32 v212, -v96, v20, v212
    v_fma_f32 v213, -v96, v21, v213
    v_fma_f32 v214, -v96, v22, v214
    v_fma_f32 v215, -v96, v23, v215
    v_mul_f32 v208, v208, v97
    v_mul_f32 v209, v209, v97
    v_mul_f32 v210, v210, v97
    v_mul_f32 v211, v211, v97
    v_mul_f32 v212, v212, v97
    v_mul_f32 v213, v213, v97
    v_mul_f32 v214, v214, v97
    v_mul_f32 v215, v215, v97
    v_cvt_pk_bf16_f32 v240, v208, v209
    v_cvt_pk_bf16_f32 v241, v210, v211
    v_cvt_pk_bf16_f32 v242, v212, v213
    v_cvt_pk_bf16_f32 v243, v214, v215
    ds_write_b128 v6, v[184:187] offset:6144
    ds_write_b128 v6, v[188:191] offset:7168
    ds_write_b128 v6, v[192:195] offset:8192
    ds_write_b128 v6, v[196:199] offset:9216
    ds_write_b128 v6, v[200:203] offset:10240
    ds_write_b128 v6, v[204:207] offset:11264
    v_mov_b32 v208, 0
    v_mov_b32 v209, 0
    v_mov_b32 v210, 0
    v_mov_b32 v211, 0
    v_mov_b32 v212, 0
    v_mov_b32 v213, 0
    v_mov_b32 v214, 0
    v_mov_b32 v215, 0
    v_mov_b32 v216, 0
    v_mov_b32 v217, 0
    v_mov_b32 v218, 0
    v_mov_b32 v219, 0
    v_mov_b32 v220, 0
    v_mov_b32 v221, 0
    v_mov_b32 v222, 0
    v_mov_b32 v223, 0
    s_waitcnt lgkmcnt(0)
    s_barrier
    ds_read_b128 v[184:187], v7 offset:6144
    ds_read_b128 v[188:191], v7 offset:7168
    ds_read_b128 v[192:195], v8 offset:6144
    ds_read_b128 v[196:199], v8 offset:7168
    ds_read_b128 v[200:203], v9 offset:6144
    ds_read_b128 v[204:207], v9 offset:7168
    v_mov_b32 v224, 0
    v_mov_b32 v225, 0
    v_mov_b32 v226, 0
    v_mov_b32 v227, 0
    v_mov_b32 v228, 0
    v_mov_b32 v229, 0
    v_mov_b32 v230, 0
    v_mov_b32 v231, 0
    v_mov_b32 v232, 0
    v_mov_b32 v233, 0
    v_mov_b32 v234, 0
    v_mov_b32 v235, 0
    v_mov_b32 v236, 0
    v_mov_b32 v237, 0
    v_mov_b32 v238, 0
    v_mov_b32 v239, 0
    v_mov_b32 v56, 0
    v_mov_b32 v57, 0
    v_mov_b32 v58, 0
    v_mov_b32 v59, 0
    v_mov_b32 v60, 0
    v_mov_b32 v61, 0
    v_mov_b32 v62, 0
    v_mov_b32 v63, 0
    s_add_u32 s67, s75, 0x10000
    v_add_u32 v6, s67, v1
    v_xor_b32 v7, 0x2000, v6
    v_xor_b32 v8, 0x4000, v6
    v_add_u32 v8, 2048, v8
    v_xor_b32 v9, 0x6000, v6
    v_add_u32 v9, 4096, v9
    v_mul_f32 v99, 0x3eb8aa3b, v99
    s_waitcnt lgkmcnt(5)
    v_pk_add_f32 v[176:177], v[176:177], v[184:185]
    v_pk_add_f32 v[178:179], v[178:179], v[186:187]
    s_waitcnt lgkmcnt(4)
    v_pk_add_f32 v[180:181], v[180:181], v[188:189]
    v_pk_add_f32 v[182:183], v[182:183], v[190:191]
    s_waitcnt lgkmcnt(3)
    v_pk_add_f32 v[176:177], v[176:177], v[192:193]
    v_pk_add_f32 v[178:179], v[178:179], v[194:195]
    s_waitcnt lgkmcnt(2)
    v_pk_add_f32 v[180:181], v[180:181], v[196:197]
    v_pk_add_f32 v[182:183], v[182:183], v[198:199]
    s_waitcnt lgkmcnt(1)
    v_pk_add_f32 v[176:177], v[176:177], v[200:201]
    v_pk_add_f32 v[178:179], v[178:179], v[202:203]
    s_waitcnt lgkmcnt(0)
    v_pk_add_f32 v[180:181], v[180:181], v[204:205]
    v_pk_add_f32 v[182:183], v[182:183], v[206:207]
    v_fma_f32 v176, -v98, v16, v176
    v_fma_f32 v177, -v98, v17, v177
    v_fma_f32 v178, -v98, v18, v178
    v_fma_f32 v179, -v98, v19, v179
    v_fma_f32 v180, -v98, v20, v180
    v_fma_f32 v181, -v98, v21, v181
    v_fma_f32 v182, -v98, v22, v182
    v_fma_f32 v183, -v98, v23, v183
    v_mul_f32 v176, v176, v99
    v_mul_f32 v177, v177, v99
    v_mul_f32 v178, v178, v99
    v_mul_f32 v179, v179, v99
    v_mul_f32 v180, v180, v99
    v_mul_f32 v181, v181, v99
    v_mul_f32 v182, v182, v99
    v_mul_f32 v183, v183, v99
    v_cvt_pk_bf16_f32 v244, v176, v177
    v_cvt_pk_bf16_f32 v245, v178, v179
    v_cvt_pk_bf16_f32 v246, v180, v181
    v_cvt_pk_bf16_f32 v247, v182, v183
    s_waitcnt vmcnt(0)
    v_and_b32 v36, -16, v36
    v_cmp_ne_u64 vcc, s[60:61], v[36:37]
    s_cbranch_vccnz L_kp_11
L_kb_12:
    s_add_u32 m0, s76, 0x0
    s_nop 0
    buffer_load_dwordx4 v1, s[12:15], m0 offen sc1 lds
    s_add_u32 m0, s76, 0x8000
    s_nop 0
    buffer_load_dwordx4 v1, s[12:15], m0 offen sc1 lds
    s_add_u32 m0, s76, 0x1000
    s_nop 0
    buffer_load_dwordx4 v1, s[12:15], m0 offen sc1 lds
    s_add_u32 m0, s76, 0x9000
    s_nop 0
    buffer_load_dwordx4 v1, s[12:15], m0 offen sc1 lds
    v_add_u32 v41, s98, v1
    v_lshrrev_b32 v42, 5, v0
    v_lshlrev_b32 v42, 9, v42
    v_bfe_u32 v43, v0, 2, 2
    v_lshl_or_b32 v42, v43, 6, v42
    v_bfe_u32 v43, v1, 8, 1
    v_lshl_or_b32 v42, v43, 5, v42
    v_and_b32 v43, 1, v0
    v_lshl_or_b32 v42, v43, 4, v42
    v_bfe_u32 v43, v0, 1, 1
    v_lshl_or_b32 v42, v43, 3, v42
    v_add_u32 v42, s98, v42
    ds_write_b128 v41, a[64:67] offset:12288
    ds_write_b128 v41, a[68:71] offset:13312
    ds_write_b128 v41, a[72:75] offset:14336
    ds_write_b128 v41, a[76:79] offset:15360
    ds_read_b64_tr_b16 v[144:145], v42 offset:12288
    ds_read_b64_tr_b16 v[146:147], v42 offset:12544
    ds_read_b64_tr_b16 v[148:149], v42 offset:13312
    ds_read_b64_tr_b16 v[150:151], v42 offset:13568
    ds_read_b64_tr_b16 v[152:153], v42 offset:14336
    ds_read_b64_tr_b16 v[154:155], v42 offset:14592
    ds_read_b64_tr_b16 v[156:157], v42 offset:15360
    ds_read_b64_tr_b16 v[158:159], v42 offset:15616
    s_waitcnt lgkmcnt(6)
    v_mfma_f32_16x16x32_bf16 v[100:103], v[108:111], v[144:147], 0
    s_waitcnt lgkmcnt(4)
    v_mfma_f32_16x16x32_bf16 v[100:103], v[108:111], v[148:151], v[100:103]
    s_waitcnt lgkmcnt(2)
    v_mfma_f32_16x16x32_bf16 v[100:103], v[108:111], v[152:155], v[100:103]
    s_waitcnt lgkmcnt(0)
    v_mfma_f32_16x16x32_bf16 v[100:103], v[108:111], v[156:159], v[100:103]
    buffer_store_dwordx4 v[144:147], v1, s[4:7], s99 offen sc1
    buffer_store_dwordx4 v[148:151], v1, s[4:7], s99 offen offset:1024 sc1
    buffer_store_dwordx4 v[152:155], v1, s[4:7], s99 offen offset:2048 sc1
    buffer_store_dwordx4 v[156:159], v1, s[4:7], s99 offen offset:3072 sc1
    s_nop 3
    ds_write_b32 v73, v100 offset:2048
    buffer_store_dwordx4 v[32:35], v1, s[4:7], s66 offen sc1
    s_waitcnt vmcnt(5)
    s_waitcnt lgkmcnt(0)
    s_barrier
    s_cmp_eq_u32 s56, 0
    s_cbranch_scc0 L_sk_13
    ds_read_b128 v[100:103], v72 offset:2048
    s_waitcnt lgkmcnt(0)
    v_add_f32 v100, v100, v101
    v_add_f32 v102, v102, v103
    v_add_f32 v100, v100, v102
    v_cvt_pk_bf16_f32 v101, v100, v100
    v_lshlrev_b32 v102, 16, v101
    v_sub_f32 v100, v100, v102
    v_cvt_pk_bf16_f32 v100, v102, v100
    v_and_b32 v101, 0xffff, v101
    v_lshl_or_b32 v101, v28, 16, v101
    buffer_store_dwordx2 v[100:101], v1, s[4:7], s100 offen sc1
L_sk_13:
L_loop:
    s_mov_b32 s68, 0x1f800000
    s_mov_b32 s69, 0x5f800000
    ds_read_b128 v[88:91], v1 offset:0
    ds_read_b128 v[96:99], v11 offset:0
    ds_read_b128 v[100:103], v11 offset:512
    s_waitcnt lgkmcnt(2)
    v_mfma_f32_32x32x16_bf16 v[176:191], v[88:91], v[240:243], 0
    s_nop 11
    v_exp_f32 v176, v176
    v_exp_f32 v177, v177
    ds_read_b128 v[92:95], v1 offset:1024
    v_exp_f32 v178, v178
    v_exp_f32 v179, v179
    v_exp_f32 v180, v180
    v_mfma_f32_32x32x16_bf16 v[192:207], v[88:91], v[244:247], 0
    ds_read_b128 v[104:107], v11 offset:1024
    v_exp_f32 v181, v181
    v_exp_f32 v182, v182
    v_exp_f32 v183, v183
    v_exp_f32 v184, v184
    v_exp_f32 v185, v185
    s_waitcnt lgkmcnt(3)
    v_smfmac_f32_32x32x32_bf16 v[208:223], v[96:99], v[176:183], v10
    s_add_u32 m0, s76, 0x2000
    ds_read_b128 v[108:111], v11 offset:1536
    v_exp_f32 v186, v186
    v_exp_f32 v187, v187
    v_exp_f32 v188, v188
    v_exp_f32 v189, v189
    v_exp_f32 v190, v190
    v_exp_f32 v191, v191
    v_exp_f32 v192, v192
    v_exp_f32 v193, v193
    s_waitcnt lgkmcnt(3)
    v_smfmac_f32_32x32x32_bf16 v[208:223], v[100:103], v[184:191], v10
    s_waitcnt lgkmcnt(2)
    buffer_load_dwordx4 v1, s[12:15], m0 offen sc1 lds
    s_add_u32 m0, s76, 0xa000
    v_exp_f32 v194, v194
    v_exp_f32 v195, v195
    v_exp_f32 v196, v196
    v_mfma_f32_32x32x16_bf16 v[176:191], v[92:95], v[240:243], 0
    buffer_load_dwordx4 v1, s[12:15], m0 offen sc1 lds
    s_add_u32 m0, s76, 0x3000
    v_exp_f32 v197, v197
    v_exp_f32 v198, v198
    v_exp_f32 v199, v199
    v_exp_f32 v200, v200
    v_exp_f32 v201, v201
    v_smfmac_f32_32x32x32_bf16 v[224:239], v[96:99], v[192:199], v10
    s_waitcnt lgkmcnt(0)
    buffer_load_dwordx4 v1, s[12:15], m0 offen sc1 lds
    v_exp_f32 v202, v202
    v_exp_f32 v203, v203
    v_exp_f32 v204, v204
    v_exp_f32 v205, v205
    v_exp_f32 v206, v206
    v_exp_f32 v207, v207
    v_exp_f32 v176, v176
    v_exp_f32 v177, v177
    v_smfmac_f32_32x32x32_bf16 v[224:239], v[100:103], v[200:207], v10
    ds_read_b128 v[88:91], v1 offset:2048
    v_exp_f32 v178, v178
    v_exp_f32 v179, v179
    v_exp_f32 v180, v180
    v_mfma_f32_32x32x16_bf16 v[192:207], v[92:95], v[244:247], 0
    ds_read_b128 v[96:99], v11 offset:2048
    v_exp_f32 v181, v181
    v_exp_f32 v182, v182
    v_exp_f32 v183, v183
    v_exp_f32 v184, v184
    v_exp_f32 v185, v185
    v_smfmac_f32_32x32x32_bf16 v[208:223], v[104:107], v[176:183], v10
    s_add_u32 m0, s76, 0xb000
    ds_read_b128 v[100:103], v11 offset:2560
    v_exp_f32 v186, v186
    v_exp_f32 v187, v187
    v_exp_f32 v188, v188
    v_exp_f32 v189, v189
    v_exp_f32 v190, v190
    v_exp_f32 v191, v191
    v_exp_f32 v192, v192
    v_exp_f32 v193, v193
    v_smfmac_f32_32x32x32_bf16 v[208:223], v[108:111], v[184:191], v10
    s_waitcnt lgkmcnt(2)
    buffer_load_dwordx4 v1, s[12:15], m0 offen sc1 lds
    s_add_u32 m0, s76, 0x4000
    v_exp_f32 v194, v194
    v_exp_f32 v195, v195
    v_exp_f32 v196, v196
    v_mfma_f32_32x32x16_bf16 v[176:191], v[88:91], v[240:243], 0
    buffer_load_dwordx4 v1, s[12:15], m0 offen sc1 lds
    s_add_u32 m0, s76, 0xc000
    v_exp_f32 v197, v197
    v_exp_f32 v198, v198
    v_exp_f32 v199, v199
    v_exp_f32 v200, v200
    v_exp_f32 v201, v201
    v_smfmac_f32_32x32x32_bf16 v[224:239], v[104:107], v[192:199], v10
    s_waitcnt lgkmcnt(0)
    buffer_load_dwordx4 v1, s[12:15], m0 offen sc1 lds
    v_exp_f32 v202, v202
    v_exp_f32 v203, v203
    v_exp_f32 v204, v204
    v_exp_f32 v205, v205
    v_exp_f32 v206, v206
    v_exp_f32 v207, v207
    v_exp_f32 v176, v176
    v_exp_f32 v177, v177
    v_smfmac_f32_32x32x32_bf16 v[224:239], v[108:111], v[200:207], v10
    ds_read_b128 v[92:95], v1 offset:3072
    v_exp_f32 v178, v178
    v_exp_f32 v179, v179
    v_exp_f32 v180, v180
    v_mfma_f32_32x32x16_bf16 v[192:207], v[88:91], v[244:247], 0
    ds_read_b128 v[104:107], v11 offset:3072
    v_exp_f32 v181, v181
    v_exp_f32 v182, v182
    v_exp_f32 v183, v183
    v_exp_f32 v184, v184
    v_exp_f32 v185, v185
    v_smfmac_f32_32x32x32_bf16 v[208:223], v[96:99], v[176:183], v10
    s_add_u32 m0, s76, 0x5000
    ds_read_b128 v[108:111], v11 offset:3584
    v_exp_f32 v186, v186
    v_exp_f32 v187, v187
    v_exp_f32 v188, v188
    v_exp_f32 v189, v189
    v_exp_f32 v190, v190
    v_exp_f32 v191, v191
    v_exp_f32 v192, v192
    v_exp_f32 v193, v193
    v_smfmac_f32_32x32x32_bf16 v[208:223], v[100:103], v[184:191], v10
    s_waitcnt lgkmcnt(2)
    buffer_load_dwordx4 v1, s[12:15], m0 offen sc1 lds
    s_add_u32 m0, s76, 0xd000
    v_exp_f32 v194, v194
    v_exp_f32 v195, v195
    v_exp_f32 v196, v196
    v_mfma_f32_32x32x16_bf16 v[176:191], v[92:95], v[240:243], 0
    buffer_load_dwordx4 v1, s[12:15], m0 offen sc1 lds
    s_add_u32 m0, s76, 0x6000
    v_exp_f32 v197, v197
    v_exp_f32 v198, v198
    v_exp_f32 v199, v199
    v_exp_f32 v200, v200
    v_exp_f32 v201, v201
    v_smfmac_f32_32x32x32_bf16 v[224:239], v[96:99], v[192:199], v10
    s_waitcnt lgkmcnt(0)
    buffer_load_dwordx4 v1, s[12:15], m0 offen sc1 lds
    v_exp_f32 v202, v202
    v_exp_f32 v203, v203
    v_exp_f32 v204, v204
    v_exp_f32 v205, v205
    v_exp_f32 v206, v206
    v_exp_f32 v207, v207
    v_exp_f32 v176, v176
    v_exp_f32 v177, v177
    v_smfmac_f32_32x32x32_bf16 v[224:239], v[100:103], v[200:207], v10
    ds_read_b128 v[88:91], v1 offset:4096
    v_exp_f32 v178, v178
    v_exp_f32 v179, v179
    v_exp_f32 v180, v180
    v_mfma_f32_32x32x16_bf16 v[192:207], v[92:95], v[244:247], 0
    v_add_u32 v11, v38, v11
    ds_read_b128 v[96:99], v11 offset:0
    v_exp_f32 v181, v181
    v_exp_f32 v182, v182
    v_exp_f32 v183, v183
    v_exp_f32 v184, v184
    v_exp_f32 v185, v185
    v_smfmac_f32_32x32x32_bf16 v[208:223], v[104:107], v[176:183], v10
    s_add_u32 m0, s76, 0xe000
    ds_read_b128 v[100:103], v11 offset:512
    v_exp_f32 v186, v186
    v_exp_f32 v187, v187
    v_exp_f32 v188, v188
    v_exp_f32 v189, v189
    v_exp_f32 v190, v190
    v_exp_f32 v191, v191
    v_exp_f32 v192, v192
    v_exp_f32 v193, v193
    v_smfmac_f32_32x32x32_bf16 v[208:223], v[108:111], v[184:191], v10
    s_waitcnt lgkmcnt(2)
    buffer_load_dwordx4 v1, s[12:15], m0 offen sc1 lds
    s_add_u32 m0, s76, 0x7000
    v_exp_f32 v194, v194
    v_exp_f32 v195, v195
    v_exp_f32 v196, v196
    v_mfma_f32_32x32x16_bf16 v[176:191], v[88:91], v[240:243], 0
    buffer_load_dwordx4 v1, s[12:15], m0 offen sc1 lds
    s_add_u32 m0, s76, 0xf000
    v_exp_f32 v197, v197
    v_exp_f32 v198, v198
    v_exp_f32 v199, v199
    v_exp_f32 v200, v200
    v_exp_f32 v201, v201
    v_smfmac_f32_32x32x32_bf16 v[224:239], v[104:107], v[192:199], v10
    s_waitcnt lgkmcnt(0)
    s_cmp_gt_u32 s57, s56
    s_cbranch_scc0 L_sk_14
    s_cmp_ge_u32 s55, 4
    s_cbranch_scc0 L_sk_14
    v_mov_b32 v36, s59
    v_mov_b32 v37, s61
    s_mov_b64 exec, 1
    buffer_store_dwordx2 v[36:37], v3, s[4:7], s79 offen sc1
    s_mov_b64 exec, -1
L_sk_14:
    buffer_load_dwordx4 v1, s[12:15], m0 offen sc1 lds
    v_exp_f32 v202, v202
    v_exp_f32 v203, v203
    v_exp_f32 v204, v204
    v_exp_f32 v205, v205
    v_exp_f32 v206, v206
    v_exp_f32 v207, v207
    v_exp_f32 v176, v176
    v_exp_f32 v177, v177
    v_smfmac_f32_32x32x32_bf16 v[224:239], v[108:111], v[200:207], v10
    ds_read_b128 v[92:95], v1 offset:5120
    v_exp_f32 v178, v178
    v_exp_f32 v179, v179
    v_exp_f32 v180, v180
    v_mfma_f32_32x32x16_bf16 v[192:207], v[88:91], v[244:247], 0
    ds_read_b128 v[104:107], v11 offset:1024
    v_exp_f32 v181, v181
    v_exp_f32 v182, v182
    v_exp_f32 v183, v183
    v_exp_f32 v184, v184
    v_exp_f32 v185, v185
    v_smfmac_f32_32x32x32_bf16 v[208:223], v[96:99], v[176:183], v10
    ds_read_b128 v[108:111], v11 offset:1536
    v_exp_f32 v186, v186
    v_exp_f32 v187, v187
    v_exp_f32 v188, v188
    v_exp_f32 v189, v189
    v_exp_f32 v190, v190
    v_exp_f32 v191, v191
    v_exp_f32 v192, v192
    v_exp_f32 v193, v193
    v_smfmac_f32_32x32x32_bf16 v[208:223], v[100:103], v[184:191], v10
    s_waitcnt lgkmcnt(2)
    v_exp_f32 v194, v194
    v_exp_f32 v195, v195
    v_exp_f32 v196, v196
    v_mfma_f32_32x32x16_bf16 v[176:191], v[92:95], v[240:243], 0
    v_exp_f32 v197, v197
    v_exp_f32 v198, v198
    v_exp_f32 v199, v199
    v_exp_f32 v200, v200
    v_exp_f32 v201, v201
    v_smfmac_f32_32x32x32_bf16 v[224:239], v[96:99], v[192:199], v10
    s_waitcnt lgkmcnt(0)
    v_exp_f32 v202, v202
    v_exp_f32 v203, v203
    v_exp_f32 v204, v204
    v_exp_f32 v205, v205
    v_exp_f32 v206, v206
    v_exp_f32 v207, v207
    v_exp_f32 v176, v176
    v_exp_f32 v177, v177
    v_smfmac_f32_32x32x32_bf16 v[224:239], v[100:103], v[200:207], v10
    ds_read_b128 v[88:91], v1 offset:6144
    v_exp_f32 v178, v178
    v_exp_f32 v179, v179
    v_exp_f32 v180, v180
    v_mfma_f32_32x32x16_bf16 v[192:207], v[92:95], v[244:247], 0
    ds_read_b128 v[96:99], v11 offset:2048
    v_exp_f32 v181, v181
    v_exp_f32 v182, v182
    v_exp_f32 v183, v183
    v_exp_f32 v184, v184
    v_exp_f32 v185, v185
    v_smfmac_f32_32x32x32_bf16 v[208:223], v[104:107], v[176:183], v10
    ds_read_b128 v[100:103], v11 offset:2560
    v_exp_f32 v186, v186
    v_exp_f32 v187, v187
    v_exp_f32 v188, v188
    v_exp_f32 v189, v189
    v_exp_f32 v190, v190
    v_exp_f32 v191, v191
    v_exp_f32 v192, v192
    v_exp_f32 v193, v193
    v_smfmac_f32_32x32x32_bf16 v[208:223], v[108:111], v[184:191], v10
    s_waitcnt lgkmcnt(2)
    v_exp_f32 v194, v194
    v_exp_f32 v195, v195
    v_exp_f32 v196, v196
    v_mfma_f32_32x32x16_bf16 v[176:191], v[88:91], v[240:243], 0
    v_exp_f32 v197, v197
    v_exp_f32 v198, v198
    v_exp_f32 v199, v199
    v_exp_f32 v200, v200
    v_exp_f32 v201, v201
    v_smfmac_f32_32x32x32_bf16 v[224:239], v[104:107], v[192:199], v10
    s_waitcnt lgkmcnt(0)
    v_exp_f32 v202, v202
    v_exp_f32 v203, v203
    v_exp_f32 v204, v204
    v_exp_f32 v205, v205
    v_exp_f32 v206, v206
    v_exp_f32 v207, v207
    v_exp_f32 v176, v176
    v_exp_f32 v177, v177
    v_smfmac_f32_32x32x32_bf16 v[224:239], v[108:111], v[200:207], v10
    ds_read_b128 v[92:95], v1 offset:7168
    v_exp_f32 v178, v178
    v_exp_f32 v179, v179
    v_exp_f32 v180, v180
    v_mfma_f32_32x32x16_bf16 v[192:207], v[88:91], v[244:247], 0
    ds_read_b128 v[104:107], v11 offset:3072
    v_exp_f32 v181, v181
    v_exp_f32 v182, v182
    v_exp_f32 v183, v183
    v_exp_f32 v184, v184
    v_exp_f32 v185, v185
    v_smfmac_f32_32x32x32_bf16 v[208:223], v[96:99], v[176:183], v10
    ds_read_b128 v[108:111], v11 offset:3584
    v_exp_f32 v186, v186
    v_exp_f32 v187, v187
    v_exp_f32 v188, v188
    v_exp_f32 v189, v189
    v_exp_f32 v190, v190
    v_exp_f32 v191, v191
    v_exp_f32 v192, v192
    v_exp_f32 v193, v193
    v_smfmac_f32_32x32x32_bf16 v[208:223], v[100:103], v[184:191], v10
    s_waitcnt lgkmcnt(2)
    v_exp_f32 v194, v194
    v_exp_f32 v195, v195
    v_exp_f32 v196, v196
    v_mfma_f32_32x32x16_bf16 v[176:191], v[92:95], v[240:243], 0
    v_exp_f32 v197, v197
    v_exp_f32 v198, v198
    v_exp_f32 v199, v199
    v_exp_f32 v200, v200
    v_exp_f32 v201, v201
    v_smfmac_f32_32x32x32_bf16 v[224:239], v[96:99], v[192:199], v10
    s_waitcnt lgkmcnt(0)
    s_waitcnt vmcnt(0)
    s_barrier
    s_or_b32 s64, s57, s56
    s_cmp_eq_u32 s64, 0
    s_cbranch_scc0 L_sk_15
    s_lshl_b32 s64, s54, 7
    s_add_u32 s64, s64, s101
    s_mov_b64 exec, 1
    buffer_store_dwordx2 v[4:5], v3, s[4:7], s64 offen sc1
    s_mov_b64 exec, -1
L_sk_15:
    v_exp_f32 v202, v202
    v_exp_f32 v203, v203
    v_exp_f32 v204, v204
    v_exp_f32 v205, v205
    v_exp_f32 v206, v206
    v_exp_f32 v207, v207
    v_exp_f32 v176, v176
    v_exp_f32 v177, v177
    v_smfmac_f32_32x32x32_bf16 v[224:239], v[100:103], v[200:207], v10
    ds_read_b128 v[88:91], v1 offset:8192
    v_exp_f32 v178, v178
    v_exp_f32 v179, v179
    v_exp_f32 v180, v180
    v_mfma_f32_32x32x16_bf16 v[192:207], v[92:95], v[244:247], 0
    v_add_u32 v11, v38, v11
    ds_read_b128 v[96:99], v11 offset:0
    v_exp_f32 v181, v181
    v_exp_f32 v182, v182
    v_exp_f32 v183, v183
    v_exp_f32 v184, v184
    v_exp_f32 v185, v185
    v_smfmac_f32_32x32x32_bf16 v[208:223], v[104:107], v[176:183], v10
    ds_read_b128 v[100:103], v11 offset:512
    v_exp_f32 v186, v186
    v_exp_f32 v187, v187
    v_exp_f32 v188, v188
    v_exp_f32 v189, v189
    v_exp_f32 v190, v190
    v_exp_f32 v191, v191
    v_exp_f32 v192, v192
    v_exp_f32 v193, v193
    v_smfmac_f32_32x32x32_bf16 v[208:223], v[108:111], v[184:191], v10
    s_waitcnt lgkmcnt(2)
    v_exp_f32 v194, v194
    v_exp_f32 v195, v195
    v_exp_f32 v196, v196
    v_mfma_f32_32x32x16_bf16 v[176:191], v[88:91], v[240:243], 0
    v_exp_f32 v197, v197
    v_exp_f32 v198, v198
    v_exp_f32 v199, v199
    v_exp_f32 v200, v200
    v_exp_f32 v201, v201
    v_smfmac_f32_32x32x32_bf16 v[224:239], v[104:107], v[192:199], v10
    s_waitcnt lgkmcnt(0)
    v_exp_f32 v202, v202
    v_exp_f32 v203, v203
    v_exp_f32 v204, v204
    v_exp_f32 v205, v205
    v_exp_f32 v206, v206
    v_exp_f32 v207, v207
    v_exp_f32 v176, v176
    v_exp_f32 v177, v177
    v_smfmac_f32_32x32x32_bf16 v[224:239], v[108:111], v[200:207], v10
    ds_read_b128 v[92:95], v1 offset:9216
    v_exp_f32 v178, v178
    v_exp_f32 v179, v179
    v_exp_f32 v180, v180
    v_mfma_f32_32x32x16_bf16 v[192:207], v[88:91], v[244:247], 0
    ds_read_b128 v[104:107], v11 offset:1024
    v_exp_f32 v181, v181
    v_exp_f32 v182, v182
    v_exp_f32 v183, v183
    v_exp_f32 v184, v184
    v_exp_f32 v185, v185
    v_smfmac_f32_32x32x32_bf16 v[208:223], v[96:99], v[176:183], v10
    s_add_u32 s65, s80, 4096
    ds_read_b128 v[108:111], v11 offset:1536
    v_exp_f32 v186, v186
    v_exp_f32 v187, v187
    v_exp_f32 v188, v188
    v_exp_f32 v189, v189
    v_exp_f32 v190, v190
    v_exp_f32 v191, v191
    v_exp_f32 v192, v192
    v_exp_f32 v193, v193
    v_smfmac_f32_32x32x32_bf16 v[208:223], v[100:103], v[184:191], v10
    s_waitcnt lgkmcnt(2)
    buffer_load_dwordx2 v[36:37], v66, s[4:7], s65 offen sc1
    v_exp_f32 v194, v194
    v_exp_f32 v195, v195
    v_exp_f32 v196, v196
    v_mfma_f32_32x32x16_bf16 v[176:191], v[92:95], v[240:243], 0
    v_exp_f32 v197, v197
    v_exp_f32 v198, v198
    v_exp_f32 v199, v199
    v_exp_f32 v200, v200
    v_exp_f32 v201, v201
    v_smfmac_f32_32x32x32_bf16 v[224:239], v[96:99], v[192:199], v10
    s_waitcnt lgkmcnt(0)
    v_exp_f32 v202, v202
    v_exp_f32 v203, v203
    v_exp_f32 v204, v204
    v_exp_f32 v205, v205
    v_exp_f32 v206, v206
    v_exp_f32 v207, v207
    v_exp_f32 v176, v176
    v_exp_f32 v177, v177
    v_smfmac_f32_32x32x32_bf16 v[224:239], v[100:103], v[200:207], v10
    ds_read_b128 v[88:91], v1 offset:10240
    v_exp_f32 v178, v178
    v_exp_f32 v179, v179
    v_exp_f32 v180, v180
    v_mfma_f32_32x32x16_bf16 v[192:207], v[92:95], v[244:247], 0
    ds_read_b128 v[96:99], v11 offset:2048
    v_exp_f32 v181, v181
    v_exp_f32 v182, v182
    v_exp_f32 v183, v183
    v_exp_f32 v184, v184
    v_exp_f32 v185, v185
    v_smfmac_f32_32x32x32_bf16 v[208:223], v[104:107], v[176:183], v10
    ds_read_b128 v[100:103], v11 offset:2560
    v_exp_f32 v186, v186
    v_exp_f32 v187, v187
    v_exp_f32 v188, v188
    v_exp_f32 v189, v189
    v_exp_f32 v190, v190
    v_exp_f32 v191, v191
    v_exp_f32 v192, v192
    v_exp_f32 v193, v193
    v_smfmac_f32_32x32x32_bf16 v[208:223], v[108:111], v[184:191], v10
    s_waitcnt lgkmcnt(2)
    buffer_load_dwordx2 v[68:69], v66, s[4:7], s101 offen sc1
    v_exp_f32 v194, v194
    v_exp_f32 v195, v195
    v_exp_f32 v196, v196
    v_mfma_f32_32x32x16_bf16 v[176:191], v[88:91], v[240:243], 0
    v_exp_f32 v197, v197
    v_exp_f32 v198, v198
    v_exp_f32 v199, v199
    v_exp_f32 v200, v200
    v_exp_f32 v201, v201
    v_smfmac_f32_32x32x32_bf16 v[224:239], v[104:107], v[192:199], v10
    s_waitcnt lgkmcnt(0)
    v_exp_f32 v202, v202
    v_exp_f32 v203, v203
    v_exp_f32 v204, v204
    v_exp_f32 v205, v205
    v_exp_f32 v206, v206
    v_exp_f32 v207, v207
    v_exp_f32 v176, v176
    v_exp_f32 v177, v177
    v_smfmac_f32_32x32x32_bf16 v[224:239], v[108:111], v[200:207], v10
    ds_read_b128 v[92:95], v1 offset:11264
    v_exp_f32 v178, v178
    v_exp_f32 v179, v179
    v_exp_f32 v180, v180
    v_mfma_f32_32x32x16_bf16 v[192:207], v[88:91], v[244:247], 0
    ds_read_b128 v[104:107], v11 offset:3072
    v_exp_f32 v181, v181
    v_exp_f32 v182, v182
    v_exp_f32 v183, v183
    v_exp_f32 v184, v184
    v_exp_f32 v185, v185
    v_smfmac_f32_32x32x32_bf16 v[208:223], v[96:99], v[176:183], v10
    ds_read_b128 v[108:111], v11 offset:3584
    v_exp_f32 v186, v186
    v_exp_f32 v187, v187
    v_exp_f32 v188, v188
    v_exp_f32 v189, v189
    v_exp_f32 v190, v190
    v_exp_f32 v191, v191
    v_exp_f32 v192, v192
    v_exp_f32 v193, v193
    v_smfmac_f32_32x32x32_bf16 v[208:223], v[100:103], v[184:191], v10
    s_waitcnt lgkmcnt(2)
    v_exp_f32 v194, v194
    v_exp_f32 v195, v195
    v_exp_f32 v196, v196
    v_mfma_f32_32x32x16_bf16 v[176:191], v[92:95], v[240:243], 0
    v_exp_f32 v197, v197
    v_exp_f32 v198, v198
    v_exp_f32 v199, v199
    v_exp_f32 v200, v200
    v_exp_f32 v201, v201
    v_smfmac_f32_32x32x32_bf16 v[224:239], v[96:99], v[192:199], v10
    s_waitcnt lgkmcnt(0)
    s_waitcnt vmcnt(1)
    v_and_b32 v36, -16, v36
    v_cmp_ne_u64 vcc, s[60:61], v[36:37]
    s_cbranch_vccnz L_kp_16
L_kb_17:
    v_exp_f32 v202, v202
    v_exp_f32 v203, v203
    v_exp_f32 v204, v204
    v_exp_f32 v205, v205
    v_exp_f32 v206, v206
    v_exp_f32 v207, v207
    v_exp_f32 v176, v176
    v_exp_f32 v177, v177
    v_smfmac_f32_32x32x32_bf16 v[224:239], v[100:103], v[200:207], v10
    ds_read_b128 v[88:91], v1 offset:12288
    v_exp_f32 v178, v178
    v_exp_f32 v179, v179
    v_exp_f32 v180, v180
    v_mfma_f32_32x32x16_bf16 v[192:207], v[92:95], v[244:247], 0
    v_add_u32 v11, v38, v11
    ds_read_b128 v[96:99], v11 offset:0
    v_exp_f32 v181, v181
    v_exp_f32 v182, v182
    v_exp_f32 v183, v183
    v_exp_f32 v184, v184
    v_exp_f32 v185, v185
    v_smfmac_f32_32x32x32_bf16 v[208:223], v[104:107], v[176:183], v10
    s_add_u32 m0, s76, 0x10000
    ds_read_b128 v[100:103], v11 offset:512
    v_exp_f32 v186, v186
    v_exp_f32 v187, v187
    v_exp_f32 v188, v188
    v_exp_f32 v189, v189
    v_exp_f32 v190, v190
    v_exp_f32 v191, v191
    v_exp_f32 v192, v192
    v_exp_f32 v193, v193
    v_smfmac_f32_32x32x32_bf16 v[208:223], v[108:111], v[184:191], v10
    s_waitcnt lgkmcnt(2)
    buffer_load_dwordx4 v1, s[12:15], m0 offen sc1 lds
    v_exp_f32 v194, v194
    v_exp_f32 v195, v195
    v_exp_f32 v196, v196
    v_mfma_f32_32x32x16_bf16 v[176:191], v[88:91], v[240:243], 0
    s_add_u32 m0, s76, 0x18000
    v_exp_f32 v197, v197
    v_exp_f32 v198, v198
    v_exp_f32 v199, v199
    v_exp_f32 v200, v200
    v_exp_f32 v201, v201
    v_smfmac_f32_32x32x32_bf16 v[224:239], v[104:107], v[192:199], v10
    s_waitcnt lgkmcnt(0)
    s_waitcnt vmcnt(1)
    v_cmp_ne_u64 vcc, s[60:61], v[68:69]
    s_cbranch_vccnz L_swpoll
L_swback:
    buffer_load_dwordx4 v1, s[12:15], m0 offen sc1 lds
    v_exp_f32 v202, v202
    v_exp_f32 v203, v203
    v_exp_f32 v204, v204
    v_exp_f32 v205, v205
    v_exp_f32 v206, v206
    v_exp_f32 v207, v207
    v_exp_f32 v176, v176
    v_exp_f32 v177, v177
    v_smfmac_f32_32x32x32_bf16 v[224:239], v[108:111], v[200:207], v10
    ds_read_b128 v[92:95], v1 offset:13312
    v_exp_f32 v178, v178
    v_exp_f32 v179, v179
    v_exp_f32 v180, v180
    v_mfma_f32_32x32x16_bf16 v[192:207], v[88:91], v[244:247], 0
    ds_read_b128 v[104:107], v11 offset:1024
    v_exp_f32 v181, v181
    v_exp_f32 v182, v182
    v_exp_f32 v183, v183
    v_exp_f32 v184, v184
    v_exp_f32 v185, v185
    v_smfmac_f32_32x32x32_bf16 v[208:223], v[96:99], v[176:183], v10
    s_add_u32 m0, s76, 0x11000
    ds_read_b128 v[108:111], v11 offset:1536
    v_exp_f32 v186, v186
    v_exp_f32 v187, v187
    v_exp_f32 v188, v188
    v_exp_f32 v189, v189
    v_exp_f32 v190, v190
    v_exp_f32 v191, v191
    v_exp_f32 v192, v192
    v_exp_f32 v193, v193
    v_smfmac_f32_32x32x32_bf16 v[208:223], v[100:103], v[184:191], v10
    s_waitcnt lgkmcnt(2)
    buffer_load_dwordx4 v1, s[12:15], m0 offen sc1 lds
    s_add_u32 s67, s87, 0
    v_exp_f32 v194, v194
    v_exp_f32 v195, v195
    v_exp_f32 v196, v196
    v_mfma_f32_32x32x16_bf16 v[176:191], v[92:95], v[240:243], 0
    buffer_load_dwordx4 v[112:115], v2, s[4:7], s67 offen sc1
    v_exp_f32 v197, v197
    v_exp_f32 v198, v198
    v_exp_f32 v199, v199
    v_exp_f32 v200, v200
    v_exp_f32 v201, v201
    v_smfmac_f32_32x32x32_bf16 v[224:239], v[96:99], v[192:199], v10
    s_waitcnt lgkmcnt(0)
    buffer_load_dwordx4 v[120:123], v2, s[4:7], s67 offen offset:1024 sc1
    v_exp_f32 v202, v202
    v_exp_f32 v203, v203
    v_exp_f32 v204, v204
    v_exp_f32 v205, v205
    v_exp_f32 v206, v206
    v_exp_f32 v207, v207
    v_exp_f32 v176, v176
    v_exp_f32 v177, v177
    v_smfmac_f32_32x32x32_bf16 v[224:239], v[100:103], v[200:207], v10
    ds_read_b128 v[88:91], v1 offset:14336
    v_exp_f32 v178, v178
    v_exp_f32 v179, v179
    v_exp_f32 v180, v180
    v_mfma_f32_32x32x16_bf16 v[192:207], v[92:95], v[244:247], 0
    ds_read_b128 v[96:99], v11 offset:2048
    v_exp_f32 v181, v181
    v_exp_f32 v182, v182
    v_exp_f32 v183, v183
    v_exp_f32 v184, v184
    v_exp_f32 v185, v185
    v_smfmac_f32_32x32x32_bf16 v[208:223], v[104:107], v[176:183], v10
    s_add_u32 m0, s76, 0x19000
    ds_read_b128 v[100:103], v11 offset:2560
    v_exp_f32 v186, v186
    v_exp_f32 v187, v187
    v_exp_f32 v188, v188
    v_exp_f32 v189, v189
    v_exp_f32 v190, v190
    v_exp_f32 v191, v191
    v_exp_f32 v192, v192
    v_exp_f32 v193, v193
    v_smfmac_f32_32x32x32_bf16 v[208:223], v[108:111], v[184:191], v10
    s_waitcnt lgkmcnt(2)
    buffer_load_dwordx4 v1, s[12:15], m0 offen sc1 lds
    v_exp_f32 v194, v194
    v_exp_f32 v195, v195
    v_exp_f32 v196, v196
    v_mfma_f32_32x32x16_bf16 v[176:191], v[88:91], v[240:243], 0
    buffer_load_dwordx4 v[128:131], v2, s[4:7], s67 offen offset:2048 sc1
    v_exp_f32 v197, v197
    v_exp_f32 v198, v198
    v_exp_f32 v199, v199
    v_exp_f32 v200, v200
    v_exp_f32 v201, v201
    v_smfmac_f32_32x32x32_bf16 v[224:239], v[104:107], v[192:199], v10
    s_waitcnt lgkmcnt(0)
    buffer_load_dwordx4 v[136:139], v2, s[4:7], s67 offen offset:3072 sc1
    v_exp_f32 v202, v202
    v_exp_f32 v203, v203
    v_exp_f32 v204, v204
    v_exp_f32 v205, v205
    v_exp_f32 v206, v206
    v_exp_f32 v207, v207
    v_exp_f32 v176, v176
    v_exp_f32 v177, v177
    v_smfmac_f32_32x32x32_bf16 v[224:239], v[108:111], v[200:207], v10
    ds_read_b128 v[92:95], v1 offset:15360
    v_exp_f32 v178, v178
    v_exp_f32 v179, v179
    v_exp_f32 v180, v180
    v_mfma_f32_32x32x16_bf16 v[192:207], v[88:91], v[244:247], 0
    ds_read_b128 v[104:107], v11 offset:3072
    v_exp_f32 v181, v181
    v_exp_f32 v182, v182
    v_exp_f32 v183, v183
    v_exp_f32 v184, v184
    v_exp_f32 v185, v185
    v_smfmac_f32_32x32x32_bf16 v[208:223], v[96:99], v[176:183], v10
    s_add_u32 m0, s76, 0x12000
    ds_read_b128 v[108:111], v11 offset:3584
    v_exp_f32 v186, v186
    v_exp_f32 v187, v187
    v_exp_f32 v188, v188
    v_exp_f32 v189, v189
    v_exp_f32 v190, v190
    v_exp_f32 v191, v191
    v_exp_f32 v192, v192
    v_exp_f32 v193, v193
    v_smfmac_f32_32x32x32_bf16 v[208:223], v[100:103], v[184:191], v10
    s_waitcnt lgkmcnt(2)
    buffer_load_dwordx4 v1, s[12:15], m0 offen sc1 lds
    s_add_u32 s67, s87, 4096
    v_exp_f32 v194, v194
    v_exp_f32 v195, v195
    v_exp_f32 v196, v196
    v_mfma_f32_32x32x16_bf16 v[176:191], v[92:95], v[240:243], 0
    buffer_load_dwordx4 v[144:147], v2, s[4:7], s67 offen sc1
    v_exp_f32 v197, v197
    v_exp_f32 v198, v198
    v_exp_f32 v199, v199
    v_exp_f32 v200, v200
    v_exp_f32 v201, v201
    v_smfmac_f32_32x32x32_bf16 v[224:239], v[96:99], v[192:199], v10
    s_waitcnt lgkmcnt(0)
    buffer_load_dwordx4 v[152:155], v2, s[4:7], s67 offen offset:1024 sc1
    v_exp_f32 v202, v202
    v_exp_f32 v203, v203
    v_exp_f32 v204, v204
    v_exp_f32 v205, v205
    v_exp_f32 v206, v206
    v_exp_f32 v207, v207
    v_exp_f32 v176, v176
    v_exp_f32 v177, v177
    v_smfmac_f32_32x32x32_bf16 v[224:239], v[100:103], v[200:207], v10
    ds_read_b128 v[88:91], v1 offset:16384
    v_exp_f32 v178, v178
    v_exp_f32 v179, v179
    v_exp_f32 v180, v180
    v_mfma_f32_32x32x16_bf16 v[192:207], v[92:95], v[244:247], 0
    v_add_u32 v11, v38, v11
    ds_read_b128 v[96:99], v11 offset:0
    v_exp_f32 v181, v181
    v_exp_f32 v182, v182
    v_exp_f32 v183, v183
    v_exp_f32 v184, v184
    v_exp_f32 v185, v185
    v_smfmac_f32_32x32x32_bf16 v[208:223], v[104:107], v[176:183], v10
    s_add_u32 m0, s76, 0x1a000
    ds_read_b128 v[100:103], v11 offset:512
    v_exp_f32 v186, v186
    v_exp_f32 v187, v187
    v_exp_f32 v188, v188
    v_exp_f32 v189, v189
    v_exp_f32 v190, v190
    v_exp_f32 v191, v191
    v_exp_f32 v192, v192
    v_exp_f32 v193, v193
    v_smfmac_f32_32x32x32_bf16 v[208:223], v[108:111], v[184:191], v10
    s_waitcnt lgkmcnt(2)
    buffer_load_dwordx4 v1, s[12:15], m0 offen sc1 lds
    v_exp_f32 v194, v194
    v_exp_f32 v195, v195
    v_exp_f32 v196, v196
    v_mfma_f32_32x32x16_bf16 v[176:191], v[88:91], v[240:243], 0
    buffer_load_dwordx4 v[160:163], v2, s[4:7], s67 offen offset:2048 sc1
    v_exp_f32 v197, v197
    v_exp_f32 v198, v198
    v_exp_f32 v199, v199
    v_exp_f32 v200, v200
    v_exp_f32 v201, v201
    v_smfmac_f32_32x32x32_bf16 v[224:239], v[104:107], v[192:199], v10
    s_waitcnt lgkmcnt(0)
    buffer_load_dwordx4 v[168:171], v2, s[4:7], s67 offen offset:3072 sc1
    v_exp_f32 v202, v202
    v_exp_f32 v203, v203
    v_exp_f32 v204, v204
    v_exp_f32 v205, v205
    v_exp_f32 v206, v206
    v_exp_f32 v207, v207
    v_exp_f32 v176, v176
    v_exp_f32 v177, v177
    v_smfmac_f32_32x32x32_bf16 v[224:239], v[108:111], v[200:207], v10
    ds_read_b128 v[92:95], v1 offset:17408
    v_exp_f32 v178, v178
    v_exp_f32 v179, v179
    v_exp_f32 v180, v180
    v_mfma_f32_32x32x16_bf16 v[192:207], v[88:91], v[244:247], 0
    ds_read_b128 v[104:107], v11 offset:1024
    v_exp_f32 v181, v181
    v_exp_f32 v182, v182
    v_exp_f32 v183, v183
    v_exp_f32 v184, v184
    v_exp_f32 v185, v185
    v_smfmac_f32_32x32x32_bf16 v[208:223], v[96:99], v[176:183], v10
    s_add_u32 m0, s76, 0x13000
    ds_read_b128 v[108:111], v11 offset:1536
    v_exp_f32 v186, v186
    v_exp_f32 v187, v187
    v_exp_f32 v188, v188
    v_exp_f32 v189, v189
    v_exp_f32 v190, v190
    v_exp_f32 v191, v191
    v_exp_f32 v192, v192
    v_exp_f32 v193, v193
    v_smfmac_f32_32x32x32_bf16 v[208:223], v[100:103], v[184:191], v10
    s_waitcnt lgkmcnt(2)
    buffer_load_dwordx4 v1, s[12:15], m0 offen sc1 lds
    v_exp_f32 v194, v194
    v_exp_f32 v195, v195
    v_exp_f32 v196, v196
    v_mfma_f32_32x32x16_bf16 v[176:191], v[92:95], v[240:243], 0
    s_add_u32 s67, s88, 0
    v_exp_f32 v197, v197
    v_exp_f32 v198, v198
    v_exp_f32 v199, v199
    v_exp_f32 v200, v200
    v_exp_f32 v201, v201
    v_smfmac_f32_32x32x32_bf16 v[224:239], v[96:99], v[192:199], v10
    s_waitcnt lgkmcnt(0)
    buffer_load_dwordx4 v[116:119], v2, s[4:7], s67 offen sc1
    v_exp_f32 v202, v202
    v_exp_f32 v203, v203
    v_exp_f32 v204, v204
    v_exp_f32 v205, v205
    v_exp_f32 v206, v206
    v_exp_f32 v207, v207
    v_exp_f32 v176, v176
    v_exp_f32 v177, v177
    v_smfmac_f32_32x32x32_bf16 v[224:239], v[100:103], v[200:207], v10
    ds_read_b128 v[88:91], v1 offset:18432
    v_exp_f32 v178, v178
    v_exp_f32 v179, v179
    v_exp_f32 v180, v180
    v_mfma_f32_32x32x16_bf16 v[192:207], v[92:95], v[244:247], 0
    ds_read_b128 v[96:99], v11 offset:2048
    v_exp_f32 v181, v181
    v_exp_f32 v182, v182
    v_exp_f32 v183, v183
    v_exp_f32 v184, v184
    v_exp_f32 v185, v185
    v_smfmac_f32_32x32x32_bf16 v[208:223], v[104:107], v[176:183], v10
    s_add_u32 m0, s76, 0x1b000
    ds_read_b128 v[100:103], v11 offset:2560
    v_exp_f32 v186, v186
    v_exp_f32 v187, v187
    v_exp_f32 v188, v188
    v_exp_f32 v189, v189
    v_exp_f32 v190, v190
    v_exp_f32 v191, v191
    v_exp_f32 v192, v192
    v_exp_f32 v193, v193
    v_smfmac_f32_32x32x32_bf16 v[208:223], v[108:111], v[184:191], v10
    s_waitcnt lgkmcnt(2)
    buffer_load_dwordx4 v1, s[12:15], m0 offen sc1 lds
    v_exp_f32 v194, v194
    v_exp_f32 v195, v195
    v_exp_f32 v196, v196
    v_mfma_f32_32x32x16_bf16 v[176:191], v[88:91], v[240:243], 0
    buffer_load_dwordx4 v[124:127], v2, s[4:7], s67 offen offset:1024 sc1
    v_exp_f32 v197, v197
    v_exp_f32 v198, v198
    v_exp_f32 v199, v199
    v_exp_f32 v200, v200
    v_exp_f32 v201, v201
    v_smfmac_f32_32x32x32_bf16 v[224:239], v[104:107], v[192:199], v10
    s_waitcnt lgkmcnt(0)
    buffer_load_dwordx4 v[132:135], v2, s[4:7], s67 offen offset:2048 sc1
    v_exp_f32 v202, v202
    v_exp_f32 v203, v203
    v_exp_f32 v204, v204
    v_exp_f32 v205, v205
    v_exp_f32 v206, v206
    v_exp_f32 v207, v207
    v_exp_f32 v176, v176
    v_exp_f32 v177, v177
    v_smfmac_f32_32x32x32_bf16 v[224:239], v[108:111], v[200:207], v10
    ds_read_b128 v[92:95], v1 offset:19456
    v_exp_f32 v178, v178
    v_exp_f32 v179, v179
    v_exp_f32 v180, v180
    v_mfma_f32_32x32x16_bf16 v[192:207], v[88:91], v[244:247], 0
    ds_read_b128 v[104:107], v11 offset:3072
    v_exp_f32 v181, v181
    v_exp_f32 v182, v182
    v_exp_f32 v183, v183
    v_exp_f32 v184, v184
    v_exp_f32 v185, v185
    v_smfmac_f32_32x32x32_bf16 v[208:223], v[96:99], v[176:183], v10
    s_add_u32 m0, s76, 0x14000
    ds_read_b128 v[108:111], v11 offset:3584
    v_exp_f32 v186, v186
    v_exp_f32 v187, v187
    v_exp_f32 v188, v188
    v_exp_f32 v189, v189
    v_exp_f32 v190, v190
    v_exp_f32 v191, v191
    v_exp_f32 v192, v192
    v_exp_f32 v193, v193
    v_smfmac_f32_32x32x32_bf16 v[208:223], v[100:103], v[184:191], v10
    s_waitcnt lgkmcnt(2)
    buffer_load_dwordx4 v1, s[12:15], m0 offen sc1 lds
    s_add_u32 m0, s76, 0x1c000
    v_exp_f32 v194, v194
    v_exp_f32 v195, v195
    v_exp_f32 v196, v196
    v_mfma_f32_32x32x16_bf16 v[176:191], v[92:95], v[240:243], 0
    buffer_load_dwordx4 v1, s[12:15], m0 offen sc1 lds
    v_exp_f32 v197, v197
    v_exp_f32 v198, v198
    v_exp_f32 v199, v199
    v_exp_f32 v200, v200
    v_exp_f32 v201, v201
    v_smfmac_f32_32x32x32_bf16 v[224:239], v[96:99], v[192:199], v10
    s_waitcnt lgkmcnt(0)
    buffer_load_dwordx4 v[140:143], v2, s[4:7], s67 offen offset:3072 sc1
    v_exp_f32 v202, v202
    v_exp_f32 v203, v203
    v_exp_f32 v204, v204
    v_exp_f32 v205, v205
    v_exp_f32 v206, v206
    v_exp_f32 v207, v207
    v_exp_f32 v176, v176
    v_exp_f32 v177, v177
    v_smfmac_f32_32x32x32_bf16 v[224:239], v[100:103], v[200:207], v10
    ds_read_b128 v[88:91], v1 offset:20480
    v_exp_f32 v178, v178
    v_exp_f32 v179, v179
    v_exp_f32 v180, v180
    v_mfma_f32_32x32x16_bf16 v[192:207], v[92:95], v[244:247], 0
    v_add_u32 v11, v38, v11
    ds_read_b128 v[96:99], v11 offset:0
    v_exp_f32 v181, v181
    v_exp_f32 v182, v182
    v_exp_f32 v183, v183
    v_exp_f32 v184, v184
    v_exp_f32 v185, v185
    v_smfmac_f32_32x32x32_bf16 v[208:223], v[104:107], v[176:183], v10
    s_add_u32 m0, s76, 0x15000
    ds_read_b128 v[100:103], v11 offset:512
    v_exp_f32 v186, v186
    v_exp_f32 v187, v187
    v_exp_f32 v188, v188
    v_exp_f32 v189, v189
    v_exp_f32 v190, v190
    v_exp_f32 v191, v191
    v_exp_f32 v192, v192
    v_exp_f32 v193, v193
    v_smfmac_f32_32x32x32_bf16 v[208:223], v[108:111], v[184:191], v10
    s_waitcnt lgkmcnt(2)
    buffer_load_dwordx4 v1, s[12:15], m0 offen sc1 lds
    s_add_u32 s67, s88, 4096
    v_exp_f32 v194, v194
    v_exp_f32 v195, v195
    v_exp_f32 v196, v196
    v_mfma_f32_32x32x16_bf16 v[176:191], v[88:91], v[240:243], 0
    buffer_load_dwordx4 v[148:151], v2, s[4:7], s67 offen sc1
    v_exp_f32 v197, v197
    v_exp_f32 v198, v198
    v_exp_f32 v199, v199
    v_exp_f32 v200, v200
    v_exp_f32 v201, v201
    v_smfmac_f32_32x32x32_bf16 v[224:239], v[104:107], v[192:199], v10
    s_waitcnt lgkmcnt(0)
    buffer_load_dwordx4 v[156:159], v2, s[4:7], s67 offen offset:1024 sc1
    v_exp_f32 v202, v202
    v_exp_f32 v203, v203
    v_exp_f32 v204, v204
    v_exp_f32 v205, v205
    v_exp_f32 v206, v206
    v_exp_f32 v207, v207
    v_exp_f32 v176, v176
    v_exp_f32 v177, v177
    v_smfmac_f32_32x32x32_bf16 v[224:239], v[108:111], v[200:207], v10
    ds_read_b128 v[92:95], v1 offset:21504
    v_exp_f32 v178, v178
    v_exp_f32 v179, v179
    v_exp_f32 v180, v180
    v_mfma_f32_32x32x16_bf16 v[192:207], v[88:91], v[244:247], 0
    ds_read_b128 v[104:107], v11 offset:1024
    v_exp_f32 v181, v181
    v_exp_f32 v182, v182
    v_exp_f32 v183, v183
    v_exp_f32 v184, v184
    v_exp_f32 v185, v185
    v_smfmac_f32_32x32x32_bf16 v[208:223], v[96:99], v[176:183], v10
    s_add_u32 m0, s76, 0x1d000
    ds_read_b128 v[108:111], v11 offset:1536
    v_exp_f32 v186, v186
    v_exp_f32 v187, v187
    v_exp_f32 v188, v188
    v_exp_f32 v189, v189
    v_exp_f32 v190, v190
    v_exp_f32 v191, v191
    v_exp_f32 v192, v192
    v_exp_f32 v193, v193
    v_smfmac_f32_32x32x32_bf16 v[208:223], v[100:103], v[184:191], v10
    s_waitcnt lgkmcnt(2)
    buffer_load_dwordx4 v1, s[12:15], m0 offen sc1 lds
    v_exp_f32 v194, v194
    v_exp_f32 v195, v195
    v_exp_f32 v196, v196
    v_mfma_f32_32x32x16_bf16 v[176:191], v[92:95], v[240:243], 0
    buffer_load_dwordx4 v[164:167], v2, s[4:7], s67 offen offset:2048 sc1
    v_exp_f32 v197, v197
    v_exp_f32 v198, v198
    v_exp_f32 v199, v199
    v_exp_f32 v200, v200
    v_exp_f32 v201, v201
    v_smfmac_f32_32x32x32_bf16 v[224:239], v[96:99], v[192:199], v10
    s_waitcnt lgkmcnt(0)
    buffer_load_dwordx4 v[172:175], v2, s[4:7], s67 offen offset:3072 sc1
    v_exp_f32 v202, v202
    v_exp_f32 v203, v203
    v_exp_f32 v204, v204
    v_exp_f32 v205, v205
    v_exp_f32 v206, v206
    v_exp_f32 v207, v207
    v_exp_f32 v176, v176
    v_exp_f32 v177, v177
    v_smfmac_f32_32x32x32_bf16 v[224:239], v[100:103], v[200:207], v10
    ds_read_b128 v[88:91], v1 offset:22528
    v_exp_f32 v178, v178
    v_exp_f32 v179, v179
    v_exp_f32 v180, v180
    v_mfma_f32_32x32x16_bf16 v[192:207], v[92:95], v[244:247], 0
    ds_read_b128 v[96:99], v11 offset:2048
    v_exp_f32 v181, v181
    v_exp_f32 v182, v182
    v_exp_f32 v183, v183
    v_exp_f32 v184, v184
    v_exp_f32 v185, v185
    v_smfmac_f32_32x32x32_bf16 v[208:223], v[104:107], v[176:183], v10
    s_add_u32 m0, s76, 0x16000
    ds_read_b128 v[100:103], v11 offset:2560
    v_exp_f32 v186, v186
    v_exp_f32 v187, v187
    v_exp_f32 v188, v188
    v_exp_f32 v189, v189
    v_exp_f32 v190, v190
    v_exp_f32 v191, v191
    v_exp_f32 v192, v192
    v_exp_f32 v193, v193
    v_smfmac_f32_32x32x32_bf16 v[208:223], v[108:111], v[184:191], v10
    s_waitcnt lgkmcnt(2)
    buffer_load_dwordx4 v1, s[12:15], m0 offen sc1 lds
    v_exp_f32 v194, v194
    v_exp_f32 v195, v195
    v_exp_f32 v196, v196
    v_mfma_f32_32x32x16_bf16 v[176:191], v[88:91], v[240:243], 0
    s_add_u32 s67, s85, s81
    v_exp_f32 v197, v197
    v_exp_f32 v198, v198
    v_exp_f32 v199, v199
    v_exp_f32 v200, v200
    v_exp_f32 v201, v201
    v_smfmac_f32_32x32x32_bf16 v[224:239], v[104:107], v[192:199], v10
    s_waitcnt lgkmcnt(0)
    buffer_load_dwordx4 a[0:3], v1, s[4:7], s67 offen sc1
    v_exp_f32 v202, v202
    v_exp_f32 v203, v203
    v_exp_f32 v204, v204
    v_exp_f32 v205, v205
    v_exp_f32 v206, v206
    v_exp_f32 v207, v207
    v_exp_f32 v176, v176
    v_exp_f32 v177, v177
    v_smfmac_f32_32x32x32_bf16 v[224:239], v[108:111], v[200:207], v10
    ds_read_b128 v[92:95], v1 offset:23552
    v_exp_f32 v178, v178
    v_exp_f32 v179, v179
    v_exp_f32 v180, v180
    v_mfma_f32_32x32x16_bf16 v[192:207], v[88:91], v[244:247], 0
    ds_read_b128 v[104:107], v11 offset:3072
    v_exp_f32 v181, v181
    v_exp_f32 v182, v182
    v_exp_f32 v183, v183
    v_exp_f32 v184, v184
    v_exp_f32 v185, v185
    v_smfmac_f32_32x32x32_bf16 v[208:223], v[96:99], v[176:183], v10
    s_add_u32 m0, s76, 0x1e000
    ds_read_b128 v[108:111], v11 offset:3584
    v_exp_f32 v186, v186
    v_exp_f32 v187, v187
    v_exp_f32 v188, v188
    v_exp_f32 v189, v189
    v_exp_f32 v190, v190
    v_exp_f32 v191, v191
    v_exp_f32 v192, v192
    v_exp_f32 v193, v193
    v_smfmac_f32_32x32x32_bf16 v[208:223], v[100:103], v[184:191], v10
    s_waitcnt lgkmcnt(2)
    buffer_load_dwordx4 v1, s[12:15], m0 offen sc1 lds
    v_exp_f32 v194, v194
    v_exp_f32 v195, v195
    v_exp_f32 v196, v196
    v_mfma_f32_32x32x16_bf16 v[176:191], v[92:95], v[240:243], 0
    buffer_load_dwordx4 a[8:11], v1, s[4:7], s67 offen offset:1024 sc1
    v_exp_f32 v197, v197
    v_exp_f32 v198, v198
    v_exp_f32 v199, v199
    v_exp_f32 v200, v200
    v_exp_f32 v201, v201
    v_smfmac_f32_32x32x32_bf16 v[224:239], v[96:99], v[192:199], v10
    s_waitcnt lgkmcnt(0)
    buffer_load_dwordx4 a[16:19], v1, s[4:7], s67 offen offset:2048 sc1
    v_exp_f32 v202, v202
    v_exp_f32 v203, v203
    v_exp_f32 v204, v204
    v_exp_f32 v205, v205
    v_exp_f32 v206, v206
    v_exp_f32 v207, v207
    v_exp_f32 v176, v176
    v_exp_f32 v177, v177
    v_smfmac_f32_32x32x32_bf16 v[224:239], v[100:103], v[200:207], v10
    ds_read_b128 v[88:91], v1 offset:24576
    v_exp_f32 v178, v178
    v_exp_f32 v179, v179
    v_exp_f32 v180, v180
    v_mfma_f32_32x32x16_bf16 v[192:207], v[92:95], v[244:247], 0
    v_add_u32 v11, v38, v11
    ds_read_b128 v[96:99], v11 offset:0
    v_exp_f32 v181, v181
    v_exp_f32 v182, v182
    v_exp_f32 v183, v183
    v_exp_f32 v184, v184
    v_exp_f32 v185, v185
    v_smfmac_f32_32x32x32_bf16 v[208:223], v[104:107], v[176:183], v10
    s_add_u32 m0, s76, 0x17000
    ds_read_b128 v[100:103], v11 offset:512
    v_exp_f32 v186, v186
    v_exp_f32 v187, v187
    v_exp_f32 v188, v188
    v_exp_f32 v189, v189
    v_exp_f32 v190, v190
    v_exp_f32 v191, v191
    v_exp_f32 v192, v192
    v_exp_f32 v193, v193
    v_smfmac_f32_32x32x32_bf16 v[208:223], v[108:111], v[184:191], v10
    s_waitcnt lgkmcnt(2)
    buffer_load_dwordx4 v1, s[12:15], m0 offen sc1 lds
    v_exp_f32 v194, v194
    v_exp_f32 v195, v195
    v_exp_f32 v196, v196
    v_mfma_f32_32x32x16_bf16 v[176:191], v[88:91], v[240:243], 0
    buffer_load_dwordx4 a[24:27], v1, s[4:7], s67 offen offset:3072 sc1
    s_add_u32 s67, s67, 4096
    v_exp_f32 v197, v197
    v_exp_f32 v198, v198
    v_exp_f32 v199, v199
    v_exp_f32 v200, v200
    v_exp_f32 v201, v201
    v_smfmac_f32_32x32x32_bf16 v[224:239], v[104:107], v[192:199], v10
    s_waitcnt lgkmcnt(0)
    buffer_load_dwordx4 a[32:35], v1, s[4:7], s67 offen sc1
    v_exp_f32 v202, v202
    v_exp_f32 v203, v203
    v_exp_f32 v204, v204
    v_exp_f32 v205, v205
    v_exp_f32 v206, v206
    v_exp_f32 v207, v207
    v_exp_f32 v176, v176
    v_exp_f32 v177, v177
    v_smfmac_f32_32x32x32_bf16 v[224:239], v[108:111], v[200:207], v10
    ds_read_b128 v[92:95], v1 offset:25600
    v_exp_f32 v178, v178
    v_exp_f32 v179, v179
    v_exp_f32 v180, v180
    v_mfma_f32_32x32x16_bf16 v[192:207], v[88:91], v[244:247], 0
    ds_read_b128 v[104:107], v11 offset:1024
    v_exp_f32 v181, v181
    v_exp_f32 v182, v182
    v_exp_f32 v183, v183
    v_exp_f32 v184, v184
    v_exp_f32 v185, v185
    v_smfmac_f32_32x32x32_bf16 v[208:223], v[96:99], v[176:183], v10
    s_add_u32 m0, s76, 0x1f000
    ds_read_b128 v[108:111], v11 offset:1536
    v_exp_f32 v186, v186
    v_exp_f32 v187, v187
    v_exp_f32 v188, v188
    v_exp_f32 v189, v189
    v_exp_f32 v190, v190
    v_exp_f32 v191, v191
    v_exp_f32 v192, v192
    v_exp_f32 v193, v193
    v_smfmac_f32_32x32x32_bf16 v[208:223], v[100:103], v[184:191], v10
    s_waitcnt lgkmcnt(2)
    buffer_load_dwordx4 v1, s[12:15], m0 offen sc1 lds
    v_exp_f32 v194, v194
    v_exp_f32 v195, v195
    v_exp_f32 v196, v196
    v_mfma_f32_32x32x16_bf16 v[176:191], v[92:95], v[240:243], 0
    buffer_load_dwordx4 a[40:43], v1, s[4:7], s67 offen offset:1024 sc1
    v_exp_f32 v197, v197
    v_exp_f32 v198, v198
    v_exp_f32 v199, v199
    v_exp_f32 v200, v200
    v_exp_f32 v201, v201
    v_smfmac_f32_32x32x32_bf16 v[224:239], v[96:99], v[192:199], v10
    s_waitcnt lgkmcnt(0)
    buffer_load_dwordx4 a[48:51], v1, s[4:7], s67 offen offset:2048 sc1
    v_exp_f32 v202, v202
    v_exp_f32 v203, v203
    v_exp_f32 v204, v204
    v_exp_f32 v205, v205
    v_exp_f32 v206, v206
    v_exp_f32 v207, v207
    v_exp_f32 v176, v176
    v_exp_f32 v177, v177
    v_smfmac_f32_32x32x32_bf16 v[224:239], v[100:103], v[200:207], v10
    ds_read_b128 v[88:91], v1 offset:26624
    v_exp_f32 v178, v178
    v_exp_f32 v179, v179
    v_exp_f32 v180, v180
    v_mfma_f32_32x32x16_bf16 v[192:207], v[92:95], v[244:247], 0
    ds_read_b128 v[96:99], v11 offset:2048
    v_exp_f32 v181, v181
    v_exp_f32 v182, v182
    v_exp_f32 v183, v183
    v_exp_f32 v184, v184
    v_exp_f32 v185, v185
    v_smfmac_f32_32x32x32_bf16 v[208:223], v[104:107], v[176:183], v10
    ds_read_b128 v[100:103], v11 offset:2560
    v_exp_f32 v186, v186
    v_exp_f32 v187, v187
    v_exp_f32 v188, v188
    v_exp_f32 v189, v189
    v_exp_f32 v190, v190
    v_exp_f32 v191, v191
    v_exp_f32 v192, v192
    v_exp_f32 v193, v193
    v_smfmac_f32_32x32x32_bf16 v[208:223], v[108:111], v[184:191], v10
    s_waitcnt lgkmcnt(2)
    buffer_load_dwordx4 a[56:59], v1, s[4:7], s67 offen offset:3072 sc1
    v_exp_f32 v194, v194
    v_exp_f32 v195, v195
    v_exp_f32 v196, v196
    v_mfma_f32_32x32x16_bf16 v[176:191], v[88:91], v[240:243], 0
    s_add_u32 s67, s85, s82
    v_exp_f32 v197, v197
    v_exp_f32 v198, v198
    v_exp_f32 v199, v199
    v_exp_f32 v200, v200
    v_exp_f32 v201, v201
    v_smfmac_f32_32x32x32_bf16 v[224:239], v[104:107], v[192:199], v10
    s_waitcnt lgkmcnt(0)
    buffer_load_dwordx4 a[64:67], v1, s[4:7], s67 offen sc1
    v_exp_f32 v202, v202
    v_exp_f32 v203, v203
    v_exp_f32 v204, v204
    v_exp_f32 v205, v205
    v_exp_f32 v206, v206
    v_exp_f32 v207, v207
    v_exp_f32 v176, v176
    v_exp_f32 v177, v177
    v_smfmac_f32_32x32x32_bf16 v[224:239], v[108:111], v[200:207], v10
    ds_read_b128 v[92:95], v1 offset:27648
    v_exp_f32 v178, v178
    v_exp_f32 v179, v179
    v_exp_f32 v180, v180
    v_mfma_f32_32x32x16_bf16 v[192:207], v[88:91], v[244:247], 0
    ds_read_b128 v[104:107], v11 offset:3072
    v_exp_f32 v181, v181
    v_exp_f32 v182, v182
    v_exp_f32 v183, v183
    v_exp_f32 v184, v184
    v_exp_f32 v185, v185
    v_smfmac_f32_32x32x32_bf16 v[208:223], v[96:99], v[176:183], v10
    ds_read_b128 v[108:111], v11 offset:3584
    v_exp_f32 v186, v186
    v_exp_f32 v187, v187
    v_exp_f32 v188, v188
    v_exp_f32 v189, v189
    v_exp_f32 v190, v190
    v_exp_f32 v191, v191
    v_exp_f32 v192, v192
    v_exp_f32 v193, v193
    v_smfmac_f32_32x32x32_bf16 v[208:223], v[100:103], v[184:191], v10
    s_waitcnt lgkmcnt(2)
    buffer_load_dwordx4 a[72:75], v1, s[4:7], s67 offen offset:1024 sc1
    v_exp_f32 v194, v194
    v_exp_f32 v195, v195
    v_exp_f32 v196, v196
    v_mfma_f32_32x32x16_bf16 v[176:191], v[92:95], v[240:243], 0
    buffer_load_dwordx4 a[80:83], v1, s[4:7], s67 offen offset:2048 sc1
    v_exp_f32 v197, v197
    v_exp_f32 v198, v198
    v_exp_f32 v199, v199
    v_exp_f32 v200, v200
    v_exp_f32 v201, v201
    v_smfmac_f32_32x32x32_bf16 v[224:239], v[96:99], v[192:199], v10
    s_waitcnt lgkmcnt(0)
    buffer_load_dwordx4 a[88:91], v1, s[4:7], s67 offen offset:3072 sc1
    v_exp_f32 v202, v202
    v_exp_f32 v203, v203
    v_exp_f32 v204, v204
    v_exp_f32 v205, v205
    v_exp_f32 v206, v206
    v_exp_f32 v207, v207
    v_exp_f32 v176, v176
    v_exp_f32 v177, v177
    v_smfmac_f32_32x32x32_bf16 v[224:239], v[100:103], v[200:207], v10
    ds_read_b128 v[88:91], v1 offset:28672
    v_exp_f32 v178, v178
    v_exp_f32 v179, v179
    v_exp_f32 v180, v180
    v_mfma_f32_32x32x16_bf16 v[192:207], v[92:95], v[244:247], 0
    v_add_u32 v11, v38, v11
    ds_read_b128 v[96:99], v11 offset:0
    v_exp_f32 v181, v181
    v_exp_f32 v182, v182
    v_exp_f32 v183, v183
    v_exp_f32 v184, v184
    v_exp_f32 v185, v185
    v_smfmac_f32_32x32x32_bf16 v[208:223], v[104:107], v[176:183], v10
    s_add_u32 s67, s67, 4096
    ds_read_b128 v[100:103], v11 offset:512
    v_exp_f32 v186, v186
    v_exp_f32 v187, v187
    v_exp_f32 v188, v188
    v_exp_f32 v189, v189
    v_exp_f32 v190, v190
    v_exp_f32 v191, v191
    v_exp_f32 v192, v192
    v_exp_f32 v193, v193
    v_smfmac_f32_32x32x32_bf16 v[208:223], v[108:111], v[184:191], v10
    s_waitcnt lgkmcnt(2)
    buffer_load_dwordx4 a[96:99], v1, s[4:7], s67 offen sc1
    v_exp_f32 v194, v194
    v_exp_f32 v195, v195
    v_exp_f32 v196, v196
    v_mfma_f32_32x32x16_bf16 v[176:191], v[88:91], v[240:243], 0
    buffer_load_dwordx4 a[104:107], v1, s[4:7], s67 offen offset:1024 sc1
    v_exp_f32 v197, v197
    v_exp_f32 v198, v198
    v_exp_f32 v199, v199
    v_exp_f32 v200, v200
    v_exp_f32 v201, v201
    v_smfmac_f32_32x32x32_bf16 v[224:239], v[104:107], v[192:199], v10
    s_waitcnt lgkmcnt(0)
    buffer_load_dwordx4 a[112:115], v1, s[4:7], s67 offen offset:2048 sc1
    v_exp_f32 v202, v202
    v_exp_f32 v203, v203
    v_exp_f32 v204, v204
    v_exp_f32 v205, v205
    v_exp_f32 v206, v206
    v_exp_f32 v207, v207
    v_exp_f32 v176, v176
    v_exp_f32 v177, v177
    v_smfmac_f32_32x32x32_bf16 v[224:239], v[108:111], v[200:207], v10
    ds_read_b128 v[92:95], v1 offset:29696
    v_exp_f32 v178, v178
    v_exp_f32 v179, v179
    v_exp_f32 v180, v180
    v_mfma_f32_32x32x16_bf16 v[192:207], v[88:91], v[244:247], 0
    ds_read_b128 v[104:107], v11 offset:1024
    v_exp_f32 v181, v181
    v_exp_f32 v182, v182
    v_exp_f32 v183, v183
    v_exp_f32 v184, v184
    v_exp_f32 v185, v185
    v_smfmac_f32_32x32x32_bf16 v[208:223], v[96:99], v[176:183], v10
    ds_read_b128 v[108:111], v11 offset:1536
    v_exp_f32 v186, v186
    v_exp_f32 v187, v187
    v_exp_f32 v188, v188
    v_exp_f32 v189, v189
    v_exp_f32 v190, v190
    v_exp_f32 v191, v191
    v_exp_f32 v192, v192
    v_exp_f32 v193, v193
    v_smfmac_f32_32x32x32_bf16 v[208:223], v[100:103], v[184:191], v10
    s_waitcnt lgkmcnt(2)
    buffer_load_dwordx4 a[120:123], v1, s[4:7], s67 offen offset:3072 sc1
    v_exp_f32 v194, v194
    v_exp_f32 v195, v195
    v_exp_f32 v196, v196
    v_mfma_f32_32x32x16_bf16 v[176:191], v[92:95], v[240:243], 0
    s_add_u32 s67, s85, s83
    v_exp_f32 v197, v197
    v_exp_f32 v198, v198
    v_exp_f32 v199, v199
    v_exp_f32 v200, v200
    v_exp_f32 v201, v201
    v_smfmac_f32_32x32x32_bf16 v[224:239], v[96:99], v[192:199], v10
    s_waitcnt lgkmcnt(0)
    buffer_load_dwordx4 a[128:131], v1, s[4:7], s67 offen sc1
    v_exp_f32 v202, v202
    v_exp_f32 v203, v203
    v_exp_f32 v204, v204
    v_exp_f32 v205, v205
    v_exp_f32 v206, v206
    v_exp_f32 v207, v207
    v_exp_f32 v176, v176
    v_exp_f32 v177, v177
    v_smfmac_f32_32x32x32_bf16 v[224:239], v[100:103], v[200:207], v10
    ds_read_b128 v[88:91], v1 offset:30720
    v_exp_f32 v178, v178
    v_exp_f32 v179, v179
    v_exp_f32 v180, v180
    v_mfma_f32_32x32x16_bf16 v[192:207], v[92:95], v[244:247], 0
    ds_read_b128 v[96:99], v11 offset:2048
    v_exp_f32 v181, v181
    v_exp_f32 v182, v182
    v_exp_f32 v183, v183
    v_exp_f32 v184, v184
    v_exp_f32 v185, v185
    v_smfmac_f32_32x32x32_bf16 v[208:223], v[104:107], v[176:183], v10
    ds_read_b128 v[100:103], v11 offset:2560
    v_exp_f32 v186, v186
    v_exp_f32 v187, v187
    v_exp_f32 v188, v188
    v_exp_f32 v189, v189
    v_exp_f32 v190, v190
    v_exp_f32 v191, v191
    v_exp_f32 v192, v192
    v_exp_f32 v193, v193
    v_smfmac_f32_32x32x32_bf16 v[208:223], v[108:111], v[184:191], v10
    s_waitcnt lgkmcnt(2)
    buffer_load_dwordx4 a[136:139], v1, s[4:7], s67 offen offset:1024 sc1
    v_exp_f32 v194, v194
    v_exp_f32 v195, v195
    v_exp_f32 v196, v196
    v_mfma_f32_32x32x16_bf16 v[176:191], v[88:91], v[240:243], 0
    buffer_load_dwordx4 a[144:147], v1, s[4:7], s67 offen offset:2048 sc1
    v_exp_f32 v197, v197
    v_exp_f32 v198, v198
    v_exp_f32 v199, v199
    v_exp_f32 v200, v200
    v_exp_f32 v201, v201
    v_smfmac_f32_32x32x32_bf16 v[224:239], v[104:107], v[192:199], v10
    s_waitcnt lgkmcnt(0)
    buffer_load_dwordx4 a[152:155], v1, s[4:7], s67 offen offset:3072 sc1
    v_exp_f32 v202, v202
    v_exp_f32 v203, v203
    v_exp_f32 v204, v204
    v_exp_f32 v205, v205
    v_exp_f32 v206, v206
    v_exp_f32 v207, v207
    v_exp_f32 v176, v176
    v_exp_f32 v177, v177
    v_smfmac_f32_32x32x32_bf16 v[224:239], v[108:111], v[200:207], v10
    ds_read_b128 v[92:95], v1 offset:31744
    v_exp_f32 v178, v178
    v_exp_f32 v179, v179
    v_exp_f32 v180, v180
    v_mfma_f32_32x32x16_bf16 v[192:207], v[88:91], v[244:247], 0
    ds_read_b128 v[104:107], v11 offset:3072
    v_exp_f32 v181, v181
    v_exp_f32 v182, v182
    v_exp_f32 v183, v183
    v_exp_f32 v184, v184
    v_exp_f32 v185, v185
    v_smfmac_f32_32x32x32_bf16 v[208:223], v[96:99], v[176:183], v10
    s_lshl_b32 s63, s57, 2
    s_add_u32 s63, s63, s74
    ds_read_b128 v[108:111], v11 offset:3584
    v_exp_f32 v186, v186
    v_exp_f32 v187, v187
    v_exp_f32 v188, v188
    v_exp_f32 v189, v189
    v_exp_f32 v190, v190
    v_exp_f32 v191, v191
    v_exp_f32 v192, v192
    v_exp_f32 v193, v193
    v_smfmac_f32_32x32x32_bf16 v[208:223], v[100:103], v[184:191], v10
    s_waitcnt lgkmcnt(2)
    buffer_load_dword v44, v1, s[8:11], s63 offen sc1
    s_add_u32 s67, s67, 4096
    v_exp_f32 v194, v194
    v_exp_f32 v195, v195
    v_exp_f32 v196, v196
    v_mfma_f32_32x32x16_bf16 v[176:191], v[92:95], v[240:243], 0
    buffer_load_dwordx4 a[160:163], v1, s[4:7], s67 offen sc1
    v_exp_f32 v197, v197
    v_exp_f32 v198, v198
    v_exp_f32 v199, v199
    v_exp_f32 v200, v200
    v_exp_f32 v201, v201
    v_smfmac_f32_32x32x32_bf16 v[224:239], v[96:99], v[192:199], v10
    s_waitcnt lgkmcnt(0)
    s_waitcnt vmcnt(17)
    s_barrier
    s_or_b32 s64, s57, s56
    s_or_b32 s64, s64, s2
    s_cmp_eq_u32 s64, 0
    s_cbranch_scc0 L_sk_18
    s_mov_b64 exec, 1
    buffer_store_dwordx2 v[4:5], v3, s[4:7], 0 offen sc1
    s_mov_b64 exec, -1
L_sk_18:
    buffer_load_dwordx4 a[168:171], v1, s[4:7], s67 offen offset:1024 sc1
    v_exp_f32 v202, v202
    v_exp_f32 v203, v203
    v_exp_f32 v204, v204
    v_exp_f32 v205, v205
    v_exp_f32 v206, v206
    v_exp_f32 v207, v207
    v_exp_f32 v176, v176
    v_exp_f32 v177, v177
    v_smfmac_f32_32x32x32_bf16 v[224:239], v[100:103], v[200:207], v10
    ds_read_b128 v[88:91], v39 offset:0
    v_exp_f32 v178, v178
    v_exp_f32 v179, v179
    v_exp_f32 v180, v180
    v_mfma_f32_32x32x16_bf16 v[192:207], v[92:95], v[244:247], 0
    v_mad_i32_i24 v11, v38, 9, v11
    ds_read_b128 v[96:99], v11 offset:0
    v_exp_f32 v181, v181
    v_exp_f32 v182, v182
    v_exp_f32 v183, v183
    v_exp_f32 v184, v184
    v_exp_f32 v185, v185
    v_smfmac_f32_32x32x32_bf16 v[208:223], v[104:107], v[176:183], v10
    ds_read_b128 v[100:103], v11 offset:512
    v_exp_f32 v186, v186
    v_exp_f32 v187, v187
    v_exp_f32 v188, v188
    v_exp_f32 v189, v189
    v_exp_f32 v190, v190
    v_exp_f32 v191, v191
    v_exp_f32 v192, v192
    v_exp_f32 v193, v193
    v_smfmac_f32_32x32x32_bf16 v[208:223], v[108:111], v[184:191], v10
    s_waitcnt lgkmcnt(2)
    buffer_load_dwordx4 a[176:179], v1, s[4:7], s67 offen offset:2048 sc1
    v_exp_f32 v194, v194
    v_exp_f32 v195, v195
    v_exp_f32 v196, v196
    v_mfma_f32_32x32x16_bf16 v[176:191], v[88:91], v[240:243], 0
    v_exp_f32 v197, v197
    v_exp_f32 v198, v198
    v_exp_f32 v199, v199
    v_exp_f32 v200, v200
    v_exp_f32 v201, v201
    v_smfmac_f32_32x32x32_bf16 v[224:239], v[104:107], v[192:199], v10
    s_waitcnt lgkmcnt(0)
    buffer_load_dwordx4 a[184:187], v1, s[4:7], s67 offen offset:3072 sc1
    v_exp_f32 v202, v202
    v_exp_f32 v203, v203
    v_exp_f32 v204, v204
    v_exp_f32 v205, v205
    v_exp_f32 v206, v206
    v_exp_f32 v207, v207
    v_exp_f32 v176, v176
    v_exp_f32 v177, v177
    v_smfmac_f32_32x32x32_bf16 v[224:239], v[108:111], v[200:207], v10
    ds_read_b128 v[92:95], v39 offset:1024
    v_exp_f32 v178, v178
    v_exp_f32 v179, v179
    v_exp_f32 v180, v180
    v_mfma_f32_32x32x16_bf16 v[192:207], v[88:91], v[244:247], 0
    ds_read_b128 v[104:107], v11 offset:1024
    v_exp_f32 v181, v181
    v_exp_f32 v182, v182
    v_exp_f32 v183, v183
    v_exp_f32 v184, v184
    v_exp_f32 v185, v185
    v_smfmac_f32_32x32x32_bf16 v[208:223], v[96:99], v[176:183], v10
    s_add_u32 s67, s85, s84
    ds_read_b128 v[108:111], v11 offset:1536
    v_exp_f32 v186, v186
    v_exp_f32 v187, v187
    v_exp_f32 v188, v188
    v_exp_f32 v189, v189
    v_exp_f32 v190, v190
    v_exp_f32 v191, v191
    v_exp_f32 v192, v192
    v_exp_f32 v193, v193
    v_smfmac_f32_32x32x32_bf16 v[208:223], v[100:103], v[184:191], v10
    s_waitcnt lgkmcnt(2)
    buffer_load_dwordx4 a[192:195], v1, s[4:7], s67 offen sc1
    s_add_u32 s62, s63, 0x38000
    v_exp_f32 v194, v194
    v_exp_f32 v195, v195
    v_exp_f32 v196, v196
    v_mfma_f32_32x32x16_bf16 v[176:191], v[92:95], v[240:243], 0
    buffer_load_dword v44, v1, s[8:11], s62 offen sc1
    v_exp_f32 v197, v197
    v_exp_f32 v198, v198
    v_exp_f32 v199, v199
    v_exp_f32 v200, v200
    v_exp_f32 v201, v201
    v_smfmac_f32_32x32x32_bf16 v[224:239], v[96:99], v[192:199], v10
    s_waitcnt lgkmcnt(0)
    buffer_load_dwordx4 a[200:203], v1, s[4:7], s67 offen offset:1024 sc1
    v_exp_f32 v202, v202
    v_exp_f32 v203, v203
    v_exp_f32 v204, v204
    v_exp_f32 v205, v205
    v_exp_f32 v206, v206
    v_exp_f32 v207, v207
    v_exp_f32 v176, v176
    v_exp_f32 v177, v177
    v_smfmac_f32_32x32x32_bf16 v[224:239], v[100:103], v[200:207], v10
    ds_read_b128 v[88:91], v39 offset:2048
    v_exp_f32 v178, v178
    v_exp_f32 v179, v179
    v_exp_f32 v180, v180
    v_mfma_f32_32x32x16_bf16 v[192:207], v[92:95], v[244:247], 0
    ds_read_b128 v[96:99], v11 offset:2048
    v_exp_f32 v181, v181
    v_exp_f32 v182, v182
    v_exp_f32 v183, v183
    v_exp_f32 v184, v184
    v_exp_f32 v185, v185
    v_smfmac_f32_32x32x32_bf16 v[208:223], v[104:107], v[176:183], v10
    s_andn2_b32 s65, s79, 0x1180
    ds_read_b128 v[100:103], v11 offset:2560
    v_exp_f32 v186, v186
    v_exp_f32 v187, v187
    v_exp_f32 v188, v188
    v_exp_f32 v189, v189
    v_exp_f32 v190, v190
    v_exp_f32 v191, v191
    v_exp_f32 v192, v192
    v_exp_f32 v193, v193
    v_smfmac_f32_32x32x32_bf16 v[208:223], v[108:111], v[184:191], v10
    s_waitcnt lgkmcnt(2)
    buffer_load_dword v67, v65, s[4:7], s65 offen sc1
    v_exp_f32 v194, v194
    v_exp_f32 v195, v195
    v_exp_f32 v196, v196
    v_mfma_f32_32x32x16_bf16 v[176:191], v[88:91], v[240:243], 0
    buffer_load_dwordx4 a[208:211], v1, s[4:7], s67 offen offset:2048 sc1
    v_exp_f32 v197, v197
    v_exp_f32 v198, v198
    v_exp_f32 v199, v199
    v_exp_f32 v200, v200
    v_exp_f32 v201, v201
    v_smfmac_f32_32x32x32_bf16 v[224:239], v[104:107], v[192:199], v10
    s_waitcnt lgkmcnt(0)
    buffer_load_dwordx4 a[216:219], v1, s[4:7], s67 offen offset:3072 sc1
    v_exp_f32 v202, v202
    v_exp_f32 v203, v203
    v_exp_f32 v204, v204
    v_exp_f32 v205, v205
    v_exp_f32 v206, v206
    v_exp_f32 v207, v207
    v_exp_f32 v176, v176
    v_exp_f32 v177, v177
    v_smfmac_f32_32x32x32_bf16 v[224:239], v[108:111], v[200:207], v10
    ds_read_b128 v[92:95], v39 offset:3072
    v_exp_f32 v178, v178
    v_exp_f32 v179, v179
    v_exp_f32 v180, v180
    v_mfma_f32_32x32x16_bf16 v[192:207], v[88:91], v[244:247], 0
    ds_read_b128 v[104:107], v11 offset:3072
    v_exp_f32 v181, v181
    v_exp_f32 v182, v182
    v_exp_f32 v183, v183
    v_exp_f32 v184, v184
    v_exp_f32 v185, v185
    v_smfmac_f32_32x32x32_bf16 v[208:223], v[96:99], v[176:183], v10
    s_add_u32 s67, s67, 4096
    ds_read_b128 v[108:111], v11 offset:3584
    v_exp_f32 v186, v186
    v_exp_f32 v187, v187
    v_exp_f32 v188, v188
    v_exp_f32 v189, v189
    v_exp_f32 v190, v190
    v_exp_f32 v191, v191
    v_exp_f32 v192, v192
    v_exp_f32 v193, v193
    v_smfmac_f32_32x32x32_bf16 v[208:223], v[100:103], v[184:191], v10
    s_waitcnt lgkmcnt(2)
    buffer_load_dwordx4 a[224:227], v1, s[4:7], s67 offen sc1
    v_exp_f32 v194, v194
    v_exp_f32 v195, v195
    v_exp_f32 v196, v196
    v_mfma_f32_32x32x16_bf16 v[176:191], v[92:95], v[240:243], 0
    v_exp_f32 v197, v197
    v_exp_f32 v198, v198
    v_exp_f32 v199, v199
    v_exp_f32 v200, v200
    v_exp_f32 v201, v201
    v_smfmac_f32_32x32x32_bf16 v[224:239], v[96:99], v[192:199], v10
    s_waitcnt lgkmcnt(0)
    buffer_load_dwordx4 a[232:235], v1, s[4:7], s67 offen offset:1024 sc1
    v_exp_f32 v202, v202
    v_exp_f32 v203, v203
    v_exp_f32 v204, v204
    v_exp_f32 v205, v205
    v_exp_f32 v206, v206
    v_exp_f32 v207, v207
    v_exp_f32 v176, v176
    v_exp_f32 v177, v177
    v_smfmac_f32_32x32x32_bf16 v[224:239], v[100:103], v[200:207], v10
    ds_read_b128 v[88:91], v39 offset:4096
    v_exp_f32 v178, v178
    v_exp_f32 v179, v179
    v_exp_f32 v180, v180
    v_mfma_f32_32x32x16_bf16 v[192:207], v[92:95], v[244:247], 0
    v_add_u32 v11, v38, v11
    ds_read_b128 v[96:99], v11 offset:0
    v_exp_f32 v181, v181
    v_exp_f32 v182, v182
    v_exp_f32 v183, v183
    v_exp_f32 v184, v184
    v_exp_f32 v185, v185
    v_smfmac_f32_32x32x32_bf16 v[208:223], v[104:107], v[176:183], v10
    s_add_u32 s62, s63, 0x40000
    ds_read_b128 v[100:103], v11 offset:512
    v_exp_f32 v186, v186
    v_exp_f32 v187, v187
    v_exp_f32 v188, v188
    v_exp_f32 v189, v189
    v_exp_f32 v190, v190
    v_exp_f32 v191, v191
    v_exp_f32 v192, v192
    v_exp_f32 v193, v193
    v_smfmac_f32_32x32x32_bf16 v[208:223], v[108:111], v[184:191], v10
    s_waitcnt lgkmcnt(2)
    buffer_load_dword v44, v1, s[8:11], s62 offen sc1
    v_exp_f32 v194, v194
    v_exp_f32 v195, v195
    v_exp_f32 v196, v196
    v_mfma_f32_32x32x16_bf16 v[176:191], v[88:91], v[240:243], 0
    buffer_load_dwordx4 a[240:243], v1, s[4:7], s67 offen offset:2048 sc1
    v_exp_f32 v197, v197
    v_exp_f32 v198, v198
    v_exp_f32 v199, v199
    v_exp_f32 v200, v200
    v_exp_f32 v201, v201
    v_smfmac_f32_32x32x32_bf16 v[224:239], v[104:107], v[192:199], v10
    s_waitcnt lgkmcnt(0)
    buffer_load_dwordx4 a[248:251], v1, s[4:7], s67 offen offset:3072 sc1
    v_exp_f32 v202, v202
    v_exp_f32 v203, v203
    v_exp_f32 v204, v204
    v_exp_f32 v205, v205
    v_exp_f32 v206, v206
    v_exp_f32 v207, v207
    v_exp_f32 v176, v176
    v_exp_f32 v177, v177
    v_smfmac_f32_32x32x32_bf16 v[224:239], v[108:111], v[200:207], v10
    ds_read_b128 v[92:95], v39 offset:5120
    v_exp_f32 v178, v178
    v_exp_f32 v179, v179
    v_exp_f32 v180, v180
    v_mfma_f32_32x32x16_bf16 v[192:207], v[88:91], v[244:247], 0
    ds_read_b128 v[104:107], v11 offset:1024
    v_exp_f32 v181, v181
    v_exp_f32 v182, v182
    v_exp_f32 v183, v183
    v_exp_f32 v184, v184
    v_exp_f32 v185, v185
    v_smfmac_f32_32x32x32_bf16 v[208:223], v[96:99], v[176:183], v10
    s_add_u32 s67, s85, 32768
    ds_read_b128 v[108:111], v11 offset:1536
    v_exp_f32 v186, v186
    v_exp_f32 v187, v187
    v_exp_f32 v188, v188
    v_exp_f32 v189, v189
    v_exp_f32 v190, v190
    v_exp_f32 v191, v191
    v_exp_f32 v192, v192
    v_exp_f32 v193, v193
    v_smfmac_f32_32x32x32_bf16 v[208:223], v[100:103], v[184:191], v10
    s_waitcnt lgkmcnt(2)
    buffer_load_dwordx4 v[28:31], v1, s[4:7], s67 offen sc1
    s_add_u32 s67, s86, s81
    v_exp_f32 v194, v194
    v_exp_f32 v195, v195
    v_exp_f32 v196, v196
    v_mfma_f32_32x32x16_bf16 v[176:191], v[92:95], v[240:243], 0
    buffer_load_dwordx4 a[4:7], v1, s[4:7], s67 offen sc1
    v_exp_f32 v197, v197
    v_exp_f32 v198, v198
    v_exp_f32 v199, v199
    v_exp_f32 v200, v200
    v_exp_f32 v201, v201
    v_smfmac_f32_32x32x32_bf16 v[224:239], v[96:99], v[192:199], v10
    s_waitcnt lgkmcnt(0)
    buffer_load_dwordx4 a[12:15], v1, s[4:7], s67 offen offset:1024 sc1
    v_exp_f32 v202, v202
    v_exp_f32 v203, v203
    v_exp_f32 v204, v204
    v_exp_f32 v205, v205
    v_exp_f32 v206, v206
    v_exp_f32 v207, v207
    v_exp_f32 v176, v176
    v_exp_f32 v177, v177
    v_smfmac_f32_32x32x32_bf16 v[224:239], v[100:103], v[200:207], v10
    ds_read_b128 v[88:91], v39 offset:6144
    v_exp_f32 v178, v178
    v_exp_f32 v179, v179
    v_exp_f32 v180, v180
    v_mfma_f32_32x32x16_bf16 v[192:207], v[92:95], v[244:247], 0
    ds_read_b128 v[96:99], v11 offset:2048
    v_exp_f32 v181, v181
    v_exp_f32 v182, v182
    v_exp_f32 v183, v183
    v_exp_f32 v184, v184
    v_exp_f32 v185, v185
    v_smfmac_f32_32x32x32_bf16 v[208:223], v[104:107], v[176:183], v10
    s_add_u32 s62, s63, 0x48000
    ds_read_b128 v[100:103], v11 offset:2560
    v_exp_f32 v186, v186
    v_exp_f32 v187, v187
    v_exp_f32 v188, v188
    v_exp_f32 v189, v189
    v_exp_f32 v190, v190
    v_exp_f32 v191, v191
    v_exp_f32 v192, v192
    v_exp_f32 v193, v193
    v_smfmac_f32_32x32x32_bf16 v[208:223], v[108:111], v[184:191], v10
    s_waitcnt lgkmcnt(2)
    buffer_load_dword v44, v1, s[8:11], s62 offen sc1
    v_exp_f32 v194, v194
    v_exp_f32 v195, v195
    v_exp_f32 v196, v196
    v_mfma_f32_32x32x16_bf16 v[176:191], v[88:91], v[240:243], 0
    v_exp_f32 v197, v197
    v_exp_f32 v198, v198
    v_exp_f32 v199, v199
    v_exp_f32 v200, v200
    v_exp_f32 v201, v201
    v_smfmac_f32_32x32x32_bf16 v[224:239], v[104:107], v[192:199], v10
    s_waitcnt lgkmcnt(0)
    buffer_load_dwordx4 a[20:23], v1, s[4:7], s67 offen offset:2048 sc1
    v_exp_f32 v202, v202
    v_exp_f32 v203, v203
    v_exp_f32 v204, v204
    v_exp_f32 v205, v205
    v_exp_f32 v206, v206
    v_exp_f32 v207, v207
    v_exp_f32 v176, v176
    v_exp_f32 v177, v177
    v_smfmac_f32_32x32x32_bf16 v[224:239], v[108:111], v[200:207], v10
    ds_read_b128 v[92:95], v39 offset:7168
    v_exp_f32 v178, v178
    v_exp_f32 v179, v179
    v_exp_f32 v180, v180
    v_mfma_f32_32x32x16_bf16 v[192:207], v[88:91], v[244:247], 0
    ds_read_b128 v[104:107], v11 offset:3072
    v_exp_f32 v181, v181
    v_exp_f32 v182, v182
    v_exp_f32 v183, v183
    v_exp_f32 v184, v184
    v_exp_f32 v185, v185
    v_smfmac_f32_32x32x32_bf16 v[208:223], v[96:99], v[176:183], v10
    ds_read_b128 v[108:111], v11 offset:3584
    v_exp_f32 v186, v186
    v_exp_f32 v187, v187
    v_exp_f32 v188, v188
    v_exp_f32 v189, v189
    v_exp_f32 v190, v190
    v_exp_f32 v191, v191
    v_exp_f32 v192, v192
    v_exp_f32 v193, v193
    v_smfmac_f32_32x32x32_bf16 v[208:223], v[100:103], v[184:191], v10
    s_waitcnt lgkmcnt(2)
    buffer_load_dwordx4 a[28:31], v1, s[4:7], s67 offen offset:3072 sc1
    s_add_u32 s67, s67, 4096
    v_exp_f32 v194, v194
    v_exp_f32 v195, v195
    v_exp_f32 v196, v196
    v_mfma_f32_32x32x16_bf16 v[176:191], v[92:95], v[240:243], 0
    buffer_load_dwordx4 a[36:39], v1, s[4:7], s67 offen sc1
    v_exp_f32 v197, v197
    v_exp_f32 v198, v198
    v_exp_f32 v199, v199
    v_exp_f32 v200, v200
    v_exp_f32 v201, v201
    v_smfmac_f32_32x32x32_bf16 v[224:239], v[96:99], v[192:199], v10
    s_waitcnt lgkmcnt(0)
    buffer_load_dwordx4 a[44:47], v1, s[4:7], s67 offen offset:1024 sc1
    v_exp_f32 v202, v202
    v_exp_f32 v203, v203
    v_exp_f32 v204, v204
    v_exp_f32 v205, v205
    v_exp_f32 v206, v206
    v_exp_f32 v207, v207
    v_exp_f32 v176, v176
    v_exp_f32 v177, v177
    v_smfmac_f32_32x32x32_bf16 v[224:239], v[100:103], v[200:207], v10
    ds_read_b128 v[88:91], v39 offset:8192
    v_exp_f32 v178, v178
    v_exp_f32 v179, v179
    v_exp_f32 v180, v180
    v_mfma_f32_32x32x16_bf16 v[192:207], v[92:95], v[244:247], 0
    v_add_u32 v11, v38, v11
    ds_read_b128 v[96:99], v11 offset:0
    v_exp_f32 v181, v181
    v_exp_f32 v182, v182
    v_exp_f32 v183, v183
    v_exp_f32 v184, v184
    v_exp_f32 v185, v185
    v_smfmac_f32_32x32x32_bf16 v[208:223], v[104:107], v[176:183], v10
    ds_read_b128 v[100:103], v11 offset:512
    v_exp_f32 v186, v186
    v_exp_f32 v187, v187
    v_exp_f32 v188, v188
    v_exp_f32 v189, v189
    v_exp_f32 v190, v190
    v_exp_f32 v191, v191
    v_exp_f32 v192, v192
    v_exp_f32 v193, v193
    v_smfmac_f32_32x32x32_bf16 v[208:223], v[108:111], v[184:191], v10
    s_waitcnt lgkmcnt(2)
    buffer_load_dwordx4 a[52:55], v1, s[4:7], s67 offen offset:2048 sc1
    s_add_u32 s62, s63, 0x10000
    v_exp_f32 v194, v194
    v_exp_f32 v195, v195
    v_exp_f32 v196, v196
    v_mfma_f32_32x32x16_bf16 v[176:191], v[88:91], v[240:243], 0
    buffer_load_dword v44, v1, s[8:11], s62 offen sc1
    v_exp_f32 v197, v197
    v_exp_f32 v198, v198
    v_exp_f32 v199, v199
    v_exp_f32 v200, v200
    v_exp_f32 v201, v201
    v_smfmac_f32_32x32x32_bf16 v[224:239], v[104:107], v[192:199], v10
    s_waitcnt lgkmcnt(0)
    buffer_load_dwordx4 a[60:63], v1, s[4:7], s67 offen offset:3072 sc1
    v_exp_f32 v202, v202
    v_exp_f32 v203, v203
    v_exp_f32 v204, v204
    v_exp_f32 v205, v205
    v_exp_f32 v206, v206
    v_exp_f32 v207, v207
    v_exp_f32 v176, v176
    v_exp_f32 v177, v177
    v_smfmac_f32_32x32x32_bf16 v[224:239], v[108:111], v[200:207], v10
    ds_read_b128 v[92:95], v39 offset:9216
    v_exp_f32 v178, v178
    v_exp_f32 v179, v179
    v_exp_f32 v180, v180
    v_mfma_f32_32x32x16_bf16 v[192:207], v[88:91], v[244:247], 0
    ds_read_b128 v[104:107], v11 offset:1024
    v_exp_f32 v181, v181
    v_exp_f32 v182, v182
    v_exp_f32 v183, v183
    v_exp_f32 v184, v184
    v_exp_f32 v185, v185
    v_smfmac_f32_32x32x32_bf16 v[208:223], v[96:99], v[176:183], v10
    s_add_u32 s67, s86, s82
    ds_read_b128 v[108:111], v11 offset:1536
    v_exp_f32 v186, v186
    v_exp_f32 v187, v187
    v_exp_f32 v188, v188
    v_exp_f32 v189, v189
    v_exp_f32 v190, v190
    v_exp_f32 v191, v191
    v_exp_f32 v192, v192
    v_exp_f32 v193, v193
    v_smfmac_f32_32x32x32_bf16 v[208:223], v[100:103], v[184:191], v10
    s_waitcnt lgkmcnt(2)
    buffer_load_dwordx4 a[68:71], v1, s[4:7], s67 offen sc1
    v_exp_f32 v194, v194
    v_exp_f32 v195, v195
    v_exp_f32 v196, v196
    v_mfma_f32_32x32x16_bf16 v[176:191], v[92:95], v[240:243], 0
    v_exp_f32 v197, v197
    v_exp_f32 v198, v198
    v_exp_f32 v199, v199
    v_exp_f32 v200, v200
    v_exp_f32 v201, v201
    v_smfmac_f32_32x32x32_bf16 v[224:239], v[96:99], v[192:199], v10
    s_waitcnt lgkmcnt(0)
    buffer_load_dwordx4 a[76:79], v1, s[4:7], s67 offen offset:1024 sc1
    v_exp_f32 v202, v202
    v_exp_f32 v203, v203
    v_exp_f32 v204, v204
    v_exp_f32 v205, v205
    v_exp_f32 v206, v206
    v_exp_f32 v207, v207
    v_exp_f32 v176, v176
    v_exp_f32 v177, v177
    v_smfmac_f32_32x32x32_bf16 v[224:239], v[100:103], v[200:207], v10
    ds_read_b128 v[88:91], v39 offset:10240
    v_exp_f32 v178, v178
    v_exp_f32 v179, v179
    v_exp_f32 v180, v180
    v_mfma_f32_32x32x16_bf16 v[192:207], v[92:95], v[244:247], 0
    ds_read_b128 v[96:99], v11 offset:2048
    v_exp_f32 v181, v181
    v_exp_f32 v182, v182
    v_exp_f32 v183, v183
    v_exp_f32 v184, v184
    v_exp_f32 v185, v185
    v_smfmac_f32_32x32x32_bf16 v[208:223], v[104:107], v[176:183], v10
    ds_read_b128 v[100:103], v11 offset:2560
    v_exp_f32 v186, v186
    v_exp_f32 v187, v187
    v_exp_f32 v188, v188
    v_exp_f32 v189, v189
    v_exp_f32 v190, v190
    v_exp_f32 v191, v191
    v_exp_f32 v192, v192
    v_exp_f32 v193, v193
    v_smfmac_f32_32x32x32_bf16 v[208:223], v[108:111], v[184:191], v10
    s_waitcnt lgkmcnt(2)
    buffer_load_dwordx4 a[84:87], v1, s[4:7], s67 offen offset:2048 sc1
    v_exp_f32 v194, v194
    v_exp_f32 v195, v195
    v_exp_f32 v196, v196
    v_mfma_f32_32x32x16_bf16 v[176:191], v[88:91], v[240:243], 0
    buffer_load_dwordx4 a[92:95], v1, s[4:7], s67 offen offset:3072 sc1
    s_add_u32 s62, s63, 0x18000
    v_exp_f32 v197, v197
    v_exp_f32 v198, v198
    v_exp_f32 v199, v199
    v_exp_f32 v200, v200
    v_exp_f32 v201, v201
    v_smfmac_f32_32x32x32_bf16 v[224:239], v[104:107], v[192:199], v10
    s_waitcnt lgkmcnt(0)
    buffer_load_dword v44, v1, s[8:11], s62 offen sc1
    v_exp_f32 v202, v202
    v_exp_f32 v203, v203
    v_exp_f32 v204, v204
    v_exp_f32 v205, v205
    v_exp_f32 v206, v206
    v_exp_f32 v207, v207
    v_exp_f32 v176, v176
    v_exp_f32 v177, v177
    v_smfmac_f32_32x32x32_bf16 v[224:239], v[108:111], v[200:207], v10
    ds_read_b128 v[92:95], v39 offset:11264
    v_exp_f32 v178, v178
    v_exp_f32 v179, v179
    v_exp_f32 v180, v180
    v_mfma_f32_32x32x16_bf16 v[192:207], v[88:91], v[244:247], 0
    ds_read_b128 v[104:107], v11 offset:3072
    v_exp_f32 v181, v181
    v_exp_f32 v182, v182
    v_exp_f32 v183, v183
    v_exp_f32 v184, v184
    v_exp_f32 v185, v185
    v_smfmac_f32_32x32x32_bf16 v[208:223], v[96:99], v[176:183], v10
    s_add_u32 s67, s67, 4096
    ds_read_b128 v[108:111], v11 offset:3584
    v_exp_f32 v186, v186
    v_exp_f32 v187, v187
    v_exp_f32 v188, v188
    v_exp_f32 v189, v189
    v_exp_f32 v190, v190
    v_exp_f32 v191, v191
    v_exp_f32 v192, v192
    v_exp_f32 v193, v193
    v_smfmac_f32_32x32x32_bf16 v[208:223], v[100:103], v[184:191], v10
    s_waitcnt lgkmcnt(2)
    buffer_load_dwordx4 a[100:103], v1, s[4:7], s67 offen sc1
    v_exp_f32 v194, v194
    v_exp_f32 v195, v195
    v_exp_f32 v196, v196
    v_mfma_f32_32x32x16_bf16 v[176:191], v[92:95], v[240:243], 0
    buffer_load_dwordx4 a[108:111], v1, s[4:7], s67 offen offset:1024 sc1
    v_exp_f32 v197, v197
    v_exp_f32 v198, v198
    v_exp_f32 v199, v199
    v_exp_f32 v200, v200
    v_exp_f32 v201, v201
    v_smfmac_f32_32x32x32_bf16 v[224:239], v[96:99], v[192:199], v10
    s_waitcnt lgkmcnt(0)
    buffer_load_dwordx4 a[116:119], v1, s[4:7], s67 offen offset:2048 sc1
    v_exp_f32 v202, v202
    v_exp_f32 v203, v203
    v_exp_f32 v204, v204
    v_exp_f32 v205, v205
    v_exp_f32 v206, v206
    v_exp_f32 v207, v207
    v_exp_f32 v176, v176
    v_exp_f32 v177, v177
    v_smfmac_f32_32x32x32_bf16 v[224:239], v[100:103], v[200:207], v10
    ds_read_b128 v[88:91], v39 offset:12288
    v_exp_f32 v178, v178
    v_exp_f32 v179, v179
    v_exp_f32 v180, v180
    v_mfma_f32_32x32x16_bf16 v[192:207], v[92:95], v[244:247], 0
    v_add_u32 v11, v38, v11
    ds_read_b128 v[96:99], v11 offset:0
    v_exp_f32 v181, v181
    v_exp_f32 v182, v182
    v_exp_f32 v183, v183
    v_exp_f32 v184, v184
    v_exp_f32 v185, v185
    v_smfmac_f32_32x32x32_bf16 v[208:223], v[104:107], v[176:183], v10
    ds_read_b128 v[100:103], v11 offset:512
    v_exp_f32 v186, v186
    v_exp_f32 v187, v187
    v_exp_f32 v188, v188
    v_exp_f32 v189, v189
    v_exp_f32 v190, v190
    v_exp_f32 v191, v191
    v_exp_f32 v192, v192
    v_exp_f32 v193, v193
    v_smfmac_f32_32x32x32_bf16 v[208:223], v[108:111], v[184:191], v10
    s_waitcnt lgkmcnt(2)
    buffer_load_dwordx4 a[124:127], v1, s[4:7], s67 offen offset:3072 sc1
    v_exp_f32 v194, v194
    v_exp_f32 v195, v195
    v_exp_f32 v196, v196
    v_mfma_f32_32x32x16_bf16 v[176:191], v[88:91], v[240:243], 0
    s_add_u32 s67, s86, s83
    v_exp_f32 v197, v197
    v_exp_f32 v198, v198
    v_exp_f32 v199, v199
    v_exp_f32 v200, v200
    v_exp_f32 v201, v201
    v_smfmac_f32_32x32x32_bf16 v[224:239], v[104:107], v[192:199], v10
    s_waitcnt lgkmcnt(0)
    buffer_load_dwordx4 a[132:135], v1, s[4:7], s67 offen sc1
    v_exp_f32 v202, v202
    v_exp_f32 v203, v203
    v_exp_f32 v204, v204
    v_exp_f32 v205, v205
    v_exp_f32 v206, v206
    v_exp_f32 v207, v207
    v_exp_f32 v176, v176
    v_exp_f32 v177, v177
    v_smfmac_f32_32x32x32_bf16 v[224:239], v[108:111], v[200:207], v10
    ds_read_b128 v[92:95], v39 offset:13312
    v_exp_f32 v178, v178
    v_exp_f32 v179, v179
    v_exp_f32 v180, v180
    v_mfma_f32_32x32x16_bf16 v[192:207], v[88:91], v[244:247], 0
    ds_read_b128 v[104:107], v11 offset:1024
    v_exp_f32 v181, v181
    v_exp_f32 v182, v182
    v_exp_f32 v183, v183
    v_exp_f32 v184, v184
    v_exp_f32 v185, v185
    v_smfmac_f32_32x32x32_bf16 v[208:223], v[96:99], v[176:183], v10
    s_add_u32 s62, s63, 0x20000
    ds_read_b128 v[108:111], v11 offset:1536
    v_exp_f32 v186, v186
    v_exp_f32 v187, v187
    v_exp_f32 v188, v188
    v_exp_f32 v189, v189
    v_exp_f32 v190, v190
    v_exp_f32 v191, v191
    v_exp_f32 v192, v192
    v_exp_f32 v193, v193
    v_smfmac_f32_32x32x32_bf16 v[208:223], v[100:103], v[184:191], v10
    s_waitcnt lgkmcnt(2)
    buffer_load_dword v44, v1, s[8:11], s62 offen sc1
    v_exp_f32 v194, v194
    v_exp_f32 v195, v195
    v_exp_f32 v196, v196
    v_mfma_f32_32x32x16_bf16 v[176:191], v[92:95], v[240:243], 0
    buffer_load_dwordx4 a[140:143], v1, s[4:7], s67 offen offset:1024 sc1
    v_exp_f32 v197, v197
    v_exp_f32 v198, v198
    v_exp_f32 v199, v199
    v_exp_f32 v200, v200
    v_exp_f32 v201, v201
    v_smfmac_f32_32x32x32_bf16 v[224:239], v[96:99], v[192:199], v10
    s_waitcnt lgkmcnt(0)
    buffer_load_dwordx4 a[148:151], v1, s[4:7], s67 offen offset:2048 sc1
    v_exp_f32 v202, v202
    v_exp_f32 v203, v203
    v_exp_f32 v204, v204
    v_exp_f32 v205, v205
    v_exp_f32 v206, v206
    v_exp_f32 v207, v207
    v_exp_f32 v176, v176
    v_exp_f32 v177, v177
    v_smfmac_f32_32x32x32_bf16 v[224:239], v[100:103], v[200:207], v10
    ds_read_b128 v[88:91], v39 offset:14336
    v_exp_f32 v178, v178
    v_exp_f32 v179, v179
    v_exp_f32 v180, v180
    v_mfma_f32_32x32x16_bf16 v[192:207], v[92:95], v[244:247], 0
    ds_read_b128 v[96:99], v11 offset:2048
    v_exp_f32 v181, v181
    v_exp_f32 v182, v182
    v_exp_f32 v183, v183
    v_exp_f32 v184, v184
    v_exp_f32 v185, v185
    v_smfmac_f32_32x32x32_bf16 v[208:223], v[104:107], v[176:183], v10
    ds_read_b128 v[100:103], v11 offset:2560
    v_exp_f32 v186, v186
    v_exp_f32 v187, v187
    v_exp_f32 v188, v188
    v_exp_f32 v189, v189
    v_exp_f32 v190, v190
    v_exp_f32 v191, v191
    v_exp_f32 v192, v192
    v_exp_f32 v193, v193
    v_smfmac_f32_32x32x32_bf16 v[208:223], v[108:111], v[184:191], v10
    s_waitcnt lgkmcnt(2)
    buffer_load_dwordx4 a[156:159], v1, s[4:7], s67 offen offset:3072 sc1
    s_add_u32 s67, s67, 4096
    v_exp_f32 v194, v194
    v_exp_f32 v195, v195
    v_exp_f32 v196, v196
    v_mfma_f32_32x32x16_bf16 v[176:191], v[88:91], v[240:243], 0
    buffer_load_dwordx4 a[164:167], v1, s[4:7], s67 offen sc1
    v_exp_f32 v197, v197
    v_exp_f32 v198, v198
    v_exp_f32 v199, v199
    v_exp_f32 v200, v200
    v_exp_f32 v201, v201
    v_smfmac_f32_32x32x32_bf16 v[224:239], v[104:107], v[192:199], v10
    s_waitcnt lgkmcnt(0)
    buffer_load_dwordx4 a[172:175], v1, s[4:7], s67 offen offset:1024 sc1
    v_exp_f32 v202, v202
    v_exp_f32 v203, v203
    v_exp_f32 v204, v204
    v_exp_f32 v205, v205
    v_exp_f32 v206, v206
    v_exp_f32 v207, v207
    v_exp_f32 v176, v176
    v_exp_f32 v177, v177
    v_smfmac_f32_32x32x32_bf16 v[224:239], v[108:111], v[200:207], v10
    ds_read_b128 v[92:95], v39 offset:15360
    v_exp_f32 v178, v178
    v_exp_f32 v179, v179
    v_exp_f32 v180, v180
    v_mfma_f32_32x32x16_bf16 v[192:207], v[88:91], v[244:247], 0
    ds_read_b128 v[104:107], v11 offset:3072
    v_exp_f32 v181, v181
    v_exp_f32 v182, v182
    v_exp_f32 v183, v183
    v_exp_f32 v184, v184
    v_exp_f32 v185, v185
    v_smfmac_f32_32x32x32_bf16 v[208:223], v[96:99], v[176:183], v10
    s_add_u32 s62, s63, 0x28000
    ds_read_b128 v[108:111], v11 offset:3584
    v_exp_f32 v186, v186
    v_exp_f32 v187, v187
    v_exp_f32 v188, v188
    v_exp_f32 v189, v189
    v_exp_f32 v190, v190
    v_exp_f32 v191, v191
    v_exp_f32 v192, v192
    v_exp_f32 v193, v193
    v_smfmac_f32_32x32x32_bf16 v[208:223], v[100:103], v[184:191], v10
    s_waitcnt lgkmcnt(2)
    buffer_load_dword v44, v1, s[8:11], s62 offen sc1
    v_exp_f32 v194, v194
    v_exp_f32 v195, v195
    v_exp_f32 v196, v196
    v_mfma_f32_32x32x16_bf16 v[176:191], v[92:95], v[240:243], 0
    v_exp_f32 v197, v197
    v_exp_f32 v198, v198
    v_exp_f32 v199, v199
    v_exp_f32 v200, v200
    v_exp_f32 v201, v201
    v_smfmac_f32_32x32x32_bf16 v[224:239], v[96:99], v[192:199], v10
    s_waitcnt lgkmcnt(0)
    buffer_load_dwordx4 a[180:183], v1, s[4:7], s67 offen offset:2048 sc1
    v_exp_f32 v202, v202
    v_exp_f32 v203, v203
    v_exp_f32 v204, v204
    v_exp_f32 v205, v205
    v_exp_f32 v206, v206
    v_exp_f32 v207, v207
    v_exp_f32 v176, v176
    v_exp_f32 v177, v177
    v_smfmac_f32_32x32x32_bf16 v[224:239], v[100:103], v[200:207], v10
    ds_read_b128 v[88:91], v39 offset:16384
    v_exp_f32 v178, v178
    v_exp_f32 v179, v179
    v_exp_f32 v180, v180
    v_mfma_f32_32x32x16_bf16 v[192:207], v[92:95], v[244:247], 0
    v_add_u32 v11, v38, v11
    ds_read_b128 v[96:99], v11 offset:0
    v_exp_f32 v181, v181
    v_exp_f32 v182, v182
    v_exp_f32 v183, v183
    v_exp_f32 v184, v184
    v_exp_f32 v185, v185
    v_smfmac_f32_32x32x32_bf16 v[208:223], v[104:107], v[176:183], v10
    ds_read_b128 v[100:103], v11 offset:512
    v_exp_f32 v186, v186
    v_exp_f32 v187, v187
    v_exp_f32 v188, v188
    v_exp_f32 v189, v189
    v_exp_f32 v190, v190
    v_exp_f32 v191, v191
    v_exp_f32 v192, v192
    v_exp_f32 v193, v193
    v_smfmac_f32_32x32x32_bf16 v[208:223], v[108:111], v[184:191], v10
    s_waitcnt lgkmcnt(2)
    buffer_load_dwordx4 a[188:191], v1, s[4:7], s67 offen offset:3072 sc1
    s_add_u32 s67, s86, s84
    v_exp_f32 v194, v194
    v_exp_f32 v195, v195
    v_exp_f32 v196, v196
    v_mfma_f32_32x32x16_bf16 v[176:191], v[88:91], v[240:243], 0
    buffer_load_dwordx4 a[196:199], v1, s[4:7], s67 offen sc1
    v_exp_f32 v197, v197
    v_exp_f32 v198, v198
    v_exp_f32 v199, v199
    v_exp_f32 v200, v200
    v_exp_f32 v201, v201
    v_smfmac_f32_32x32x32_bf16 v[224:239], v[104:107], v[192:199], v10
    s_waitcnt lgkmcnt(0)
    buffer_load_dwordx4 a[204:207], v1, s[4:7], s67 offen offset:1024 sc1
    v_exp_f32 v202, v202
    v_exp_f32 v203, v203
    v_exp_f32 v204, v204
    v_exp_f32 v205, v205
    v_exp_f32 v206, v206
    v_exp_f32 v207, v207
    v_exp_f32 v176, v176
    v_exp_f32 v177, v177
    v_smfmac_f32_32x32x32_bf16 v[224:239], v[108:111], v[200:207], v10
    ds_read_b128 v[92:95], v39 offset:17408
    v_exp_f32 v178, v178
    v_exp_f32 v179, v179
    v_exp_f32 v180, v180
    v_mfma_f32_32x32x16_bf16 v[192:207], v[88:91], v[244:247], 0
    ds_read_b128 v[104:107], v11 offset:1024
    v_exp_f32 v181, v181
    v_exp_f32 v182, v182
    v_exp_f32 v183, v183
    v_exp_f32 v184, v184
    v_exp_f32 v185, v185
    v_smfmac_f32_32x32x32_bf16 v[208:223], v[96:99], v[176:183], v10
    ds_read_b128 v[108:111], v11 offset:1536
    v_exp_f32 v186, v186
    v_exp_f32 v187, v187
    v_exp_f32 v188, v188
    v_exp_f32 v189, v189
    v_exp_f32 v190, v190
    v_exp_f32 v191, v191
    v_exp_f32 v192, v192
    v_exp_f32 v193, v193
    v_smfmac_f32_32x32x32_bf16 v[208:223], v[100:103], v[184:191], v10
    s_waitcnt lgkmcnt(2)
    buffer_load_dwordx4 a[212:215], v1, s[4:7], s67 offen offset:2048 sc1
    s_add_u32 s62, s63, 0x30000
    v_exp_f32 v194, v194
    v_exp_f32 v195, v195
    v_exp_f32 v196, v196
    v_mfma_f32_32x32x16_bf16 v[176:191], v[92:95], v[240:243], 0
    buffer_load_dword v44, v1, s[8:11], s62 offen sc1
    v_exp_f32 v197, v197
    v_exp_f32 v198, v198
    v_exp_f32 v199, v199
    v_exp_f32 v200, v200
    v_exp_f32 v201, v201
    v_smfmac_f32_32x32x32_bf16 v[224:239], v[96:99], v[192:199], v10
    s_waitcnt lgkmcnt(0)
    buffer_load_dwordx4 a[220:223], v1, s[4:7], s67 offen offset:3072 sc1
    v_exp_f32 v202, v202
    v_exp_f32 v203, v203
    v_exp_f32 v204, v204
    v_exp_f32 v205, v205
    v_exp_f32 v206, v206
    v_exp_f32 v207, v207
    v_exp_f32 v176, v176
    v_exp_f32 v177, v177
    v_smfmac_f32_32x32x32_bf16 v[224:239], v[100:103], v[200:207], v10
    ds_read_b128 v[88:91], v39 offset:18432
    v_exp_f32 v178, v178
    v_exp_f32 v179, v179
    v_exp_f32 v180, v180
    v_mfma_f32_32x32x16_bf16 v[192:207], v[92:95], v[244:247], 0
    ds_read_b128 v[96:99], v11 offset:2048
    v_exp_f32 v181, v181
    v_exp_f32 v182, v182
    v_exp_f32 v183, v183
    v_exp_f32 v184, v184
    v_exp_f32 v185, v185
    v_smfmac_f32_32x32x32_bf16 v[208:223], v[104:107], v[176:183], v10
    s_add_u32 s67, s67, 4096
    ds_read_b128 v[100:103], v11 offset:2560
    v_exp_f32 v186, v186
    v_exp_f32 v187, v187
    v_exp_f32 v188, v188
    v_exp_f32 v189, v189
    v_exp_f32 v190, v190
    v_exp_f32 v191, v191
    v_exp_f32 v192, v192
    v_exp_f32 v193, v193
    v_smfmac_f32_32x32x32_bf16 v[208:223], v[108:111], v[184:191], v10
    s_waitcnt lgkmcnt(2)
    buffer_load_dwordx4 a[228:231], v1, s[4:7], s67 offen sc1
    v_exp_f32 v194, v194
    v_exp_f32 v195, v195
    v_exp_f32 v196, v196
    v_mfma_f32_32x32x16_bf16 v[176:191], v[88:91], v[240:243], 0
    v_exp_f32 v197, v197
    v_exp_f32 v198, v198
    v_exp_f32 v199, v199
    v_exp_f32 v200, v200
    v_exp_f32 v201, v201
    v_smfmac_f32_32x32x32_bf16 v[224:239], v[104:107], v[192:199], v10
    s_waitcnt lgkmcnt(0)
    buffer_load_dwordx4 a[236:239], v1, s[4:7], s67 offen offset:1024 sc1
    v_exp_f32 v202, v202
    v_exp_f32 v203, v203
    v_exp_f32 v204, v204
    v_exp_f32 v205, v205
    v_exp_f32 v206, v206
    v_exp_f32 v207, v207
    v_exp_f32 v176, v176
    v_exp_f32 v177, v177
    v_smfmac_f32_32x32x32_bf16 v[224:239], v[108:111], v[200:207], v10
    ds_read_b128 v[92:95], v39 offset:19456
    v_exp_f32 v178, v178
    v_exp_f32 v179, v179
    v_exp_f32 v180, v180
    v_mfma_f32_32x32x16_bf16 v[192:207], v[88:91], v[244:247], 0
    ds_read_b128 v[104:107], v11 offset:3072
    v_exp_f32 v181, v181
    v_exp_f32 v182, v182
    v_exp_f32 v183, v183
    v_exp_f32 v184, v184
    v_exp_f32 v185, v185
    v_smfmac_f32_32x32x32_bf16 v[208:223], v[96:99], v[176:183], v10
    ds_read_b128 v[108:111], v11 offset:3584
    v_exp_f32 v186, v186
    v_exp_f32 v187, v187
    v_exp_f32 v188, v188
    v_exp_f32 v189, v189
    v_exp_f32 v190, v190
    v_exp_f32 v191, v191
    v_exp_f32 v192, v192
    v_exp_f32 v193, v193
    v_smfmac_f32_32x32x32_bf16 v[208:223], v[100:103], v[184:191], v10
    s_waitcnt lgkmcnt(2)
    buffer_load_dwordx4 a[244:247], v1, s[4:7], s67 offen offset:2048 sc1
    v_exp_f32 v194, v194
    v_exp_f32 v195, v195
    v_exp_f32 v196, v196
    v_mfma_f32_32x32x16_bf16 v[176:191], v[92:95], v[240:243], 0
    buffer_load_dwordx4 a[252:255], v1, s[4:7], s67 offen offset:3072 sc1
    s_add_u32 s62, s63, 0x50000
    v_exp_f32 v197, v197
    v_exp_f32 v198, v198
    v_exp_f32 v199, v199
    v_exp_f32 v200, v200
    v_exp_f32 v201, v201
    v_smfmac_f32_32x32x32_bf16 v[224:239], v[96:99], v[192:199], v10
    s_waitcnt lgkmcnt(0)
    buffer_load_dword v44, v1, s[8:11], s62 offen sc1
    v_exp_f32 v202, v202
    v_exp_f32 v203, v203
    v_exp_f32 v204, v204
    v_exp_f32 v205, v205
    v_exp_f32 v206, v206
    v_exp_f32 v207, v207
    v_exp_f32 v176, v176
    v_exp_f32 v177, v177
    v_smfmac_f32_32x32x32_bf16 v[224:239], v[100:103], v[200:207], v10
    ds_read_b128 v[88:91], v39 offset:20480
    v_exp_f32 v178, v178
    v_exp_f32 v179, v179
    v_exp_f32 v180, v180
    v_mfma_f32_32x32x16_bf16 v[192:207], v[92:95], v[244:247], 0
    v_add_u32 v11, v38, v11
    ds_read_b128 v[96:99], v11 offset:0
    v_exp_f32 v181, v181
    v_exp_f32 v182, v182
    v_exp_f32 v183, v183
    v_exp_f32 v184, v184
    v_exp_f32 v185, v185
    v_smfmac_f32_32x32x32_bf16 v[208:223], v[104:107], v[176:183], v10
    s_add_u32 s67, s86, 32768
    ds_read_b128 v[100:103], v11 offset:512
    v_exp_f32 v186, v186
    v_exp_f32 v187, v187
    v_exp_f32 v188, v188
    v_exp_f32 v189, v189
    v_exp_f32 v190, v190
    v_exp_f32 v191, v191
    v_exp_f32 v192, v192
    v_exp_f32 v193, v193
    v_smfmac_f32_32x32x32_bf16 v[208:223], v[108:111], v[184:191], v10
    s_waitcnt lgkmcnt(2)
    ds_read_b128 v[92:95], v39 offset:21504
    buffer_load_dwordx4 v[32:35], v1, s[4:7], s67 offen sc1
    v_exp_f32 v194, v194
    v_exp_f32 v195, v195
    v_exp_f32 v196, v196
    v_mfma_f32_32x32x16_bf16 v[176:191], v[88:91], v[240:243], 0
    s_lshl1_add_u32 m0, s75, 0
    s_add_u32 s67, s89, 10240
    v_exp_f32 v197, v197
    v_exp_f32 v198, v198
    v_exp_f32 v199, v199
    v_exp_f32 v200, v200
    v_exp_f32 v201, v201
    v_smfmac_f32_32x32x32_bf16 v[224:239], v[104:107], v[192:199], v10
    s_waitcnt lgkmcnt(1)
    s_waitcnt vmcnt(48)
    v_cmp_ne_u32 vcc, s59, v67
    s_cmp_lg_u64 vcc, 0
    s_cselect_b32 s58, 1, 0
    buffer_load_dwordx4 v2, s[4:7], s67 offen sc1 lds
    v_exp_f32 v202, v202
    v_exp_f32 v203, v203
    v_exp_f32 v204, v204
    v_exp_f32 v205, v205
    v_exp_f32 v206, v206
    v_exp_f32 v207, v207
    v_exp_f32 v176, v176
    v_exp_f32 v177, v177
    v_smfmac_f32_32x32x32_bf16 v[224:239], v[108:111], v[200:207], v10
    ds_read_b128 v[88:91], v39 offset:22528
    buffer_load_dwordx4 v2, s[4:7], s67 offen offset:1024 sc1 lds
    v_exp_f32 v178, v178
    v_exp_f32 v179, v179
    v_exp_f32 v180, v180
    s_waitcnt lgkmcnt(1)
    v_mfma_f32_32x32x16_bf16 v[192:207], v[92:95], v[240:243], 0
    ds_read_b128 v[104:107], v11 offset:1024
    v_exp_f32 v181, v181
    v_exp_f32 v182, v182
    v_exp_f32 v183, v183
    v_exp_f32 v184, v184
    v_exp_f32 v185, v185
    v_smfmac_f32_32x32x32_bf16 v[208:223], v[96:99], v[176:183], v10
    ds_read_b128 v[108:111], v11 offset:1536
    s_lshl1_add_u32 m0, s75, 2048
    s_add_u32 s67, s90, 10240
    buffer_load_dwordx4 v2, s[4:7], s67 offen sc1 lds
    v_exp_f32 v186, v186
    v_exp_f32 v187, v187
    v_exp_f32 v188, v188
    v_exp_f32 v189, v189
    v_exp_f32 v190, v190
    v_exp_f32 v191, v191
    v_exp_f32 v192, v192
    v_exp_f32 v193, v193
    v_smfmac_f32_32x32x32_bf16 v[208:223], v[100:103], v[184:191], v10
    s_waitcnt lgkmcnt(0)
    ds_read_b128 v[92:95], v39 offset:23552
    buffer_load_dwordx4 v2, s[4:7], s67 offen offset:1024 sc1 lds
    v_exp_f32 v194, v194
    v_exp_f32 v195, v195
    v_exp_f32 v196, v196
    v_mfma_f32_32x32x16_bf16 v[176:191], v[88:91], v[240:243], 0
    ds_read_b128 v[96:99], v11 offset:2048
    v_exp_f32 v197, v197
    v_exp_f32 v198, v198
    v_exp_f32 v199, v199
    v_exp_f32 v200, v200
    v_exp_f32 v201, v201
    v_smfmac_f32_32x32x32_bf16 v[208:223], v[104:107], v[192:199], v10
    ds_read_b128 v[100:103], v11 offset:2560
    s_lshl1_add_u32 m0, s75, 4096
    s_add_u32 s67, s89, 16384
    buffer_load_dwordx4 v2, s[4:7], s67 offen sc1 lds
    v_exp_f32 v202, v202
    v_exp_f32 v203, v203
    v_exp_f32 v204, v204
    v_exp_f32 v205, v205
    v_exp_f32 v206, v206
    v_exp_f32 v207, v207
    v_exp_f32 v176, v176
    v_exp_f32 v177, v177
    v_smfmac_f32_32x32x32_bf16 v[208:223], v[108:111], v[200:207], v10
    s_waitcnt lgkmcnt(0)
    ds_read_b128 v[88:91], v39 offset:24576
    buffer_load_dwordx4 v2, s[4:7], s67 offen offset:1024 sc1 lds
    v_exp_f32 v178, v178
    v_exp_f32 v179, v179
    v_exp_f32 v180, v180
    v_mfma_f32_32x32x16_bf16 v[192:207], v[92:95], v[240:243], 0
    ds_read_b128 v[104:107], v11 offset:3072
    v_exp_f32 v181, v181
    v_exp_f32 v182, v182
    v_exp_f32 v183, v183
    v_exp_f32 v184, v184
    v_exp_f32 v185, v185
    v_smfmac_f32_32x32x32_bf16 v[208:223], v[96:99], v[176:183], v10
    ds_read_b128 v[108:111], v11 offset:3584
    s_lshl1_add_u32 m0, s75, 6144
    s_add_u32 s67, s90, 16384
    buffer_load_dwordx4 v2, s[4:7], s67 offen sc1 lds
    v_exp_f32 v186, v186
    v_exp_f32 v187, v187
    v_exp_f32 v188, v188
    v_exp_f32 v189, v189
    v_exp_f32 v190, v190
    v_exp_f32 v191, v191
    v_exp_f32 v192, v192
    v_exp_f32 v193, v193
    v_smfmac_f32_32x32x32_bf16 v[208:223], v[100:103], v[184:191], v10
    s_waitcnt lgkmcnt(0)
    ds_read_b128 v[92:95], v39 offset:25600
    buffer_load_dwordx4 v2, s[4:7], s67 offen offset:1024 sc1 lds
    v_exp_f32 v194, v194
    v_exp_f32 v195, v195
    v_exp_f32 v196, v196
    v_mfma_f32_32x32x16_bf16 v[176:191], v[88:91], v[240:243], 0
    v_add_u32 v11, v38, v11
    ds_read_b128 v[96:99], v11 offset:0
    v_exp_f32 v197, v197
    v_exp_f32 v198, v198
    v_exp_f32 v199, v199
    v_exp_f32 v200, v200
    v_exp_f32 v201, v201
    v_smfmac_f32_32x32x32_bf16 v[208:223], v[104:107], v[192:199], v10
    ds_read_b128 v[100:103], v11 offset:512
    s_lshl1_add_u32 m0, s75, 8192
    s_add_u32 s67, s89, 20480
    buffer_load_dwordx4 v2, s[4:7], s67 offen sc1 lds
    v_exp_f32 v202, v202
    v_exp_f32 v203, v203
    v_exp_f32 v204, v204
    v_exp_f32 v205, v205
    v_exp_f32 v206, v206
    v_exp_f32 v207, v207
    v_exp_f32 v176, v176
    v_exp_f32 v177, v177
    v_smfmac_f32_32x32x32_bf16 v[208:223], v[108:111], v[200:207], v10
    s_waitcnt lgkmcnt(0)
    ds_read_b128 v[88:91], v39 offset:26624
    buffer_load_dwordx4 v2, s[4:7], s67 offen offset:1024 sc1 lds
    v_exp_f32 v178, v178
    v_exp_f32 v179, v179
    v_exp_f32 v180, v180
    v_mfma_f32_32x32x16_bf16 v[192:207], v[92:95], v[240:243], 0
    ds_read_b128 v[104:107], v11 offset:1024
    v_exp_f32 v181, v181
    v_exp_f32 v182, v182
    v_exp_f32 v183, v183
    v_exp_f32 v184, v184
    v_exp_f32 v185, v185
    v_smfmac_f32_32x32x32_bf16 v[208:223], v[96:99], v[176:183], v10
    ds_read_b128 v[108:111], v11 offset:1536
    s_lshl1_add_u32 m0, s75, 10240
    s_add_u32 s67, s90, 20480
    buffer_load_dwordx4 v2, s[4:7], s67 offen sc1 lds
    v_exp_f32 v186, v186
    v_exp_f32 v187, v187
    v_exp_f32 v188, v188
    v_exp_f32 v189, v189
    v_exp_f32 v190, v190
    v_exp_f32 v191, v191
    v_exp_f32 v192, v192
    v_exp_f32 v193, v193
    v_smfmac_f32_32x32x32_bf16 v[208:223], v[100:103], v[184:191], v10
    s_waitcnt lgkmcnt(0)
    ds_read_b128 v[92:95], v39 offset:27648
    buffer_load_dwordx4 v2, s[4:7], s67 offen offset:1024 sc1 lds
    v_exp_f32 v194, v194
    v_exp_f32 v195, v195
    v_exp_f32 v196, v196
    v_mfma_f32_32x32x16_bf16 v[176:191], v[88:91], v[240:243], 0
    ds_read_b128 v[96:99], v11 offset:2048
    v_exp_f32 v197, v197
    v_exp_f32 v198, v198
    v_exp_f32 v199, v199
    v_exp_f32 v200, v200
    v_exp_f32 v201, v201
    v_smfmac_f32_32x32x32_bf16 v[208:223], v[104:107], v[192:199], v10
    ds_read_b128 v[100:103], v11 offset:2560
    s_lshl1_add_u32 m0, s75, 12288
    s_add_u32 s67, s89, 24576
    buffer_load_dwordx4 v2, s[4:7], s67 offen sc1 lds
    v_exp_f32 v202, v202
    v_exp_f32 v203, v203
    v_exp_f32 v204, v204
    v_exp_f32 v205, v205
    v_exp_f32 v206, v206
    v_exp_f32 v207, v207
    v_exp_f32 v176, v176
    v_exp_f32 v177, v177
    v_smfmac_f32_32x32x32_bf16 v[208:223], v[108:111], v[200:207], v10
    s_waitcnt lgkmcnt(0)
    ds_read_b128 v[88:91], v39 offset:28672
    buffer_load_dwordx4 v2, s[4:7], s67 offen offset:1024 sc1 lds
    v_exp_f32 v178, v178
    v_exp_f32 v179, v179
    v_exp_f32 v180, v180
    v_mfma_f32_32x32x16_bf16 v[192:207], v[92:95], v[240:243], 0
    ds_read_b128 v[104:107], v11 offset:3072
    v_exp_f32 v181, v181
    v_exp_f32 v182, v182
    v_exp_f32 v183, v183
    v_exp_f32 v184, v184
    v_exp_f32 v185, v185
    v_smfmac_f32_32x32x32_bf16 v[208:223], v[96:99], v[176:183], v10
    ds_read_b128 v[108:111], v11 offset:3584
    s_lshl1_add_u32 m0, s75, 14336
    s_add_u32 s67, s90, 24576
    buffer_load_dwordx4 v2, s[4:7], s67 offen sc1 lds
    v_exp_f32 v186, v186
    v_exp_f32 v187, v187
    v_exp_f32 v188, v188
    v_exp_f32 v189, v189
    v_exp_f32 v190, v190
    v_exp_f32 v191, v191
    v_exp_f32 v192, v192
    v_exp_f32 v193, v193
    v_smfmac_f32_32x32x32_bf16 v[208:223], v[100:103], v[184:191], v10
    s_waitcnt lgkmcnt(0)
    ds_read_b128 v[92:95], v39 offset:29696
    buffer_load_dwordx4 v2, s[4:7], s67 offen offset:1024 sc1 lds
    v_exp_f32 v194, v194
    v_exp_f32 v195, v195
    v_exp_f32 v196, v196
    v_mfma_f32_32x32x16_bf16 v[176:191], v[88:91], v[240:243], 0
    v_add_u32 v11, v38, v11
    ds_read_b128 v[96:99], v11 offset:0
    v_exp_f32 v197, v197
    v_exp_f32 v198, v198
    v_exp_f32 v199, v199
    v_exp_f32 v200, v200
    v_exp_f32 v201, v201
    v_smfmac_f32_32x32x32_bf16 v[208:223], v[104:107], v[192:199], v10
    ds_read_b128 v[100:103], v11 offset:512
    s_getpc_b64 s[64:65]
L_cpf:
    s_min_u32 s62, s74, L_end-L_post
    s_add_u32 s62, s62, L_post-L_cpf
    s_add_u32 s64, s64, s62
    s_addc_u32 s65, s65, 0
    global_load_dword v44, v1, s[64:65]
    v_exp_f32 v202, v202
    v_exp_f32 v203, v203
    v_exp_f32 v204, v204
    v_exp_f32 v205, v205
    v_exp_f32 v206, v206
    v_exp_f32 v207, v207
    v_exp_f32 v176, v176
    v_exp_f32 v177, v177
    v_smfmac_f32_32x32x32_bf16 v[208:223], v[108:111], v[200:207], v10
    s_waitcnt lgkmcnt(0)
    ds_read_b128 v[88:91], v39 offset:30720
    v_exp_f32 v178, v178
    v_exp_f32 v179, v179
    v_exp_f32 v180, v180
    v_mfma_f32_32x32x16_bf16 v[192:207], v[92:95], v[240:243], 0
    ds_read_b128 v[104:107], v11 offset:1024
    v_exp_f32 v181, v181
    v_exp_f32 v182, v182
    v_exp_f32 v183, v183
    v_exp_f32 v184, v184
    v_exp_f32 v185, v185
    v_smfmac_f32_32x32x32_bf16 v[208:223], v[96:99], v[176:183], v10
    ds_read_b128 v[108:111], v11 offset:1536
    v_exp_f32 v186, v186
    v_exp_f32 v187, v187
    v_exp_f32 v188, v188
    v_exp_f32 v189, v189
    v_exp_f32 v190, v190
    v_exp_f32 v191, v191
    v_exp_f32 v192, v192
    v_exp_f32 v193, v193
    v_smfmac_f32_32x32x32_bf16 v[208:223], v[100:103], v[184:191], v10
    s_waitcnt lgkmcnt(0)
    ds_read_b128 v[92:95], v39 offset:31744
    v_exp_f32 v194, v194
    v_exp_f32 v195, v195
    v_exp_f32 v196, v196
    v_mfma_f32_32x32x16_bf16 v[176:191], v[88:91], v[240:243], 0
    ds_read_b128 v[96:99], v11 offset:2048
    v_exp_f32 v197, v197
    v_exp_f32 v198, v198
    v_exp_f32 v199, v199
    v_exp_f32 v200, v200
    v_exp_f32 v201, v201
    v_smfmac_f32_32x32x32_bf16 v[208:223], v[104:107], v[192:199], v10
    ds_read_b128 v[100:103], v11 offset:2560
    v_exp_f32 v202, v202
    v_exp_f32 v203, v203
    v_exp_f32 v204, v204
    v_exp_f32 v205, v205
    v_exp_f32 v206, v206
    v_exp_f32 v207, v207
    v_exp_f32 v176, v176
    v_exp_f32 v177, v177
    v_smfmac_f32_32x32x32_bf16 v[208:223], v[108:111], v[200:207], v10
    s_waitcnt lgkmcnt(0)
    ds_read_b128 v[88:91], v39 offset:20480
    v_exp_f32 v178, v178
    v_exp_f32 v179, v179
    v_exp_f32 v180, v180
    v_mfma_f32_32x32x16_bf16 v[192:207], v[92:95], v[240:243], 0
    ds_read_b128 v[104:107], v11 offset:3072
    v_exp_f32 v181, v181
    v_exp_f32 v182, v182
    v_exp_f32 v183, v183
    v_exp_f32 v184, v184
    v_exp_f32 v185, v185
    v_smfmac_f32_32x32x32_bf16 v[208:223], v[96:99], v[176:183], v10
    ds_read_b128 v[108:111], v11 offset:3584
    v_exp_f32 v186, v186
    v_exp_f32 v187, v187
    v_exp_f32 v188, v188
    v_exp_f32 v189, v189
    v_exp_f32 v190, v190
    v_exp_f32 v191, v191
    v_exp_f32 v192, v192
    v_exp_f32 v193, v193
    v_smfmac_f32_32x32x32_bf16 v[208:223], v[100:103], v[184:191], v10
    s_waitcnt lgkmcnt(0)
    ds_read_b128 v[92:95], v39 offset:21504
    v_exp_f32 v194, v194
    v_exp_f32 v195, v195
    v_exp_f32 v196, v196
    v_mfma_f32_32x32x16_bf16 v[176:191], v[88:91], v[244:247], 0
    v_mad_i32_i24 v11, v38, -2, v11
    ds_read_b128 v[96:99], v11 offset:0
    v_exp_f32 v197, v197
    v_exp_f32 v198, v198
    v_exp_f32 v199, v199
    v_exp_f32 v200, v200
    v_exp_f32 v201, v201
    v_smfmac_f32_32x32x32_bf16 v[208:223], v[104:107], v[192:199], v10
    ds_read_b128 v[100:103], v11 offset:512
    v_exp_f32 v202, v202
    v_exp_f32 v203, v203
    v_exp_f32 v204, v204
    v_exp_f32 v205, v205
    v_exp_f32 v206, v206
    v_exp_f32 v207, v207
    v_exp_f32 v176, v176
    v_exp_f32 v177, v177
    v_smfmac_f32_32x32x32_bf16 v[208:223], v[108:111], v[200:207], v10
    s_waitcnt lgkmcnt(0)
    ds_read_b128 v[88:91], v39 offset:22528
    v_exp_f32 v178, v178
    v_exp_f32 v179, v179
    v_exp_f32 v180, v180
    v_mfma_f32_32x32x16_bf16 v[192:207], v[92:95], v[244:247], 0
    ds_read_b128 v[104:107], v11 offset:1024
    v_exp_f32 v181, v181
    v_exp_f32 v182, v182
    v_exp_f32 v183, v183
    v_exp_f32 v184, v184
    v_exp_f32 v185, v185
    v_smfmac_f32_32x32x32_bf16 v[224:239], v[96:99], v[176:183], v10
    ds_read_b128 v[108:111], v11 offset:1536
    v_exp_f32 v186, v186
    v_exp_f32 v187, v187
    v_exp_f32 v188, v188
    v_exp_f32 v189, v189
    v_exp_f32 v190, v190
    v_exp_f32 v191, v191
    v_exp_f32 v192, v192
    v_exp_f32 v193, v193
    v_smfmac_f32_32x32x32_bf16 v[224:239], v[100:103], v[184:191], v10
    s_waitcnt lgkmcnt(0)
    ds_read_b128 v[92:95], v39 offset:23552
    v_cmp_lt_f32 vcc, s68, v216
    v_cmp_gt_f32 s[64:65], s69, v216
    s_and_b64 vcc, vcc, s[64:65]
    s_andn2_b64 vcc, exec, vcc
    s_cbranch_scc1 L_slow0
L_slowb0:
    v_rcp_f32 v216, v216
    s_add_u32 s64, s74, 0x3c000
    v_exp_f32 v194, v194
    v_exp_f32 v195, v195
    v_exp_f32 v196, v196
    v_mfma_f32_32x32x16_bf16 v[176:191], v[88:91], v[244:247], 0
    ds_read_b128 v[96:99], v11 offset:2048
    v_mul_f32 v208, v208, v216
    v_mul_f32 v209, v209, v216
    v_mul_f32 v210, v210, v216
    v_mul_f32 v211, v211, v216
    v_mul_f32 v212, v212, v216
    v_mul_f32 v213, v213, v216
    v_mul_f32 v214, v214, v216
    v_mul_f32 v215, v215, v216
    v_exp_f32 v197, v197
    v_exp_f32 v198, v198
    v_exp_f32 v199, v199
    v_exp_f32 v200, v200
    v_exp_f32 v201, v201
    v_smfmac_f32_32x32x32_bf16 v[224:239], v[104:107], v[192:199], v10
    ds_read_b128 v[100:103], v11 offset:2560
    v_cvt_pk_bf16_f32 v240, v208, v209
    v_cvt_pk_bf16_f32 v241, v210, v211
    v_cvt_pk_bf16_f32 v242, v212, v213
    v_cvt_pk_bf16_f32 v243, v214, v215
    s_cmp_lg_u32 s58, 0
    s_cbranch_scc1 L_sl_19
    buffer_store_dwordx4 v[240:243], v1, s[8:11], s64 offen
L_bk_20:
    v_exp_f32 v202, v202
    v_exp_f32 v203, v203
    v_exp_f32 v204, v204
    v_exp_f32 v205, v205
    v_exp_f32 v206, v206
    v_exp_f32 v207, v207
    v_exp_f32 v176, v176
    v_exp_f32 v177, v177
    v_smfmac_f32_32x32x32_bf16 v[224:239], v[108:111], v[200:207], v10
    s_waitcnt lgkmcnt(0)
    ds_read_b128 v[88:91], v39 offset:24576
    v_exp_f32 v178, v178
    v_exp_f32 v179, v179
    v_exp_f32 v180, v180
    v_mfma_f32_32x32x16_bf16 v[192:207], v[92:95], v[244:247], 0
    ds_read_b128 v[104:107], v11 offset:3072
    v_exp_f32 v181, v181
    v_exp_f32 v182, v182
    v_exp_f32 v183, v183
    v_exp_f32 v184, v184
    v_exp_f32 v185, v185
    v_smfmac_f32_32x32x32_bf16 v[224:239], v[96:99], v[176:183], v10
    ds_read_b128 v[108:111], v11 offset:3584
    v_exp_f32 v186, v186
    v_exp_f32 v187, v187
    v_exp_f32 v188, v188
    v_exp_f32 v189, v189
    v_exp_f32 v190, v190
    v_exp_f32 v191, v191
    v_exp_f32 v192, v192
    v_exp_f32 v193, v193
    v_smfmac_f32_32x32x32_bf16 v[224:239], v[100:103], v[184:191], v10
    s_waitcnt lgkmcnt(0)
    ds_read_b128 v[92:95], v39 offset:25600
    v_exp_f32 v194, v194
    v_exp_f32 v195, v195
    v_exp_f32 v196, v196
    v_mfma_f32_32x32x16_bf16 v[176:191], v[88:91], v[244:247], 0
    v_add_u32 v11, v38, v11
    ds_read_b128 v[96:99], v11 offset:0
    v_exp_f32 v197, v197
    v_exp_f32 v198, v198
    v_exp_f32 v199, v199
    v_exp_f32 v200, v200
    v_exp_f32 v201, v201
    v_smfmac_f32_32x32x32_bf16 v[224:239], v[104:107], v[192:199], v10
    ds_read_b128 v[100:103], v11 offset:512
    s_waitcnt vmcnt(0)
    s_cmp_lg_u32 s58, 0
    s_cbranch_scc1 L_sl_21
    buffer_store_dwordx2 v[4:5], v45, s[8:11], s77 offen
L_bk_22:
    v_exp_f32 v202, v202
    v_exp_f32 v203, v203
    v_exp_f32 v204, v204
    v_exp_f32 v205, v205
    v_exp_f32 v206, v206
    v_exp_f32 v207, v207
    v_exp_f32 v176, v176
    v_exp_f32 v177, v177
    v_smfmac_f32_32x32x32_bf16 v[224:239], v[108:111], v[200:207], v10
    s_waitcnt lgkmcnt(0)
    ds_read_b128 v[88:91], v39 offset:26624
    v_exp_f32 v178, v178
    v_exp_f32 v179, v179
    v_exp_f32 v180, v180
    v_mfma_f32_32x32x16_bf16 v[192:207], v[92:95], v[244:247], 0
    ds_read_b128 v[104:107], v11 offset:1024
    v_exp_f32 v181, v181
    v_exp_f32 v182, v182
    v_exp_f32 v183, v183
    v_exp_f32 v184, v184
    v_exp_f32 v185, v185
    v_smfmac_f32_32x32x32_bf16 v[224:239], v[96:99], v[176:183], v10
    ds_read_b128 v[108:111], v11 offset:1536
    v_exp_f32 v186, v186
    v_exp_f32 v187, v187
    v_exp_f32 v188, v188
    v_exp_f32 v189, v189
    v_exp_f32 v190, v190
    v_exp_f32 v191, v191
    v_exp_f32 v192, v192
    v_exp_f32 v193, v193
    v_smfmac_f32_32x32x32_bf16 v[224:239], v[100:103], v[184:191], v10
    s_waitcnt lgkmcnt(0)
    ds_read_b128 v[92:95], v39 offset:27648
    v_exp_f32 v194, v194
    v_exp_f32 v195, v195
    v_exp_f32 v196, v196
    v_mfma_f32_32x32x16_bf16 v[176:191], v[88:91], v[244:247], 0
    ds_read_b128 v[96:99], v11 offset:2048
    v_exp_f32 v197, v197
    v_exp_f32 v198, v198
    v_exp_f32 v199, v199
    v_exp_f32 v200, v200
    v_exp_f32 v201, v201
    v_smfmac_f32_32x32x32_bf16 v[224:239], v[104:107], v[192:199], v10
    ds_read_b128 v[100:103], v11 offset:2560
    v_exp_f32 v202, v202
    v_exp_f32 v203, v203
    v_exp_f32 v204, v204
    v_exp_f32 v205, v205
    v_exp_f32 v206, v206
    v_exp_f32 v207, v207
    v_exp_f32 v176, v176
    v_exp_f32 v177, v177
    v_smfmac_f32_32x32x32_bf16 v[224:239], v[108:111], v[200:207], v10
    s_waitcnt lgkmcnt(0)
    ds_read_b128 v[88:91], v39 offset:28672
    buffer_load_dwordx2 v[36:37], v46, s[8:11], s78 offen sc1
    v_exp_f32 v178, v178
    v_exp_f32 v179, v179
    v_exp_f32 v180, v180
    v_mfma_f32_32x32x16_bf16 v[192:207], v[92:95], v[244:247], 0
    ds_read_b128 v[104:107], v11 offset:3072
    v_exp_f32 v181, v181
    v_exp_f32 v182, v182
    v_exp_f32 v183, v183
    v_exp_f32 v184, v184
    v_exp_f32 v185, v185
    v_smfmac_f32_32x32x32_bf16 v[224:239], v[96:99], v[176:183], v10
    ds_read_b128 v[108:111], v11 offset:3584
    v_exp_f32 v186, v186
    v_exp_f32 v187, v187
    v_exp_f32 v188, v188
    v_exp_f32 v189, v189
    v_exp_f32 v190, v190
    v_exp_f32 v191, v191
    v_exp_f32 v192, v192
    v_exp_f32 v193, v193
    v_smfmac_f32_32x32x32_bf16 v[224:239], v[100:103], v[184:191], v10
    s_waitcnt lgkmcnt(0)
    ds_read_b128 v[92:95], v39 offset:29696
    v_exp_f32 v194, v194
    v_exp_f32 v195, v195
    v_exp_f32 v196, v196
    v_mfma_f32_32x32x16_bf16 v[176:191], v[88:91], v[244:247], 0
    v_add_u32 v11, v38, v11
    ds_read_b128 v[96:99], v11 offset:0
    v_exp_f32 v197, v197
    v_exp_f32 v198, v198
    v_exp_f32 v199, v199
    v_exp_f32 v200, v200
    v_exp_f32 v201, v201
    v_smfmac_f32_32x32x32_bf16 v[224:239], v[104:107], v[192:199], v10
    ds_read_b128 v[100:103], v11 offset:512
    v_exp_f32 v202, v202
    v_exp_f32 v203, v203
    v_exp_f32 v204, v204
    v_exp_f32 v205, v205
    v_exp_f32 v206, v206
    v_exp_f32 v207, v207
    v_exp_f32 v176, v176
    v_exp_f32 v177, v177
    v_smfmac_f32_32x32x32_bf16 v[224:239], v[108:111], v[200:207], v10
    s_waitcnt lgkmcnt(0)
    ds_read_b128 v[88:91], v39 offset:30720
    v_exp_f32 v178, v178
    v_exp_f32 v179, v179
    v_exp_f32 v180, v180
    v_mfma_f32_32x32x16_bf16 v[192:207], v[92:95], v[244:247], 0
    ds_read_b128 v[104:107], v11 offset:1024
    s_waitcnt vmcnt(0)
    v_cmp_ne_u64 vcc, s[60:61], v[36:37]
    s_cbranch_vccnz L_sp_23
L_sb_24:
    s_add_u32 s63, s75, 0x3c000
    buffer_load_dwordx4 v[208:211], v1, s[8:11], s63 offen sc1
    v_exp_f32 v181, v181
    v_exp_f32 v182, v182
    v_exp_f32 v183, v183
    v_exp_f32 v184, v184
    v_exp_f32 v185, v185
    v_smfmac_f32_32x32x32_bf16 v[224:239], v[96:99], v[176:183], v10
    ds_read_b128 v[108:111], v11 offset:1536
    buffer_load_dwordx4 v[212:215], v1, s[8:11], s63 offen offset:1024 sc1
    v_exp_f32 v186, v186
    v_exp_f32 v187, v187
    v_exp_f32 v188, v188
    v_exp_f32 v189, v189
    v_exp_f32 v190, v190
    v_exp_f32 v191, v191
    v_exp_f32 v192, v192
    v_exp_f32 v193, v193
    v_smfmac_f32_32x32x32_bf16 v[224:239], v[100:103], v[184:191], v10
    s_waitcnt lgkmcnt(0)
    ds_read_b128 v[92:95], v39 offset:31744
    buffer_load_dwordx4 v[216:219], v1, s[8:11], s63 offen offset:2048 sc1
    v_exp_f32 v194, v194
    v_exp_f32 v195, v195
    v_exp_f32 v196, v196
    v_mfma_f32_32x32x16_bf16 v[176:191], v[88:91], v[244:247], 0
    ds_read_b128 v[96:99], v11 offset:2048
    buffer_load_dwordx4 v[220:223], v1, s[8:11], s63 offen offset:3072 sc1
    v_exp_f32 v197, v197
    v_exp_f32 v198, v198
    v_exp_f32 v199, v199
    v_exp_f32 v200, v200
    v_exp_f32 v201, v201
    v_smfmac_f32_32x32x32_bf16 v[224:239], v[104:107], v[192:199], v10
    ds_read_b128 v[100:103], v11 offset:2560
    s_add_u32 s63, s75, 0x3d000
    buffer_load_dwordx4 v[248:251], v1, s[8:11], s63 offen sc1
    v_exp_f32 v202, v202
    v_exp_f32 v203, v203
    v_exp_f32 v204, v204
    v_exp_f32 v205, v205
    v_exp_f32 v206, v206
    v_exp_f32 v207, v207
    v_exp_f32 v176, v176
    v_exp_f32 v177, v177
    v_smfmac_f32_32x32x32_bf16 v[224:239], v[108:111], v[200:207], v10
    s_waitcnt lgkmcnt(0)
    buffer_load_dwordx4 v[252:255], v1, s[8:11], s63 offen offset:1024 sc1
    v_exp_f32 v178, v178
    v_exp_f32 v179, v179
    v_exp_f32 v180, v180
    v_mfma_f32_32x32x16_bf16 v[192:207], v[92:95], v[244:247], 0
    ds_read_b128 v[104:107], v11 offset:3072
    buffer_load_dwordx4 v[40:43], v1, s[8:11], s63 offen offset:2048 sc1
    v_exp_f32 v181, v181
    v_exp_f32 v182, v182
    v_exp_f32 v183, v183
    v_exp_f32 v184, v184
    v_exp_f32 v185, v185
    v_smfmac_f32_32x32x32_bf16 v[224:239], v[96:99], v[176:183], v10
    ds_read_b128 v[108:111], v11 offset:3584
    buffer_load_dwordx4 v[240:243], v1, s[8:11], s63 offen offset:3072 sc1
    v_exp_f32 v186, v186
    v_exp_f32 v187, v187
    v_exp_f32 v188, v188
    v_exp_f32 v189, v189
    v_exp_f32 v190, v190
    v_exp_f32 v191, v191
    v_exp_f32 v192, v192
    v_exp_f32 v193, v193
    v_smfmac_f32_32x32x32_bf16 v[224:239], v[100:103], v[184:191], v10
    s_waitcnt lgkmcnt(0)
    v_exp_f32 v194, v194
    v_exp_f32 v195, v195
    v_exp_f32 v196, v196
    v_exp_f32 v197, v197
    v_exp_f32 v198, v198
    v_exp_f32 v199, v199
    v_exp_f32 v200, v200
    v_exp_f32 v201, v201
    v_smfmac_f32_32x32x32_bf16 v[224:239], v[104:107], v[192:199], v10
    v_exp_f32 v202, v202
    v_exp_f32 v203, v203
    v_exp_f32 v204, v204
    v_exp_f32 v205, v205
    v_exp_f32 v206, v206
    v_exp_f32 v207, v207
    s_nop 1
    v_smfmac_f32_32x32x32_bf16 v[224:239], v[108:111], v[200:207], v10
L_post:
    s_waitcnt vmcnt(7)
    v_mfma_f32_32x32x16_bf16 v[48:63], v[112:115], v[208:211], v[48:63]
    v_mfma_f32_32x32x16_bf16 v[64:79], v[116:119], v[208:211], 0
    s_nop 1
    v_cmp_lt_f32 vcc, s68, v232
    v_cmp_gt_f32 s[64:65], s69, v232
    s_and_b64 vcc, vcc, s[64:65]
    s_andn2_b64 vcc, exec, vcc
    s_cbranch_scc1 L_slow1
L_slowb1:
    v_rcp_f32 v232, v232
    s_waitcnt vmcnt(6)
    v_mfma_f32_32x32x16_bf16 v[48:63], v[120:123], v[212:215], v[48:63]
    s_add_u32 s64, s74, 0x44000
    v_mul_f32 v224, v224, v232
    v_mul_f32 v225, v225, v232
    v_mul_f32 v226, v226, v232
    v_mul_f32 v227, v227, v232
    v_mul_f32 v228, v228, v232
    v_mfma_f32_32x32x16_bf16 v[64:79], v[124:127], v[212:215], v[64:79]
    v_mul_f32 v229, v229, v232
    v_mul_f32 v230, v230, v232
    v_mul_f32 v231, v231, v232
    v_cvt_pk_bf16_f32 v244, v224, v225
    v_cvt_pk_bf16_f32 v245, v226, v227
    v_cvt_pk_bf16_f32 v246, v228, v229
    s_waitcnt vmcnt(5)
    v_mfma_f32_32x32x16_bf16 v[48:63], v[128:131], v[216:219], v[48:63]
    v_cvt_pk_bf16_f32 v247, v230, v231
    s_cmp_lg_u32 s58, 0
    s_cbranch_scc1 L_sl_25
    buffer_store_dwordx4 v[244:247], v1, s[8:11], s64 offen
L_bk_26:
    v_mfma_f32_32x32x16_bf16 v[64:79], v[132:135], v[216:219], v[64:79]
    s_waitcnt vmcnt(5)
    v_mfma_f32_32x32x16_bf16 v[48:63], v[136:139], v[220:223], v[48:63]
    v_mfma_f32_32x32x16_bf16 v[64:79], v[140:143], v[220:223], v[64:79]
    s_barrier
    v_mov_b32 v88, 0
    v_mov_b32 v89, 0
    s_waitcnt vmcnt(4)
    v_mfma_f32_32x32x16_bf16 v[48:63], v[144:147], v[248:251], v[48:63]
    v_mov_b32 v90, 0
    v_mov_b32 v91, 0
    v_mov_b32 v92, 0
    v_mov_b32 v93, 0
    v_mov_b32 v94, 0
    v_mov_b32 v95, 0
    v_mfma_f32_32x32x16_bf16 v[64:79], v[148:151], v[248:251], v[64:79]
    s_waitcnt vmcnt(3)
    v_mfma_f32_32x32x16_bf16 v[48:63], v[152:155], v[252:255], v[48:63]
    v_mfma_f32_32x32x16_bf16 v[64:79], v[156:159], v[252:255], v[64:79]
    s_waitcnt vmcnt(2)
    v_mfma_f32_32x32x16_bf16 v[48:63], v[160:163], v[40:43], v[48:63]
    v_mfma_f32_32x32x16_bf16 v[64:79], v[164:167], v[40:43], v[64:79]
    s_waitcnt vmcnt(1)
    v_mfma_f32_32x32x16_bf16 v[48:63], v[168:171], v[240:243], v[48:63]
    s_waitcnt vmcnt(0)
    s_cmp_lg_u32 s58, 0
    s_cbranch_scc1 L_sl_27
    buffer_store_dwordx2 v[4:5], v45, s[8:11], s77 offen offset:8
L_bk_28:
    v_mfma_f32_32x32x16_bf16 v[64:79], v[172:175], v[240:243], v[64:79]
    s_nop 4
    ds_write_b128 v6, v[56:59] offset:0
    ds_write_b128 v6, v[60:63] offset:1024
    s_nop 4
    ds_write_b128 v6, v[64:67] offset:2048
    ds_write_b128 v6, v[68:71] offset:3072
    ds_write_b128 v6, v[72:75] offset:4096
    ds_write_b128 v6, v[76:79] offset:5120
    s_add_u32 s67, s81, 0x10000
    v_add_u32 v38, s67, v1
    s_add_u32 s67, s82, 0x10000
    v_add_u32 v39, s67, v1
    s_add_u32 s67, s83, 0x10000
    v_add_u32 v40, s67, v1
    s_add_u32 s67, s84, 0x10000
    v_add_u32 v41, s67, v1
    v_add_u32 v42, 0x20000, v1
    s_lshl_b32 s67, s56, 2
    v_add_u32 v43, s67, v42
    s_waitcnt lgkmcnt(0)
    s_barrier
    ds_read_b128 v[208:211], v7 offset:0
    ds_read_b128 v[212:215], v7 offset:1024
    ds_read_b128 v[216:219], v8 offset:0
    ds_read_b128 v[220:223], v8 offset:1024
    ds_read_b128 v[224:227], v9 offset:0
    ds_read_b128 v[228:231], v9 offset:1024
    buffer_load_dwordx2 v[36:37], v46, s[8:11], s78 offen offset:8 sc1
    s_waitcnt lgkmcnt(5)
    v_pk_add_f32 v[48:49], v[48:49], v[208:209]
    v_pk_add_f32 v[50:51], v[50:51], v[210:211]
    s_waitcnt lgkmcnt(4)
    v_pk_add_f32 v[52:53], v[52:53], v[212:213]
    v_pk_add_f32 v[54:55], v[54:55], v[214:215]
    s_waitcnt lgkmcnt(3)
    v_pk_add_f32 v[48:49], v[48:49], v[216:217]
    v_pk_add_f32 v[50:51], v[50:51], v[218:219]
    s_waitcnt lgkmcnt(2)
    v_pk_add_f32 v[52:53], v[52:53], v[220:221]
    v_pk_add_f32 v[54:55], v[54:55], v[222:223]
    s_waitcnt lgkmcnt(1)
    v_pk_add_f32 v[48:49], v[48:49], v[224:225]
    v_pk_add_f32 v[50:51], v[50:51], v[226:227]
    s_waitcnt lgkmcnt(0)
    v_pk_add_f32 v[52:53], v[52:53], v[228:229]
    v_pk_add_f32 v[54:55], v[54:55], v[230:231]
    v_cvt_pk_bf16_f32 v232, v48, v49
    v_cvt_pk_bf16_f32 v233, v50, v51
    v_cvt_pk_bf16_f32 v234, v52, v53
    v_cvt_pk_bf16_f32 v235, v54, v55
    s_add_u32 s64, s74, 0x10000
    s_cmp_lg_u32 s58, 0
    s_cbranch_scc1 L_sl_29
    buffer_store_dwordx4 v[232:235], v1, s[8:11], s64 offen
L_bk_30:
    v_pk_mul_f32 v[210:211], v[48:49], v[48:49]
    v_pk_add_f32 v[208:209], v[48:49], v[50:51]
    v_pk_fma_f32 v[210:211], v[50:51], v[50:51], v[210:211]
    v_pk_fma_f32 v[210:211], v[52:53], v[52:53], v[210:211]
    v_pk_add_f32 v[208:209], v[208:209], v[52:53]
    v_pk_fma_f32 v[210:211], v[54:55], v[54:55], v[210:211]
    v_pk_add_f32 v[208:209], v[208:209], v[54:55]
    v_add_f32 v208, v208, v209
    v_add_f32 v210, v210, v211
    s_add_u32 s64, s32, 0
    s_nop 0
    v_permlane32_swap_b32 v208, v210
    v_add_f32 v208, v208, v210
    s_cmp_lg_u32 s58, 0
    s_cbranch_scc1 L_sl_31
    buffer_store_dword v208, v1, s[8:11], s64 offen
L_bk_32:
    s_waitcnt vmcnt(2)
    v_cmp_ne_u64 vcc, s[60:61], v[36:37]
    s_cbranch_vccnz L_sp_33
L_sb_34:
    s_add_u32 s63, s75, 0x44000
    buffer_load_dwordx4 v[176:179], v1, s[8:11], s63 offen sc1
    buffer_load_dwordx4 v[180:183], v1, s[8:11], s63 offen offset:1024 sc1
    buffer_load_dwordx4 v[184:187], v1, s[8:11], s63 offen offset:2048 sc1
    buffer_load_dwordx4 v[188:191], v1, s[8:11], s63 offen offset:3072 sc1
    s_add_u32 s63, s75, 0x45000
    buffer_load_dwordx4 v[192:195], v1, s[8:11], s63 offen sc1
    buffer_load_dwordx4 v[196:199], v1, s[8:11], s63 offen offset:1024 sc1
    buffer_load_dwordx4 v[200:203], v1, s[8:11], s63 offen offset:2048 sc1
    buffer_load_dwordx4 v[204:207], v1, s[8:11], s63 offen offset:3072 sc1
    v_lshlrev_b32 v236, 16, v24
    v_and_b32 v237, 0xffff0000, v24
    v_pk_add_f32 v[48:49], v[48:49], v[236:237]
    v_lshlrev_b32 v236, 16, v25
    v_and_b32 v237, 0xffff0000, v25
    v_pk_add_f32 v[50:51], v[50:51], v[236:237]
    v_lshlrev_b32 v236, 16, v26
    v_and_b32 v237, 0xffff0000, v26
    v_pk_add_f32 v[52:53], v[52:53], v[236:237]
    v_lshlrev_b32 v236, 16, v27
    v_and_b32 v237, 0xffff0000, v27
    v_pk_add_f32 v[54:55], v[54:55], v[236:237]
    v_mov_b32 v56, 0
    v_mov_b32 v57, 0
    v_mov_b32 v58, 0
    v_mov_b32 v59, 0
    v_mov_b32 v60, 0
    v_mov_b32 v61, 0
    v_mov_b32 v62, 0
    v_mov_b32 v63, 0
    s_waitcnt vmcnt(8)
    s_cmp_lg_u32 s58, 0
    s_cbranch_scc1 L_sl_35
    buffer_store_dwordx2 v[4:5], v45, s[8:11], s77 offen offset:16
L_bk_36:
    s_waitcnt vmcnt(8)
    v_mfma_f32_32x32x16_bf16 v[80:95], v[112:115], v[176:179], v[80:95]
    v_mfma_f32_32x32x16_bf16 v[96:111], v[116:119], v[176:179], 0
    s_waitcnt vmcnt(7)
    v_mfma_f32_32x32x16_bf16 v[80:95], v[120:123], v[180:183], v[80:95]
    v_mfma_f32_32x32x16_bf16 v[96:111], v[124:127], v[180:183], v[96:111]
    s_waitcnt vmcnt(6)
    v_mfma_f32_32x32x16_bf16 v[80:95], v[128:131], v[184:187], v[80:95]
    v_mfma_f32_32x32x16_bf16 v[96:111], v[132:135], v[184:187], v[96:111]
    s_barrier
    s_waitcnt vmcnt(5)
    v_mfma_f32_32x32x16_bf16 v[80:95], v[136:139], v[188:191], v[80:95]
    buffer_load_dwordx2 v[36:37], v46, s[8:11], s78 offen offset:16 sc1
    v_mfma_f32_32x32x16_bf16 v[96:111], v[140:143], v[188:191], v[96:111]
    s_waitcnt vmcnt(5)
    v_mfma_f32_32x32x16_bf16 v[80:95], v[144:147], v[192:195], v[80:95]
    v_mfma_f32_32x32x16_bf16 v[96:111], v[148:151], v[192:195], v[96:111]
    s_waitcnt vmcnt(4)
    v_mfma_f32_32x32x16_bf16 v[80:95], v[152:155], v[196:199], v[80:95]
    v_mfma_f32_32x32x16_bf16 v[96:111], v[156:159], v[196:199], v[96:111]
    s_waitcnt vmcnt(3)
    v_mfma_f32_32x32x16_bf16 v[80:95], v[160:163], v[200:203], v[80:95]
    v_mfma_f32_32x32x16_bf16 v[96:111], v[164:167], v[200:203], v[96:111]
    s_waitcnt vmcnt(2)
    v_mfma_f32_32x32x16_bf16 v[80:95], v[168:171], v[204:207], v[80:95]
    v_mfma_f32_32x32x16_bf16 v[96:111], v[172:175], v[204:207], v[96:111]
    s_waitcnt vmcnt(0)
    v_cmp_ne_u64 vcc, s[60:61], v[36:37]
    s_cbranch_vccnz L_sp_37
L_sb_38:
    s_add_u32 m0, s75, 0x10000
    s_nop 0
    buffer_load_dwordx4 v1, s[8:11], m0 offen sc1 lds
    buffer_load_dwordx4 v1, s[8:11], m0 offen offset:1024 sc1 lds
    ds_write_b128 v6, v[88:91] offset:32768
    ds_write_b128 v6, v[92:95] offset:33792
    s_nop 2
    ds_write_b128 v6, v[96:99] offset:34816
    ds_write_b128 v6, v[100:103] offset:35840
    ds_write_b128 v6, v[104:107] offset:36864
    ds_write_b128 v6, v[108:111] offset:37888
    buffer_load_dwordx4 v1, s[8:11], m0 offen offset:2048 sc1 lds
    buffer_load_dwordx4 v1, s[8:11], m0 offen offset:3072 sc1 lds
    s_add_u32 m0, s75, 0x11000
    s_nop 0
    buffer_load_dwordx4 v1, s[8:11], m0 offen sc1 lds
    buffer_load_dwordx4 v1, s[8:11], m0 offen offset:1024 sc1 lds
    buffer_load_dwordx4 v1, s[8:11], m0 offen offset:2048 sc1 lds
    buffer_load_dwordx4 v1, s[8:11], m0 offen offset:3072 sc1 lds
    s_add_u32 s65, s33, 0
    buffer_load_dwordx4 v[64:67], v1, s[8:11], s65 offen sc1
    buffer_load_dwordx4 v[68:71], v1, s[8:11], s65 offen offset:1024 sc1
    s_waitcnt lgkmcnt(0)
    s_barrier
    ds_read_b128 v[208:211], v7 offset:32768
    ds_read_b128 v[212:215], v7 offset:33792
    ds_read_b128 v[216:219], v8 offset:32768
    ds_read_b128 v[220:223], v8 offset:33792
    ds_read_b128 v[224:227], v9 offset:32768
    ds_read_b128 v[228:231], v9 offset:33792
    s_waitcnt lgkmcnt(5)
    v_pk_add_f32 v[80:81], v[80:81], v[208:209]
    v_pk_add_f32 v[82:83], v[82:83], v[210:211]
    s_waitcnt lgkmcnt(4)
    v_pk_add_f32 v[84:85], v[84:85], v[212:213]
    v_pk_add_f32 v[86:87], v[86:87], v[214:215]
    s_waitcnt lgkmcnt(3)
    v_pk_add_f32 v[80:81], v[80:81], v[216:217]
    v_pk_add_f32 v[82:83], v[82:83], v[218:219]
    s_waitcnt lgkmcnt(2)
    v_pk_add_f32 v[84:85], v[84:85], v[220:221]
    v_pk_add_f32 v[86:87], v[86:87], v[222:223]
    s_waitcnt lgkmcnt(1)
    v_pk_add_f32 v[80:81], v[80:81], v[224:225]
    v_pk_add_f32 v[82:83], v[82:83], v[226:227]
    s_waitcnt lgkmcnt(0)
    v_pk_add_f32 v[84:85], v[84:85], v[228:229]
    v_pk_add_f32 v[86:87], v[86:87], v[230:231]
    v_cvt_pk_bf16_f32 v236, v80, v81
    v_cvt_pk_bf16_f32 v237, v82, v83
    v_cvt_pk_bf16_f32 v238, v84, v85
    v_cvt_pk_bf16_f32 v239, v86, v87
    s_add_u32 s64, s74, 0x18000
    s_cmp_lg_u32 s58, 0
    s_cbranch_scc1 L_sl_39
    buffer_store_dwordx4 v[236:239], v1, s[8:11], s64 offen
L_bk_40:
    v_pk_mul_f32 v[210:211], v[80:81], v[80:81]
    v_pk_add_f32 v[208:209], v[80:81], v[82:83]
    v_pk_fma_f32 v[210:211], v[82:83], v[82:83], v[210:211]
    v_pk_fma_f32 v[210:211], v[84:85], v[84:85], v[210:211]
    v_pk_add_f32 v[208:209], v[208:209], v[84:85]
    v_pk_fma_f32 v[210:211], v[86:87], v[86:87], v[210:211]
    v_pk_add_f32 v[208:209], v[208:209], v[86:87]
    v_add_f32 v208, v208, v209
    v_add_f32 v210, v210, v211
    s_add_u32 s64, s32, 8192
    s_nop 0
    v_permlane32_swap_b32 v208, v210
    v_add_f32 v208, v208, v210
    s_cmp_lg_u32 s58, 0
    s_cbranch_scc1 L_sl_41
    buffer_store_dword v208, v1, s[8:11], s64 offen
L_bk_42:
    s_waitcnt vmcnt(8)
    ds_read_b128 v[208:211], v38 offset:0
    ds_read_b128 v[212:215], v38 offset:1024
    ds_read_b128 v[216:219], v38 offset:2048
    ds_read_b128 v[220:223], v38 offset:3072
    s_waitcnt vmcnt(4)
    ds_read_b128 v[224:227], v38 offset:4096
    ds_read_b128 v[228:231], v38 offset:5120
    ds_read_b128 v[232:235], v38 offset:6144
    ds_read_b128 v[236:239], v38 offset:7168
    s_waitcnt lgkmcnt(7)
    v_mfma_f32_32x32x16_bf16 v[176:191], a[0:3], v[208:211], 0
    s_waitcnt vmcnt(2)
    v_add_f32 v64, v64, v68
    v_add_f32 v65, v65, v69
    v_add_f32 v66, v66, v70
    v_add_f32 v67, v67, v71
    s_waitcnt lgkmcnt(6)
    v_mfma_f32_32x32x16_bf16 v[176:191], a[8:11], v[212:215], v[176:191]
    v_add_f32 v64, v64, v65
    v_add_f32 v66, v66, v67
    v_add_f32 v64, v64, v66
    ds_write_b32 v43, v64 offset:0
    s_waitcnt lgkmcnt(6)
    v_mfma_f32_32x32x16_bf16 v[176:191], a[16:19], v[216:219], v[176:191]
    s_waitcnt lgkmcnt(5)
    v_mfma_f32_32x32x16_bf16 v[176:191], a[24:27], v[220:223], v[176:191]
    s_waitcnt lgkmcnt(0)
    s_barrier
    ds_read_b128 v[64:67], v42 offset:0
    ds_read_b128 v[208:211], v39 offset:0
    ds_read_b128 v[212:215], v39 offset:1024
    v_mfma_f32_32x32x16_bf16 v[176:191], a[32:35], v[224:227], v[176:191]
    ds_read_b128 v[216:219], v39 offset:2048
    ds_read_b128 v[220:223], v39 offset:3072
    v_mfma_f32_32x32x16_bf16 v[176:191], a[40:43], v[228:231], v[176:191]
    ds_read_b128 v[224:227], v39 offset:4096
    v_mfma_f32_32x32x16_bf16 v[176:191], a[48:51], v[232:235], v[176:191]
    s_waitcnt vmcnt(0)
    s_cmp_lg_u32 s58, 0
    s_cbranch_scc1 L_sl_43
    buffer_store_dwordx2 v[4:5], v45, s[8:11], s77 offen offset:24
L_bk_44:
    ds_read_b128 v[228:231], v39 offset:5120
    v_mfma_f32_32x32x16_bf16 v[176:191], a[56:59], v[236:239], v[176:191]
    s_add_u32 s62, s89, 0x0
    buffer_load_dwordx4 v[112:115], v2, s[4:7], s62 offen sc1
    ds_read_b128 v[232:235], v39 offset:6144
    s_waitcnt lgkmcnt(3)
    v_mfma_f32_32x32x16_bf16 v[176:191], a[64:67], v[208:211], v[176:191]
    ds_read_b128 v[236:239], v39 offset:7168
    v_add_f32 v64, v64, v65
    v_add_f32 v66, v66, v67
    v_mfma_f32_32x32x16_bf16 v[176:191], a[72:75], v[212:215], v[176:191]
    s_add_u32 s63, s90, 0x0
    buffer_load_dwordx4 v[116:119], v2, s[4:7], s63 offen sc1
    ds_read_b128 v[208:211], v40 offset:0
    v_add_f32 v64, v64, v66
    v_mfma_f32_32x32x16_bf16 v[176:191], a[80:83], v[216:219], v[176:191]
    ds_read_b128 v[212:215], v40 offset:1024
    v_mul_f32 v72, 0x3b000000, v64
    v_mul_f32 v64, 0x3b000000, v64
    s_nop 1
    v_permlane32_swap_b32 v72, v64
    v_fma_f32 v64, -v72, v72, v64
    v_max_f32 v64, 0, v64
    v_mfma_f32_32x32x16_bf16 v[176:191], a[88:91], v[220:223], v[176:191]
    buffer_load_dwordx4 v[120:123], v2, s[4:7], s62 offen offset:1024 sc1
    ds_read_b128 v[216:219], v40 offset:2048
    s_waitcnt lgkmcnt(3)
    v_mfma_f32_32x32x16_bf16 v[176:191], a[96:99], v[224:227], v[176:191]
    ds_read_b128 v[220:223], v40 offset:3072
    v_add_f32 v64, 0x3727c5ac, v64
    v_rsq_f32 v73, v64
    s_nop 0
    v_mul_f32 v74, v64, v73
    v_mfma_f32_32x32x16_bf16 v[176:191], a[104:107], v[228:231], v[176:191]
    buffer_load_dwordx4 v[124:127], v2, s[4:7], s63 offen offset:1024 sc1
    ds_read_b128 v[224:227], v40 offset:4096
    v_cvt_pk_bf16_f32 v76, -v72, -v72
    v_lshlrev_b32 v64, 16, v76
    v_mfma_f32_32x32x16_bf16 v[176:191], a[112:115], v[232:235], v[176:191]
    ds_read_b128 v[228:231], v40 offset:5120
    v_add_f32 v64, v64, v72
    v_cvt_pk_bf16_f32 v77, -v64, v74
    v_and_b32 v65, 0xffff0000, v77
    v_sub_f32 v65, v74, v65
    v_mfma_f32_32x32x16_bf16 v[176:191], a[120:123], v[236:239], v[176:191]
    s_add_u32 s62, s89, 0x1000
    buffer_load_dwordx4 v[128:131], v2, s[4:7], s62 offen sc1
    ds_read_b128 v[232:235], v40 offset:6144
    s_waitcnt lgkmcnt(3)
    v_mfma_f32_32x32x16_bf16 v[176:191], a[128:131], v[208:211], v[176:191]
    ds_read_b128 v[236:239], v40 offset:7168
    v_cvt_pk_bf16_f32 v79, -v64, v65
    v_mov_b32 v78, v76
    v_mul_f32 v64, v73, v73
    v_mul_f32 v72, 0xc0135761, v73
    v_mfma_f32_32x32x16_bf16 v[176:191], a[136:139], v[212:215], v[176:191]
    ds_read_b128 v[208:211], v41 offset:0
    v_mul_f32 v64, 0x3d372713, v64
    v_mul_f32 v73, v64, v72
    v_mov_b32 v88, 0
    v_mov_b32 v89, 0
    v_mfma_f32_32x32x16_bf16 v[176:191], a[144:147], v[216:219], v[176:191]
    s_add_u32 s63, s90, 0x1000
    buffer_load_dwordx4 v[132:135], v2, s[4:7], s63 offen sc1
    ds_read_b128 v[212:215], v41 offset:1024
    v_mov_b32 v90, 0
    v_mfma_f32_32x32x16_bf16 v[176:191], a[152:155], v[220:223], v[176:191]
    buffer_load_dwordx2 v[36:37], v46, s[8:11], s78 offen offset:24 sc1
    ds_read_b128 v[216:219], v41 offset:2048
    s_waitcnt lgkmcnt(3)
    v_mov_b32 v91, 0
    v_mfma_f32_32x32x16_bf16 v[176:191], a[160:163], v[224:227], v[176:191]
    buffer_load_dwordx4 v[136:139], v2, s[4:7], s62 offen offset:1024 sc1
    ds_read_b128 v[220:223], v41 offset:3072
    v_mov_b32 v92, 0
    v_mov_b32 v93, 0
    v_mfma_f32_32x32x16_bf16 v[176:191], a[168:171], v[228:231], v[176:191]
    ds_read_b128 v[224:227], v41 offset:4096
    v_mov_b32 v94, 0
    v_mov_b32 v95, 0
    v_lshlrev_b32 v240, 16, v24
    v_add_f32 v80, v80, v240
    v_mfma_f32_32x32x16_bf16 v[176:191], a[176:179], v[232:235], v[176:191]
    buffer_load_dwordx4 v[140:143], v2, s[4:7], s63 offen offset:1024 sc1
    ds_read_b128 v[228:231], v41 offset:5120
    v_and_b32 v240, 0xffff0000, v24
    v_mfma_f32_32x32x16_bf16 v[176:191], a[184:187], v[236:239], v[176:191]
    ds_read_b128 v[232:235], v41 offset:6144
    s_waitcnt lgkmcnt(3)
    v_add_f32 v81, v81, v240
    v_lshlrev_b32 v240, 16, v25
    v_add_f32 v82, v82, v240
    v_and_b32 v240, 0xffff0000, v25
    v_mfma_f32_32x32x16_bf16 v[176:191], a[192:195], v[208:211], v[176:191]
    s_add_u32 s62, s89, 0x2000
    buffer_load_dwordx4 v[144:147], v2, s[4:7], s62 offen sc1
    ds_read_b128 v[236:239], v41 offset:7168
    v_add_f32 v83, v83, v240
    v_mfma_f32_32x32x16_bf16 v[176:191], a[200:203], v[212:215], v[176:191]
    ds_read_b128 v[208:211], v38 offset:0
    v_lshlrev_b32 v240, 16, v26
    v_add_f32 v84, v84, v240
    v_and_b32 v240, 0xffff0000, v26
    v_add_f32 v85, v85, v240
    v_mfma_f32_32x32x16_bf16 v[176:191], a[208:211], v[216:219], v[176:191]
    s_add_u32 s63, s90, 0x2000
    buffer_load_dwordx4 v[148:151], v2, s[4:7], s63 offen sc1
    ds_read_b128 v[212:215], v38 offset:1024
    v_lshlrev_b32 v240, 16, v27
    v_mfma_f32_32x32x16_bf16 v[176:191], a[216:219], v[220:223], v[176:191]
    ds_read_b128 v[216:219], v38 offset:2048
    s_waitcnt lgkmcnt(3)
    v_add_f32 v86, v86, v240
    v_and_b32 v240, 0xffff0000, v27
    v_add_f32 v87, v87, v240
    v_mfma_f32_32x32x16_bf16 v[176:191], a[224:227], v[224:227], v[176:191]
    ds_read_b128 v[220:223], v38 offset:3072
    v_mfma_f32_32x32x16_bf16 v[176:191], a[232:235], v[228:231], v[176:191]
    s_waitcnt vmcnt(4)
    v_cmp_ne_u64 vcc, s[60:61], v[36:37]
    s_cbranch_vccnz L_sp_45
L_sb_46:
    s_add_u32 m0, s75, 0x18000
    s_nop 0
    buffer_load_dwordx4 v1, s[8:11], m0 offen sc1 lds
    ds_read_b128 v[224:227], v38 offset:4096
    v_mfma_f32_32x32x16_bf16 v[176:191], a[240:243], v[232:235], v[176:191]
    buffer_load_dwordx4 v1, s[8:11], m0 offen offset:1024 sc1 lds
    ds_read_b128 v[228:231], v38 offset:5120
    v_mfma_f32_32x32x16_bf16 v[176:191], a[248:251], v[236:239], v[176:191]
    buffer_load_dwordx4 v1, s[8:11], m0 offen offset:2048 sc1 lds
    ds_read_b128 v[232:235], v38 offset:6144
    v_mfma_f32_32x32x16_bf16 v[176:191], v[28:31], v[76:79], v[176:191]
    s_waitcnt lgkmcnt(3)
    v_mfma_f32_32x32x16_bf16 v[192:207], a[4:7], v[208:211], 0
    buffer_load_dwordx4 v1, s[8:11], m0 offen offset:3072 sc1 lds
    ds_read_b128 v[236:239], v38 offset:7168
    v_mfma_f32_32x32x16_bf16 v[192:207], a[12:15], v[212:215], v[192:207]
    s_add_u32 m0, s75, 0x19000
    s_nop 0
    buffer_load_dwordx4 v1, s[8:11], m0 offen sc1 lds
    ds_read_b128 v[208:211], v39 offset:0
    v_mul_f32 v240, v176, v176
    v_mul_f32 v241, v177, v177
    v_mul_f32 v242, v178, v178
    v_mul_f32 v243, v179, v179
    v_fma_f32 v240, v240, v73, v72
    v_mfma_f32_32x32x16_bf16 v[192:207], a[20:23], v[216:219], v[192:207]
    ds_read_b128 v[212:215], v39 offset:1024
    v_fma_f32 v241, v241, v73, v72
    v_fma_f32 v242, v242, v73, v72
    v_fma_f32 v243, v243, v73, v72
    v_mul_f32 v240, v240, v176
    v_mul_f32 v241, v241, v177
    v_mul_f32 v242, v242, v178
    v_mul_f32 v243, v243, v179
    v_mfma_f32_32x32x16_bf16 v[192:207], a[28:31], v[220:223], v[192:207]
    buffer_load_dwordx4 v1, s[8:11], m0 offen offset:1024 sc1 lds
    ds_read_b128 v[216:219], v39 offset:2048
    s_waitcnt lgkmcnt(3)
    v_exp_f32 v240, v240
    v_exp_f32 v241, v241
    v_exp_f32 v242, v242
    v_mfma_f32_32x32x16_bf16 v[192:207], a[36:39], v[224:227], v[192:207]
    buffer_load_dwordx4 v1, s[8:11], m0 offen offset:2048 sc1 lds
    ds_read_b128 v[220:223], v39 offset:3072
    v_exp_f32 v243, v243
    v_fma_f32 v240, v240, v74, v74
    v_fma_f32 v241, v241, v74, v74
    v_fma_f32 v242, v242, v74, v74
    v_mfma_f32_32x32x16_bf16 v[192:207], a[44:47], v[228:231], v[192:207]
    buffer_load_dwordx4 v1, s[8:11], m0 offen offset:3072 sc1 lds
    ds_read_b128 v[224:227], v39 offset:4096
    v_fma_f32 v243, v243, v74, v74
    v_rcp_f32 v240, v240
    v_rcp_f32 v241, v241
    v_mfma_f32_32x32x16_bf16 v[192:207], a[52:55], v[232:235], v[192:207]
    ds_read_b128 v[228:231], v39 offset:5120
    v_rcp_f32 v242, v242
    v_rcp_f32 v243, v243
    v_mul_f32 v176, v176, v240
    v_mul_f32 v177, v177, v241
    v_mul_f32 v178, v178, v242
    v_mul_f32 v179, v179, v243
    v_mfma_f32_32x32x16_bf16 v[192:207], a[60:63], v[236:239], v[192:207]
    s_add_u32 s65, s33, 8192
    buffer_load_dwordx4 v[96:99], v1, s[8:11], s65 offen sc1
    ds_read_b128 v[232:235], v39 offset:6144
    s_waitcnt lgkmcnt(3)
    v_cvt_pk_bf16_f32 v248, v176, v177
    v_cvt_pk_bf16_f32 v249, v178, v179
    v_mul_f32 v244, v180, v180
    v_mul_f32 v245, v181, v181
    v_mfma_f32_32x32x16_bf16 v[192:207], a[68:71], v[208:211], v[192:207]
    buffer_load_dwordx4 v[100:103], v1, s[8:11], s65 offen offset:1024 sc1
    ds_read_b128 v[236:239], v39 offset:7168
    v_mul_f32 v246, v182, v182
    v_mul_f32 v247, v183, v183
    v_fma_f32 v244, v244, v73, v72
    v_fma_f32 v245, v245, v73, v72
    v_fma_f32 v246, v246, v73, v72
    v_mfma_f32_32x32x16_bf16 v[192:207], a[76:79], v[212:215], v[192:207]
    ds_read_b128 v[208:211], v40 offset:0
    v_fma_f32 v247, v247, v73, v72
    v_mul_f32 v244, v244, v180
    v_mul_f32 v245, v245, v181
    v_mul_f32 v246, v246, v182
    v_mul_f32 v247, v247, v183
    v_exp_f32 v244, v244
    v_mfma_f32_32x32x16_bf16 v[192:207], a[84:87], v[216:219], v[192:207]
    ds_read_b128 v[212:215], v40 offset:1024
    v_exp_f32 v245, v245
    v_exp_f32 v246, v246
    v_exp_f32 v247, v247
    v_fma_f32 v244, v244, v74, v74
    v_fma_f32 v245, v245, v74, v74
    v_fma_f32 v246, v246, v74, v74
    v_mfma_f32_32x32x16_bf16 v[192:207], a[92:95], v[220:223], v[192:207]
    ds_read_b128 v[216:219], v40 offset:2048
    s_waitcnt lgkmcnt(3)
    v_fma_f32 v247, v247, v74, v74
    v_rcp_f32 v244, v244
    v_rcp_f32 v245, v245
    v_rcp_f32 v246, v246
    v_mfma_f32_32x32x16_bf16 v[192:207], a[100:103], v[224:227], v[192:207]
    buffer_load_dwordx4 v[152:155], v2, s[4:7], s62 offen offset:1024 sc1
    ds_read_b128 v[220:223], v40 offset:3072
    v_rcp_f32 v247, v247
    v_mul_f32 v180, v180, v244
    v_mul_f32 v181, v181, v245
    v_mul_f32 v182, v182, v246
    v_mfma_f32_32x32x16_bf16 v[192:207], a[108:111], v[228:231], v[192:207]
    ds_read_b128 v[224:227], v40 offset:4096
    v_mul_f32 v183, v183, v247
    v_cvt_pk_bf16_f32 v250, v180, v181
    v_cvt_pk_bf16_f32 v251, v182, v183
    s_cmp_lg_u32 s58, 0
    s_cbranch_scc1 L_sl_47
    buffer_store_dwordx4 v[248:251], v1, s[8:11], s91 offen
L_bk_48:
    v_mfma_f32_32x32x16_bf16 v[192:207], a[116:119], v[232:235], v[192:207]
    ds_read_b128 v[228:231], v40 offset:5120
    v_mul_f32 v240, v184, v184
    v_mul_f32 v241, v185, v185
    v_mul_f32 v242, v186, v186
    v_mul_f32 v243, v187, v187
    v_fma_f32 v240, v240, v73, v72
    v_fma_f32 v241, v241, v73, v72
    v_fma_f32 v242, v242, v73, v72
    v_fma_f32 v243, v243, v73, v72
    v_mfma_f32_32x32x16_bf16 v[192:207], a[124:127], v[236:239], v[192:207]
    buffer_load_dwordx4 v[156:159], v2, s[4:7], s63 offen offset:1024 sc1
    ds_read_b128 v[232:235], v40 offset:6144
    s_waitcnt lgkmcnt(3)
    v_mul_f32 v240, v240, v184
    v_mul_f32 v241, v241, v185
    v_mul_f32 v242, v242, v186
    v_mul_f32 v243, v243, v187
    v_mfma_f32_32x32x16_bf16 v[192:207], a[132:135], v[208:211], v[192:207]
    ds_read_b128 v[236:239], v40 offset:7168
    v_exp_f32 v240, v240
    v_exp_f32 v241, v241
    v_exp_f32 v242, v242
    v_exp_f32 v243, v243
    v_mfma_f32_32x32x16_bf16 v[192:207], a[140:143], v[212:215], v[192:207]
    ds_read_b128 v[208:211], v41 offset:0
    v_fma_f32 v240, v240, v74, v74
    v_fma_f32 v241, v241, v74, v74
    v_fma_f32 v242, v242, v74, v74
    v_fma_f32 v243, v243, v74, v74
    v_rcp_f32 v240, v240
    v_rcp_f32 v241, v241
    v_mfma_f32_32x32x16_bf16 v[192:207], a[148:151], v[216:219], v[192:207]
    s_add_u32 s62, s89, 0x3000
    buffer_load_dwordx4 v[160:163], v2, s[4:7], s62 offen sc1
    ds_read_b128 v[212:215], v41 offset:1024
    v_rcp_f32 v242, v242
    v_rcp_f32 v243, v243
    v_mul_f32 v184, v184, v240
    v_mfma_f32_32x32x16_bf16 v[192:207], a[156:159], v[220:223], v[192:207]
    ds_read_b128 v[216:219], v41 offset:2048
    s_waitcnt lgkmcnt(3)
    v_mul_f32 v185, v185, v241
    v_mul_f32 v186, v186, v242
    v_mul_f32 v187, v187, v243
    v_cvt_pk_bf16_f32 v252, v184, v185
    v_cvt_pk_bf16_f32 v253, v186, v187
    v_mul_f32 v244, v188, v188
    v_mul_f32 v245, v189, v189
    v_mfma_f32_32x32x16_bf16 v[192:207], a[164:167], v[224:227], v[192:207]
    ds_read_b128 v[220:223], v41 offset:3072
    v_mul_f32 v246, v190, v190
    v_mul_f32 v247, v191, v191
    v_fma_f32 v244, v244, v73, v72
    v_fma_f32 v245, v245, v73, v72
    v_fma_f32 v246, v246, v73, v72
    v_fma_f32 v247, v247, v73, v72
    v_mul_f32 v244, v244, v188
    v_mul_f32 v245, v245, v189
    v_mfma_f32_32x32x16_bf16 v[192:207], a[172:175], v[228:231], v[192:207]
    ds_read_b128 v[224:227], v41 offset:4096
    v_mul_f32 v246, v246, v190
    v_mul_f32 v247, v247, v191
    v_exp_f32 v244, v244
    v_exp_f32 v245, v245
    v_exp_f32 v246, v246
    v_mfma_f32_32x32x16_bf16 v[192:207], a[180:183], v[232:235], v[192:207]
    s_waitcnt vmcnt(6)
    s_waitcnt vmcnt(4)
    v_add_f32 v96, v96, v100
    v_add_f32 v97, v97, v101
    v_add_f32 v98, v98, v102
    v_add_f32 v99, v99, v103
    s_add_u32 s63, s90, 0x3000
    buffer_load_dwordx4 v[164:167], v2, s[4:7], s63 offen sc1
    ds_read_b128 v[228:231], v41 offset:5120
    v_mfma_f32_32x32x16_bf16 v[192:207], a[188:191], v[236:239], v[192:207]
    v_add_f32 v96, v96, v97
    v_add_f32 v98, v98, v99
    v_add_f32 v96, v96, v98
    ds_write_b32 v43, v96 offset:1024
    ds_read_b128 v[232:235], v41 offset:6144
    s_waitcnt lgkmcnt(4)
    v_mfma_f32_32x32x16_bf16 v[192:207], a[196:199], v[208:211], v[192:207]
    ds_read_b128 v[236:239], v41 offset:7168
    v_exp_f32 v247, v247
    v_fma_f32 v244, v244, v74, v74
    v_fma_f32 v245, v245, v74, v74
    v_fma_f32 v246, v246, v74, v74
    v_fma_f32 v247, v247, v74, v74
    v_rcp_f32 v244, v244
    v_mfma_f32_32x32x16_bf16 v[192:207], a[204:207], v[212:215], v[192:207]
    buffer_load_dwordx4 v[168:171], v2, s[4:7], s62 offen offset:1024 sc1
    ds_read_b128 v[208:211], v38 offset:32768
    v_rcp_f32 v245, v245
    v_rcp_f32 v246, v246
    v_rcp_f32 v247, v247
    v_mfma_f32_32x32x16_bf16 v[192:207], a[212:215], v[216:219], v[192:207]
    s_waitcnt lgkmcnt(3)
    s_barrier
    ds_read_b128 v[96:99], v42 offset:1024
    ds_read_b128 v[212:215], v38 offset:33792
    v_mul_f32 v188, v188, v244
    v_mul_f32 v189, v189, v245
    v_mul_f32 v190, v190, v246
    v_mul_f32 v191, v191, v247
    v_mfma_f32_32x32x16_bf16 v[192:207], a[220:223], v[220:223], v[192:207]
    ds_read_b128 v[216:219], v38 offset:34816
    s_waitcnt lgkmcnt(4)
    v_cvt_pk_bf16_f32 v254, v188, v189
    v_cvt_pk_bf16_f32 v255, v190, v191
    s_cmp_lg_u32 s58, 0
    s_cbranch_scc1 L_sl_49
    buffer_store_dwordx4 v[252:255], v1, s[8:11], s91 offen offset:1024
L_bk_50:
    v_mfma_f32_32x32x16_bf16 v[192:207], a[228:231], v[224:227], v[192:207]
    buffer_load_dwordx4 v[172:175], v2, s[4:7], s63 offen offset:1024 sc1
    ds_read_b128 v[220:223], v38 offset:35840
    s_waitcnt lgkmcnt(3)
    v_add_f32 v96, v96, v97
    v_add_f32 v98, v98, v99
    v_add_f32 v96, v96, v98
    v_mul_f32 v104, 0x3b000000, v96
    v_mfma_f32_32x32x16_bf16 v[192:207], a[236:239], v[228:231], v[192:207]
    ds_read_b128 v[224:227], v38 offset:36864
    v_mul_f32 v96, 0x3b000000, v96
    s_nop 1
    v_permlane32_swap_b32 v104, v96
    v_fma_f32 v96, -v104, v104, v96
    v_max_f32 v96, 0, v96
    v_mfma_f32_32x32x16_bf16 v[192:207], a[244:247], v[232:235], v[192:207]
    ds_read_b128 v[228:231], v38 offset:37888
    v_add_f32 v96, 0x3727c5ac, v96
    v_rsq_f32 v105, v96
    s_nop 0
    v_mul_f32 v106, v96, v105
    v_cvt_pk_bf16_f32 v108, -v104, -v104
    v_mfma_f32_32x32x16_bf16 v[192:207], a[252:255], v[236:239], v[192:207]
    ds_read_b128 v[232:235], v38 offset:38912
    v_lshlrev_b32 v96, 16, v108
    v_add_f32 v96, v96, v104
    v_cvt_pk_bf16_f32 v109, -v96, v106
    v_and_b32 v97, 0xffff0000, v109
    v_mfma_f32_32x32x16_bf16 v[192:207], v[32:35], v[76:79], v[192:207]
    s_waitcnt lgkmcnt(3)
    v_sub_f32 v97, v106, v97
    v_cvt_pk_bf16_f32 v111, -v96, v97
    v_mov_b32 v110, v108
    v_mul_f32 v96, v105, v105
    v_mfma_f32_32x32x16_bf16 v[176:191], a[0:3], v[208:211], 0
    buffer_load_dwordx4 a[0:3], v2, s[4:7], s62 offen offset:2048 sc1
    ds_read_b128 v[236:239], v38 offset:39936
    v_mul_f32 v104, 0xc0135761, v105
    v_mul_f32 v96, 0x3d372713, v96
    v_mul_f32 v105, v96, v104
    v_mfma_f32_32x32x16_bf16 v[176:191], a[8:11], v[212:215], v[176:191]
    buffer_load_dwordx4 a[8:11], v2, s[4:7], s63 offen offset:2048 sc1
    ds_read_b128 v[208:211], v39 offset:32768
    v_mul_f32 v240, v192, v192
    v_mul_f32 v241, v193, v193
    v_mul_f32 v242, v194, v194
    v_mul_f32 v243, v195, v195
    v_fma_f32 v240, v240, v73, v72
    v_fma_f32 v241, v241, v73, v72
    v_mfma_f32_32x32x16_bf16 v[176:191], a[16:19], v[216:219], v[176:191]
    ds_read_b128 v[212:215], v39 offset:33792
    v_fma_f32 v242, v242, v73, v72
    v_fma_f32 v243, v243, v73, v72
    v_mul_f32 v240, v240, v192
    v_mul_f32 v241, v241, v193
    v_mul_f32 v242, v242, v194
    v_mul_f32 v243, v243, v195
    v_exp_f32 v240, v240
    v_mfma_f32_32x32x16_bf16 v[176:191], a[24:27], v[220:223], v[176:191]
    buffer_load_dwordx4 a[16:19], v2, s[4:7], s62 offen offset:3072 sc1
    ds_read_b128 v[216:219], v39 offset:34816
    s_waitcnt lgkmcnt(3)
    v_exp_f32 v241, v241
    v_exp_f32 v242, v242
    v_mfma_f32_32x32x16_bf16 v[176:191], a[32:35], v[224:227], v[176:191]
    buffer_load_dwordx4 a[24:27], v2, s[4:7], s63 offen offset:3072 sc1
    ds_read_b128 v[220:223], v39 offset:35840
    v_exp_f32 v243, v243
    v_fma_f32 v240, v240, v74, v74
    v_fma_f32 v241, v241, v74, v74
    v_fma_f32 v242, v242, v74, v74
    v_fma_f32 v243, v243, v74, v74
    v_mfma_f32_32x32x16_bf16 v[176:191], a[40:43], v[228:231], v[176:191]
    s_waitcnt vmcnt(5)
    s_cmp_lg_u32 s58, 0
    s_cbranch_scc1 L_sl_51
    buffer_store_dwordx2 v[4:5], v45, s[8:11], s77 offen offset:32
L_bk_52:
    ds_read_b128 v[224:227], v39 offset:36864
    v_rcp_f32 v240, v240
    v_mfma_f32_32x32x16_bf16 v[176:191], a[48:51], v[232:235], v[176:191]
    s_add_u32 s62, s89, 0x4000
    buffer_load_dwordx4 a[32:35], v2, s[4:7], s62 offen offset:2048 sc1
    ds_read_b128 v[228:231], v39 offset:37888
    v_rcp_f32 v241, v241
    v_rcp_f32 v242, v242
    v_rcp_f32 v243, v243
    v_mfma_f32_32x32x16_bf16 v[176:191], a[56:59], v[236:239], v[176:191]
    ds_read_b128 v[232:235], v39 offset:38912
    s_waitcnt lgkmcnt(3)
    v_mul_f32 v192, v192, v240
    v_mul_f32 v193, v193, v241
    v_mul_f32 v194, v194, v242
    v_mul_f32 v195, v195, v243
    v_cvt_pk_bf16_f32 v248, v192, v193
    v_cvt_pk_bf16_f32 v249, v194, v195
    v_mfma_f32_32x32x16_bf16 v[176:191], a[64:67], v[208:211], v[176:191]
    s_add_u32 s63, s90, 0x4000
    buffer_load_dwordx4 a[40:43], v2, s[4:7], s63 offen offset:2048 sc1
    ds_read_b128 v[236:239], v39 offset:39936
    v_mul_f32 v244, v196, v196
    v_mul_f32 v245, v197, v197
    v_mul_f32 v246, v198, v198
    v_mul_f32 v247, v199, v199
    v_fma_f32 v244, v244, v73, v72
    v_mfma_f32_32x32x16_bf16 v[176:191], a[72:75], v[212:215], v[176:191]
    buffer_load_dwordx4 a[48:51], v2, s[4:7], s62 offen offset:3072 sc1
    ds_read_b128 v[208:211], v40 offset:32768
    v_fma_f32 v245, v245, v73, v72
    v_fma_f32 v246, v246, v73, v72
    v_fma_f32 v247, v247, v73, v72
    v_mul_f32 v244, v244, v196
    v_mul_f32 v245, v245, v197
    v_mul_f32 v246, v246, v198
    v_mfma_f32_32x32x16_bf16 v[176:191], a[80:83], v[216:219], v[176:191]
    ds_read_b128 v[212:215], v40 offset:33792
    v_mul_f32 v247, v247, v199
    v_exp_f32 v244, v244
    v_exp_f32 v245, v245
    v_exp_f32 v246, v246
    v_mfma_f32_32x32x16_bf16 v[176:191], a[88:91], v[220:223], v[176:191]
    buffer_load_dwordx4 a[56:59], v2, s[4:7], s63 offen offset:3072 sc1
    ds_read_b128 v[216:219], v40 offset:34816
    s_waitcnt lgkmcnt(3)
    v_exp_f32 v247, v247
    v_fma_f32 v244, v244, v74, v74
    v_fma_f32 v245, v245, v74, v74
    v_fma_f32 v246, v246, v74, v74
    v_fma_f32 v247, v247, v74, v74
    v_mfma_f32_32x32x16_bf16 v[176:191], a[96:99], v[224:227], v[176:191]
    ds_read_b128 v[220:223], v40 offset:35840
    v_rcp_f32 v244, v244
    v_rcp_f32 v245, v245
    v_rcp_f32 v246, v246
    v_rcp_f32 v247, v247
    v_mfma_f32_32x32x16_bf16 v[176:191], a[104:107], v[228:231], v[176:191]
    s_add_u32 s62, s89, 0x5000
    buffer_load_dwordx4 a[64:67], v2, s[4:7], s62 offen offset:2048 sc1
    ds_read_b128 v[224:227], v40 offset:36864
    v_mul_f32 v196, v196, v244
    v_mul_f32 v197, v197, v245
    v_mul_f32 v198, v198, v246
    v_mul_f32 v199, v199, v247
    v_cvt_pk_bf16_f32 v250, v196, v197
    v_mfma_f32_32x32x16_bf16 v[176:191], a[112:115], v[232:235], v[176:191]
    s_add_u32 s63, s90, 0x5000
    buffer_load_dwordx4 a[72:75], v2, s[4:7], s63 offen offset:2048 sc1
    ds_read_b128 v[228:231], v40 offset:37888
    v_cvt_pk_bf16_f32 v251, v198, v199
    s_cmp_lg_u32 s58, 0
    s_cbranch_scc1 L_sl_53
    buffer_store_dwordx4 v[248:251], v1, s[8:11], s92 offen
L_bk_54:
    v_mfma_f32_32x32x16_bf16 v[176:191], a[120:123], v[236:239], v[176:191]
    ds_read_b128 v[232:235], v40 offset:38912
    s_waitcnt lgkmcnt(3)
    v_mul_f32 v240, v200, v200
    v_mul_f32 v241, v201, v201
    v_mul_f32 v242, v202, v202
    v_mul_f32 v243, v203, v203
    v_fma_f32 v240, v240, v73, v72
    v_fma_f32 v241, v241, v73, v72
    v_mfma_f32_32x32x16_bf16 v[176:191], a[128:131], v[208:211], v[176:191]
    buffer_load_dwordx4 a[80:83], v2, s[4:7], s62 offen offset:3072 sc1
    ds_read_b128 v[236:239], v40 offset:39936
    v_fma_f32 v242, v242, v73, v72
    v_fma_f32 v243, v243, v73, v72
    v_mul_f32 v240, v240, v200
    v_mul_f32 v241, v241, v201
    v_mul_f32 v242, v242, v202
    v_mfma_f32_32x32x16_bf16 v[176:191], a[136:139], v[212:215], v[176:191]
    ds_read_b128 v[208:211], v41 offset:32768
    v_mul_f32 v243, v243, v203
    v_exp_f32 v240, v240
    v_exp_f32 v241, v241
    v_exp_f32 v242, v242
    v_exp_f32 v243, v243
    v_mfma_f32_32x32x16_bf16 v[176:191], a[144:147], v[216:219], v[176:191]
    buffer_load_dwordx4 a[88:91], v2, s[4:7], s63 offen offset:3072 sc1
    ds_read_b128 v[212:215], v41 offset:33792
    v_fma_f32 v240, v240, v74, v74
    v_fma_f32 v241, v241, v74, v74
    v_fma_f32 v242, v242, v74, v74
    v_fma_f32 v243, v243, v74, v74
    v_rcp_f32 v240, v240
    v_mfma_f32_32x32x16_bf16 v[176:191], a[152:155], v[220:223], v[176:191]
    s_add_u32 s62, s89, 0x6000
    buffer_load_dwordx4 a[96:99], v2, s[4:7], s62 offen offset:2048 sc1
    ds_read_b128 v[216:219], v41 offset:34816
    s_waitcnt lgkmcnt(3)
    v_rcp_f32 v241, v241
    v_rcp_f32 v242, v242
    v_mfma_f32_32x32x16_bf16 v[176:191], a[160:163], v[224:227], v[176:191]
    ds_read_b128 v[220:223], v41 offset:35840
    v_rcp_f32 v243, v243
    v_mul_f32 v200, v200, v240
    v_mul_f32 v201, v201, v241
    v_mul_f32 v202, v202, v242
    v_mul_f32 v203, v203, v243
    v_cvt_pk_bf16_f32 v252, v200, v201
    v_mfma_f32_32x32x16_bf16 v[176:191], a[168:171], v[228:231], v[176:191]
    s_add_u32 s63, s90, 0x6000
    buffer_load_dwordx4 a[104:107], v2, s[4:7], s63 offen offset:2048 sc1
    ds_read_b128 v[224:227], v41 offset:36864
    v_cvt_pk_bf16_f32 v253, v202, v203
    v_mul_f32 v244, v204, v204
    v_mul_f32 v245, v205, v205
    v_mul_f32 v246, v206, v206
    v_mul_f32 v247, v207, v207
    v_mfma_f32_32x32x16_bf16 v[176:191], a[176:179], v[232:235], v[176:191]
    ds_read_b128 v[228:231], v41 offset:37888
    v_fma_f32 v244, v244, v73, v72
    v_fma_f32 v245, v245, v73, v72
    v_fma_f32 v246, v246, v73, v72
    v_fma_f32 v247, v247, v73, v72
    v_mul_f32 v244, v244, v204
    v_mul_f32 v245, v245, v205
    v_mul_f32 v246, v246, v206
    v_mul_f32 v247, v247, v207
    v_mfma_f32_32x32x16_bf16 v[176:191], a[184:187], v[236:239], v[176:191]
    buffer_load_dwordx4 a[112:115], v2, s[4:7], s62 offen offset:3072 sc1
    ds_read_b128 v[232:235], v41 offset:38912
    s_waitcnt lgkmcnt(3)
    v_exp_f32 v244, v244
    v_exp_f32 v245, v245
    v_exp_f32 v246, v246
    v_mfma_f32_32x32x16_bf16 v[176:191], a[192:195], v[208:211], v[176:191]
    buffer_load_dwordx4 a[120:123], v2, s[4:7], s63 offen offset:3072 sc1
    ds_read_b128 v[236:239], v41 offset:39936
    v_exp_f32 v247, v247
    v_fma_f32 v244, v244, v74, v74
    v_fma_f32 v245, v245, v74, v74
    v_fma_f32 v246, v246, v74, v74
    v_mfma_f32_32x32x16_bf16 v[176:191], a[200:203], v[212:215], v[176:191]
    ds_read_b128 v[208:211], v38 offset:32768
    v_fma_f32 v247, v247, v74, v74
    v_rcp_f32 v244, v244
    v_rcp_f32 v245, v245
    v_rcp_f32 v246, v246
    v_mfma_f32_32x32x16_bf16 v[176:191], a[208:211], v[216:219], v[176:191]
    s_add_u32 s62, s89, 0x0
    buffer_load_dwordx4 a[128:131], v2, s[4:7], s62 offen offset:2048 sc1
    ds_read_b128 v[212:215], v38 offset:33792
    v_rcp_f32 v247, v247
    v_mul_f32 v204, v204, v244
    v_mul_f32 v205, v205, v245
    v_mul_f32 v206, v206, v246
    v_mul_f32 v207, v207, v247
    v_mfma_f32_32x32x16_bf16 v[176:191], a[216:219], v[220:223], v[176:191]
    ds_read_b128 v[216:219], v38 offset:34816
    s_waitcnt lgkmcnt(3)
    v_cvt_pk_bf16_f32 v254, v204, v205
    v_cvt_pk_bf16_f32 v255, v206, v207
    s_cmp_lg_u32 s58, 0
    s_cbranch_scc1 L_sl_55
    buffer_store_dwordx4 v[252:255], v1, s[8:11], s92 offen offset:1024
L_bk_56:
    v_mfma_f32_32x32x16_bf16 v[176:191], a[224:227], v[224:227], v[176:191]
    s_add_u32 s63, s90, 0x0
    buffer_load_dwordx4 a[136:139], v2, s[4:7], s63 offen offset:2048 sc1
    ds_read_b128 v[220:223], v38 offset:35840
    v_mfma_f32_32x32x16_bf16 v[176:191], a[232:235], v[228:231], v[176:191]
    buffer_load_dwordx4 a[144:147], v2, s[4:7], s62 offen offset:3072 sc1
    ds_read_b128 v[224:227], v38 offset:36864
    v_mfma_f32_32x32x16_bf16 v[176:191], a[240:243], v[232:235], v[176:191]
    ds_read_b128 v[228:231], v38 offset:37888
    v_mfma_f32_32x32x16_bf16 v[176:191], a[248:251], v[236:239], v[176:191]
    buffer_load_dwordx4 a[152:155], v2, s[4:7], s63 offen offset:3072 sc1
    ds_read_b128 v[232:235], v38 offset:38912
    v_mfma_f32_32x32x16_bf16 v[176:191], v[28:31], v[108:111], v[176:191]
    s_waitcnt lgkmcnt(3)
    v_mfma_f32_32x32x16_bf16 v[192:207], a[4:7], v[208:211], 0
    s_add_u32 s62, s89, 0x1000
    buffer_load_dwordx4 a[160:163], v2, s[4:7], s62 offen offset:2048 sc1
    ds_read_b128 v[236:239], v38 offset:39936
    v_mfma_f32_32x32x16_bf16 v[192:207], a[12:15], v[212:215], v[192:207]
    s_add_u32 s63, s90, 0x1000
    buffer_load_dwordx4 a[168:171], v2, s[4:7], s63 offen offset:2048 sc1
    ds_read_b128 v[208:211], v39 offset:32768
    v_mul_f32 v240, v176, v176
    v_mul_f32 v241, v177, v177
    v_mul_f32 v242, v178, v178
    v_mul_f32 v243, v179, v179
    v_fma_f32 v240, v240, v105, v104
    v_mfma_f32_32x32x16_bf16 v[192:207], a[20:23], v[216:219], v[192:207]
    ds_read_b128 v[212:215], v39 offset:33792
    v_fma_f32 v241, v241, v105, v104
    v_fma_f32 v242, v242, v105, v104
    v_fma_f32 v243, v243, v105, v104
    v_mul_f32 v240, v240, v176
    v_mul_f32 v241, v241, v177
    v_mul_f32 v242, v242, v178
    v_mul_f32 v243, v243, v179
    v_mfma_f32_32x32x16_bf16 v[192:207], a[28:31], v[220:223], v[192:207]
    buffer_load_dwordx4 a[176:179], v2, s[4:7], s62 offen offset:3072 sc1
    buffer_load_dwordx2 v[36:37], v46, s[8:11], s78 offen offset:32 sc1
    ds_read_b128 v[216:219], v39 offset:34816
    s_waitcnt lgkmcnt(3)
    v_exp_f32 v240, v240
    v_mfma_f32_32x32x16_bf16 v[192:207], a[36:39], v[224:227], v[192:207]
    buffer_load_dwordx4 a[184:187], v2, s[4:7], s63 offen offset:3072 sc1
    ds_read_b128 v[220:223], v39 offset:35840
    v_exp_f32 v241, v241
    v_exp_f32 v242, v242
    v_mfma_f32_32x32x16_bf16 v[192:207], a[44:47], v[228:231], v[192:207]
    s_waitcnt vmcnt(8)
    s_cmp_lg_u32 s58, 0
    s_cbranch_scc1 L_sl_57
    buffer_store_dwordx2 v[4:5], v45, s[8:11], s77 offen offset:40
L_bk_58:
    ds_read_b128 v[224:227], v39 offset:36864
    v_exp_f32 v243, v243
    v_fma_f32 v240, v240, v106, v106
    v_mfma_f32_32x32x16_bf16 v[192:207], a[52:55], v[232:235], v[192:207]
    ds_read_b128 v[228:231], v39 offset:37888
    v_fma_f32 v241, v241, v106, v106
    v_fma_f32 v242, v242, v106, v106
    v_fma_f32 v243, v243, v106, v106
    v_rcp_f32 v240, v240
    v_rcp_f32 v241, v241
    v_mfma_f32_32x32x16_bf16 v[192:207], a[60:63], v[236:239], v[192:207]
    ds_read_b128 v[232:235], v39 offset:38912
    s_waitcnt lgkmcnt(3)
    v_rcp_f32 v242, v242
    v_rcp_f32 v243, v243
    v_mul_f32 v176, v176, v240
    v_mul_f32 v177, v177, v241
    v_mul_f32 v178, v178, v242
    v_mfma_f32_32x32x16_bf16 v[192:207], a[68:71], v[208:211], v[192:207]
    ds_read_b128 v[236:239], v39 offset:39936
    v_mul_f32 v179, v179, v243
    v_cvt_pk_bf16_f32 v248, v176, v177
    v_cvt_pk_bf16_f32 v249, v178, v179
    v_mul_f32 v244, v180, v180
    v_mul_f32 v245, v181, v181
    v_mul_f32 v246, v182, v182
    v_mul_f32 v247, v183, v183
    v_mfma_f32_32x32x16_bf16 v[192:207], a[76:79], v[212:215], v[192:207]
    ds_read_b128 v[208:211], v40 offset:32768
    v_fma_f32 v244, v244, v105, v104
    v_fma_f32 v245, v245, v105, v104
    v_fma_f32 v246, v246, v105, v104
    v_fma_f32 v247, v247, v105, v104
    v_mul_f32 v244, v244, v180
    v_mul_f32 v245, v245, v181
    v_mul_f32 v246, v246, v182
    v_mul_f32 v247, v247, v183
    v_mfma_f32_32x32x16_bf16 v[192:207], a[84:87], v[216:219], v[192:207]
    ds_read_b128 v[212:215], v40 offset:33792
    v_exp_f32 v244, v244
    v_exp_f32 v245, v245
    v_exp_f32 v246, v246
    v_exp_f32 v247, v247
    v_mfma_f32_32x32x16_bf16 v[192:207], a[92:95], v[220:223], v[192:207]
    ds_read_b128 v[216:219], v40 offset:34816
    s_waitcnt lgkmcnt(3)
    v_fma_f32 v244, v244, v106, v106
    v_fma_f32 v245, v245, v106, v106
    v_fma_f32 v246, v246, v106, v106
    v_fma_f32 v247, v247, v106, v106
    v_rcp_f32 v244, v244
    v_mfma_f32_32x32x16_bf16 v[192:207], a[100:103], v[224:227], v[192:207]
    ds_read_b128 v[220:223], v40 offset:35840
    v_rcp_f32 v245, v245
    v_rcp_f32 v246, v246
    v_rcp_f32 v247, v247
    v_mul_f32 v180, v180, v244
    v_mul_f32 v181, v181, v245
    v_mfma_f32_32x32x16_bf16 v[192:207], a[108:111], v[228:231], v[192:207]
    ds_read_b128 v[224:227], v40 offset:36864
    v_mul_f32 v182, v182, v246
    v_mul_f32 v183, v183, v247
    v_cvt_pk_bf16_f32 v250, v180, v181
    v_cvt_pk_bf16_f32 v251, v182, v183
    s_add_u32 s64, s91, 0x1c000
    s_cmp_lg_u32 s58, 0
    s_cbranch_scc1 L_sl_59
    buffer_store_dwordx4 v[248:251], v1, s[8:11], s64 offen
L_bk_60:
    v_mfma_f32_32x32x16_bf16 v[192:207], a[116:119], v[232:235], v[192:207]
    ds_read_b128 v[228:231], v40 offset:37888
    v_mul_f32 v240, v184, v184
    v_mul_f32 v241, v185, v185
    v_mul_f32 v242, v186, v186
    v_mul_f32 v243, v187, v187
    v_fma_f32 v240, v240, v105, v104
    v_fma_f32 v241, v241, v105, v104
    v_mfma_f32_32x32x16_bf16 v[192:207], a[124:127], v[236:239], v[192:207]
    s_waitcnt vmcnt(3)
    v_cmp_ne_u64 vcc, s[60:61], v[36:37]
    s_cbranch_vccnz L_sp_61
L_sb_62:
    s_add_u32 s66, s93, 0x0
    buffer_load_dwordx4 a[192:195], v1, s[8:11], s66 offen sc1
    ds_read_b128 v[232:235], v40 offset:38912
    s_waitcnt lgkmcnt(3)
    v_mfma_f32_32x32x16_bf16 v[192:207], a[132:135], v[208:211], v[192:207]
    buffer_load_dwordx4 a[200:203], v1, s[8:11], s66 offen offset:1024 sc1
    ds_read_b128 v[236:239], v40 offset:39936
    v_fma_f32 v242, v242, v105, v104
    v_fma_f32 v243, v243, v105, v104
    v_mul_f32 v240, v240, v184
    v_mul_f32 v241, v241, v185
    v_mul_f32 v242, v242, v186
    v_mfma_f32_32x32x16_bf16 v[192:207], a[140:143], v[212:215], v[192:207]
    ds_read_b128 v[208:211], v41 offset:32768
    v_mul_f32 v243, v243, v187
    v_exp_f32 v240, v240
    v_exp_f32 v241, v241
    v_exp_f32 v242, v242
    v_mfma_f32_32x32x16_bf16 v[192:207], a[148:151], v[216:219], v[192:207]
    s_add_u32 s66, s93, 0x1000
    buffer_load_dwordx4 a[208:211], v1, s[8:11], s66 offen sc1
    ds_read_b128 v[212:215], v41 offset:33792
    v_exp_f32 v243, v243
    v_fma_f32 v240, v240, v106, v106
    v_fma_f32 v241, v241, v106, v106
    v_fma_f32 v242, v242, v106, v106
    v_mfma_f32_32x32x16_bf16 v[192:207], a[156:159], v[220:223], v[192:207]
    ds_read_b128 v[216:219], v41 offset:34816
    s_waitcnt lgkmcnt(3)
    v_fma_f32 v243, v243, v106, v106
    v_rcp_f32 v240, v240
    v_rcp_f32 v241, v241
    v_rcp_f32 v242, v242
    v_mfma_f32_32x32x16_bf16 v[192:207], a[164:167], v[224:227], v[192:207]
    buffer_load_dwordx4 a[216:219], v1, s[8:11], s66 offen offset:1024 sc1
    ds_read_b128 v[220:223], v41 offset:35840
    v_rcp_f32 v243, v243
    v_mul_f32 v184, v184, v240
    v_mul_f32 v185, v185, v241
    v_mul_f32 v186, v186, v242
    v_mfma_f32_32x32x16_bf16 v[192:207], a[172:175], v[228:231], v[192:207]
    ds_read_b128 v[224:227], v41 offset:36864
    v_mul_f32 v187, v187, v243
    v_cvt_pk_bf16_f32 v252, v184, v185
    v_cvt_pk_bf16_f32 v253, v186, v187
    v_mul_f32 v244, v188, v188
    v_mul_f32 v245, v189, v189
    v_mul_f32 v246, v190, v190
    v_mul_f32 v247, v191, v191
    v_mfma_f32_32x32x16_bf16 v[192:207], a[180:183], v[232:235], v[192:207]
    s_add_u32 s66, s93, 0x2000
    buffer_load_dwordx4 a[224:227], v1, s[8:11], s66 offen sc1
    ds_read_b128 v[228:231], v41 offset:37888
    v_fma_f32 v244, v244, v105, v104
    v_fma_f32 v245, v245, v105, v104
    v_fma_f32 v246, v246, v105, v104
    v_fma_f32 v247, v247, v105, v104
    v_mul_f32 v244, v244, v188
    v_mfma_f32_32x32x16_bf16 v[192:207], a[188:191], v[236:239], v[192:207]
    ds_read_b128 v[232:235], v41 offset:38912
    s_waitcnt lgkmcnt(3)
    v_mul_f32 v245, v245, v189
    v_mul_f32 v246, v246, v190
    v_mul_f32 v247, v247, v191
    v_exp_f32 v244, v244
    v_exp_f32 v245, v245
    v_mfma_f32_32x32x16_bf16 v[192:207], a[196:199], v[208:211], v[192:207]
    buffer_load_dwordx4 a[232:235], v1, s[8:11], s66 offen offset:1024 sc1
    ds_read_b128 v[236:239], v41 offset:39936
    v_exp_f32 v246, v246
    v_exp_f32 v247, v247
    v_mfma_f32_32x32x16_bf16 v[192:207], a[204:207], v[212:215], v[192:207]
    v_fma_f32 v244, v244, v106, v106
    v_fma_f32 v245, v245, v106, v106
    v_fma_f32 v246, v246, v106, v106
    v_fma_f32 v247, v247, v106, v106
    v_rcp_f32 v244, v244
    v_rcp_f32 v245, v245
    v_rcp_f32 v246, v246
    v_mfma_f32_32x32x16_bf16 v[192:207], a[212:215], v[216:219], v[192:207]
    s_add_u32 s66, s93, 0x3000
    buffer_load_dwordx4 a[240:243], v1, s[8:11], s66 offen sc1
    v_rcp_f32 v247, v247
    v_mul_f32 v188, v188, v244
    v_mul_f32 v189, v189, v245
    v_mul_f32 v190, v190, v246
    v_mfma_f32_32x32x16_bf16 v[192:207], a[220:223], v[220:223], v[192:207]
    s_waitcnt lgkmcnt(0)
    v_mul_f32 v191, v191, v247
    v_cvt_pk_bf16_f32 v254, v188, v189
    v_cvt_pk_bf16_f32 v255, v190, v191
    s_add_u32 s64, s91, 0x1c000
    s_cmp_lg_u32 s58, 0
    s_cbranch_scc1 L_sl_63
    buffer_store_dwordx4 v[252:255], v1, s[8:11], s64 offen offset:1024
L_bk_64:
    v_mfma_f32_32x32x16_bf16 v[192:207], a[228:231], v[224:227], v[192:207]
    buffer_load_dwordx4 a[248:251], v1, s[8:11], s66 offen offset:1024 sc1
    v_mfma_f32_32x32x16_bf16 v[192:207], a[236:239], v[228:231], v[192:207]
    v_mfma_f32_32x32x16_bf16 v[192:207], a[244:247], v[232:235], v[192:207]
    buffer_load_dwordx4 a[4:7], v1, s[8:11], s66 offen offset:2048 sc1
    v_mfma_f32_32x32x16_bf16 v[192:207], a[252:255], v[236:239], v[192:207]
    buffer_load_dwordx4 a[12:15], v1, s[8:11], s66 offen offset:3072 sc1
    v_mfma_f32_32x32x16_bf16 v[192:207], v[32:35], v[108:111], v[192:207]
    s_waitcnt vmcnt(10)
    v_mfma_f32_32x32x16_bf16 v[48:63], v[112:115], a[192:195], v[48:63]
    s_add_u32 s66, s93, 0x4000
    buffer_load_dwordx4 a[20:23], v1, s[8:11], s66 offen offset:2048 sc1
    s_lshl_b32 s67, s75, 1
    v_add_u32 v38, s67, v1
    v_mfma_f32_32x32x16_bf16 v[64:79], v[116:119], a[192:195], 0
    buffer_load_dwordx2 v[36:37], v46, s[8:11], s78 offen offset:40 sc1
    v_mul_f32 v240, v192, v192
    v_mul_f32 v241, v193, v193
    v_mul_f32 v242, v194, v194
    v_mul_f32 v243, v195, v195
    v_fma_f32 v240, v240, v105, v104
    v_fma_f32 v241, v241, v105, v104
    s_waitcnt vmcnt(11)
    v_mfma_f32_32x32x16_bf16 v[48:63], v[120:123], a[200:203], v[48:63]
    buffer_load_dwordx4 a[28:31], v1, s[8:11], s66 offen offset:3072 sc1
    v_fma_f32 v242, v242, v105, v104
    v_fma_f32 v243, v243, v105, v104
    v_mul_f32 v240, v240, v192
    v_mul_f32 v241, v241, v193
    v_mul_f32 v242, v242, v194
    v_mul_f32 v243, v243, v195
    v_mfma_f32_32x32x16_bf16 v[64:79], v[124:127], a[200:203], v[64:79]
    v_exp_f32 v240, v240
    v_exp_f32 v241, v241
    v_exp_f32 v242, v242
    v_exp_f32 v243, v243
    v_fma_f32 v240, v240, v106, v106
    s_waitcnt vmcnt(11)
    v_mfma_f32_32x32x16_bf16 v[48:63], v[128:131], a[208:211], v[48:63]
    s_add_u32 s66, s93, 0x5000
    buffer_load_dwordx4 a[36:39], v1, s[8:11], s66 offen offset:2048 sc1
    v_fma_f32 v241, v241, v106, v106
    v_fma_f32 v242, v242, v106, v106
    v_fma_f32 v243, v243, v106, v106
    v_rcp_f32 v240, v240
    v_mfma_f32_32x32x16_bf16 v[64:79], v[132:135], a[208:211], v[64:79]
    s_waitcnt vmcnt(7)
    s_cmp_lg_u32 s58, 0
    s_cbranch_scc1 L_sl_65
    buffer_store_dwordx2 v[4:5], v45, s[8:11], s77 offen offset:48
L_bk_66:
    v_rcp_f32 v241, v241
    v_rcp_f32 v242, v242
    v_mfma_f32_32x32x16_bf16 v[48:63], v[136:139], a[216:219], v[48:63]
    buffer_load_dwordx4 a[44:47], v1, s[8:11], s66 offen offset:3072 sc1
    v_rcp_f32 v243, v243
    v_mul_f32 v192, v192, v240
    v_mul_f32 v193, v193, v241
    v_mul_f32 v194, v194, v242
    v_mfma_f32_32x32x16_bf16 v[64:79], v[140:143], a[216:219], v[64:79]
    v_mul_f32 v195, v195, v243
    v_cvt_pk_bf16_f32 v248, v192, v193
    v_cvt_pk_bf16_f32 v249, v194, v195
    v_mul_f32 v244, v196, v196
    v_mul_f32 v245, v197, v197
    v_mul_f32 v246, v198, v198
    v_mul_f32 v247, v199, v199
    v_fma_f32 v244, v244, v105, v104
    v_fma_f32 v245, v245, v105, v104
    v_mfma_f32_32x32x16_bf16 v[48:63], v[144:147], a[224:227], v[48:63]
    s_add_u32 s66, s93, 0x6000
    buffer_load_dwordx4 a[52:55], v1, s[8:11], s66 offen offset:2048 sc1
    v_fma_f32 v246, v246, v105, v104
    v_fma_f32 v247, v247, v105, v104
    v_mul_f32 v244, v244, v196
    v_mul_f32 v245, v245, v197
    v_mul_f32 v246, v246, v198
    v_mul_f32 v247, v247, v199
    v_mfma_f32_32x32x16_bf16 v[64:79], v[148:151], a[224:227], v[64:79]
    v_exp_f32 v244, v244
    v_exp_f32 v245, v245
    v_exp_f32 v246, v246
    v_exp_f32 v247, v247
    v_mfma_f32_32x32x16_bf16 v[48:63], v[152:155], a[232:235], v[48:63]
    buffer_load_dwordx4 a[60:63], v1, s[8:11], s66 offen offset:3072 sc1
    v_fma_f32 v244, v244, v106, v106
    v_fma_f32 v245, v245, v106, v106
    v_fma_f32 v246, v246, v106, v106
    v_fma_f32 v247, v247, v106, v106
    v_rcp_f32 v244, v244
    v_mfma_f32_32x32x16_bf16 v[64:79], v[156:159], a[232:235], v[64:79]
    v_rcp_f32 v245, v245
    v_rcp_f32 v246, v246
    v_rcp_f32 v247, v247
    v_mul_f32 v196, v196, v244
    v_mul_f32 v197, v197, v245
    v_mul_f32 v198, v198, v246
    v_mfma_f32_32x32x16_bf16 v[48:63], v[160:163], a[240:243], v[48:63]
    s_waitcnt vmcnt(6)
    v_cmp_ne_u64 vcc, s[60:61], v[36:37]
    s_cbranch_vccnz L_sp_67
L_sb_68:
    s_add_u32 s66, s93, 0x0
    buffer_load_dwordx4 a[68:71], v1, s[8:11], s66 offen offset:2048 sc1
    v_mul_f32 v199, v199, v247
    v_cvt_pk_bf16_f32 v250, v196, v197
    v_mfma_f32_32x32x16_bf16 v[64:79], v[164:167], a[240:243], v[64:79]
    v_cvt_pk_bf16_f32 v251, v198, v199
    s_add_u32 s64, s92, 0x1c000
    s_cmp_lg_u32 s58, 0
    s_cbranch_scc1 L_sl_69
    buffer_store_dwordx4 v[248:251], v1, s[8:11], s64 offen
L_bk_70:
    v_mul_f32 v240, v200, v200
    v_mul_f32 v241, v201, v201
    v_mfma_f32_32x32x16_bf16 v[48:63], v[168:171], a[248:251], v[48:63]
    buffer_load_dwordx4 a[76:79], v1, s[8:11], s66 offen offset:3072 sc1
    v_mul_f32 v242, v202, v202
    v_mul_f32 v243, v203, v203
    v_fma_f32 v240, v240, v105, v104
    v_fma_f32 v241, v241, v105, v104
    v_fma_f32 v242, v242, v105, v104
    v_fma_f32 v243, v243, v105, v104
    v_mul_f32 v240, v240, v200
    v_mfma_f32_32x32x16_bf16 v[64:79], v[172:175], a[248:251], v[64:79]
    v_mul_f32 v241, v241, v201
    v_mul_f32 v242, v242, v202
    v_mul_f32 v243, v243, v203
    v_exp_f32 v240, v240
    v_exp_f32 v241, v241
    v_exp_f32 v242, v242
    v_mfma_f32_32x32x16_bf16 v[48:63], a[0:3], a[4:7], v[48:63]
    s_add_u32 s66, s93, 0x1000
    buffer_load_dwordx4 a[84:87], v1, s[8:11], s66 offen offset:2048 sc1
    v_exp_f32 v243, v243
    v_fma_f32 v240, v240, v106, v106
    v_fma_f32 v241, v241, v106, v106
    v_fma_f32 v242, v242, v106, v106
    v_mfma_f32_32x32x16_bf16 v[64:79], a[8:11], a[4:7], v[64:79]
    v_fma_f32 v243, v243, v106, v106
    v_rcp_f32 v240, v240
    v_rcp_f32 v241, v241
    v_rcp_f32 v242, v242
    v_rcp_f32 v243, v243
    v_mfma_f32_32x32x16_bf16 v[48:63], a[16:19], a[12:15], v[48:63]
    buffer_load_dwordx4 a[92:95], v1, s[8:11], s66 offen offset:3072 sc1
    v_mul_f32 v200, v200, v240
    v_mul_f32 v201, v201, v241
    v_mul_f32 v202, v202, v242
    v_mul_f32 v203, v203, v243
    v_cvt_pk_bf16_f32 v252, v200, v201
    v_cvt_pk_bf16_f32 v253, v202, v203
    v_mfma_f32_32x32x16_bf16 v[64:79], a[24:27], a[12:15], v[64:79]
    v_mul_f32 v244, v204, v204
    v_mul_f32 v245, v205, v205
    v_mul_f32 v246, v206, v206
    v_mul_f32 v247, v207, v207
    v_fma_f32 v244, v244, v105, v104
    v_fma_f32 v245, v245, v105, v104
    v_fma_f32 v246, v246, v105, v104
    v_fma_f32 v247, v247, v105, v104
    v_mfma_f32_32x32x16_bf16 v[48:63], a[32:35], a[20:23], v[48:63]
    s_add_u32 s66, s93, 0x2000
    buffer_load_dwordx4 a[100:103], v1, s[8:11], s66 offen offset:2048 sc1
    v_mul_f32 v244, v244, v204
    v_mul_f32 v245, v245, v205
    v_mul_f32 v246, v246, v206
    v_mul_f32 v247, v247, v207
    v_exp_f32 v244, v244
    v_mfma_f32_32x32x16_bf16 v[64:79], a[40:43], a[20:23], v[64:79]
    v_exp_f32 v245, v245
    v_exp_f32 v246, v246
    v_exp_f32 v247, v247
    v_fma_f32 v244, v244, v106, v106
    v_fma_f32 v245, v245, v106, v106
    v_fma_f32 v246, v246, v106, v106
    s_waitcnt vmcnt(11)
    v_mfma_f32_32x32x16_bf16 v[48:63], a[48:51], a[28:31], v[48:63]
    buffer_load_dwordx4 a[108:111], v1, s[8:11], s66 offen offset:3072 sc1
    v_fma_f32 v247, v247, v106, v106
    v_rcp_f32 v244, v244
    v_rcp_f32 v245, v245
    v_mfma_f32_32x32x16_bf16 v[64:79], a[56:59], a[28:31], v[64:79]
    v_rcp_f32 v246, v246
    v_rcp_f32 v247, v247
    v_mul_f32 v204, v204, v244
    v_mul_f32 v205, v205, v245
    v_mul_f32 v206, v206, v246
    v_mul_f32 v207, v207, v247
    v_cvt_pk_bf16_f32 v254, v204, v205
    s_waitcnt vmcnt(11)
    v_mfma_f32_32x32x16_bf16 v[48:63], a[64:67], a[36:39], v[48:63]
    s_add_u32 s66, s93, 0x4000
    buffer_load_dwordx4 a[116:119], v1, s[8:11], s66 offen sc1
    v_cvt_pk_bf16_f32 v255, v206, v207
    s_add_u32 s64, s92, 0x1c000
    s_cmp_lg_u32 s58, 0
    s_cbranch_scc1 L_sl_71
    buffer_store_dwordx4 v[252:255], v1, s[8:11], s64 offen offset:1024
L_bk_72:
    v_mfma_f32_32x32x16_bf16 v[64:79], a[72:75], a[36:39], v[64:79]
    ds_read_b128 a[132:135], v38 offset:0
    ds_read_b128 a[140:143], v38 offset:2048
    s_waitcnt vmcnt(11)
    v_mfma_f32_32x32x16_bf16 v[48:63], a[80:83], a[44:47], v[48:63]
    buffer_load_dwordx4 a[124:127], v1, s[8:11], s66 offen offset:1024 sc1
    buffer_load_dwordx2 v[36:37], v46, s[8:11], s78 offen offset:48 sc1
    ds_read_b128 a[148:151], v38 offset:1024
    v_mfma_f32_32x32x16_bf16 v[64:79], a[88:91], a[44:47], v[64:79]
    ds_read_b128 a[156:159], v38 offset:3072
    s_waitcnt vmcnt(12)
    v_mfma_f32_32x32x16_bf16 v[48:63], a[96:99], a[52:55], v[48:63]
    s_add_u32 s66, s93, 0x5000
    buffer_load_dwordx4 a[192:195], v1, s[8:11], s66 offen sc1
    ds_read_b128 a[164:167], v38 offset:4096
    ds_read_b128 a[172:175], v38 offset:6144
    v_mfma_f32_32x32x16_bf16 v[64:79], a[104:107], a[52:55], v[64:79]
    ds_read_b128 a[180:183], v38 offset:5120
    s_waitcnt vmcnt(12)
    v_mfma_f32_32x32x16_bf16 v[48:63], a[112:115], a[60:63], v[48:63]
    buffer_load_dwordx4 a[200:203], v1, s[8:11], s66 offen offset:1024 sc1
    ds_read_b128 a[188:191], v38 offset:7168
    v_mfma_f32_32x32x16_bf16 v[64:79], a[120:123], a[60:63], v[64:79]
    ds_read_b128 a[196:199], v38 offset:8192
    ds_read_b128 a[204:207], v38 offset:10240
    s_waitcnt vmcnt(12)
    v_mfma_f32_32x32x16_bf16 v[48:63], a[128:131], a[68:71], v[48:63]
    s_add_u32 s66, s93, 0x6000
    buffer_load_dwordx4 a[208:211], v1, s[8:11], s66 offen sc1
    ds_read_b128 a[212:215], v38 offset:9216
    v_mfma_f32_32x32x16_bf16 v[64:79], a[136:139], a[68:71], v[64:79]
    ds_read_b128 a[220:223], v38 offset:11264
    s_waitcnt vmcnt(11)
    v_mfma_f32_32x32x16_bf16 v[48:63], a[144:147], a[76:79], v[48:63]
    buffer_load_dwordx4 a[216:219], v1, s[8:11], s66 offen offset:1024 sc1
    ds_read_b128 a[228:231], v38 offset:12288
    ds_read_b128 a[236:239], v38 offset:14336
    v_mfma_f32_32x32x16_bf16 v[64:79], a[152:155], a[76:79], v[64:79]
    s_waitcnt vmcnt(6)
    s_cmp_lg_u32 s58, 0
    s_cbranch_scc1 L_sl_73
    buffer_store_dwordx2 v[4:5], v45, s[8:11], s77 offen offset:56
L_bk_74:
    ds_read_b128 a[244:247], v38 offset:13312
    v_mfma_f32_32x32x16_bf16 v[48:63], a[160:163], a[84:87], v[48:63]
    ds_read_b128 a[252:255], v38 offset:15360
    v_mfma_f32_32x32x16_bf16 v[64:79], a[168:171], a[84:87], v[64:79]
    s_waitcnt vmcnt(5)
    v_cmp_ne_u64 vcc, s[60:61], v[36:37]
    s_cbranch_vccnz L_sp_75
L_sb_76:
    s_add_u32 s66, s93, 0x1c000
    buffer_load_dwordx4 a[224:227], v1, s[8:11], s66 offen sc1
    v_mfma_f32_32x32x16_bf16 v[48:63], a[176:179], a[92:95], v[48:63]
    v_mfma_f32_32x32x16_bf16 v[64:79], a[184:187], a[92:95], v[64:79]
    buffer_load_dwordx4 a[232:235], v1, s[8:11], s66 offen offset:1024 sc1
    s_waitcnt lgkmcnt(15)
    v_mfma_f32_32x32x16_bf16 v[48:63], a[132:135], a[100:103], v[48:63]
    s_waitcnt lgkmcnt(14)
    v_mfma_f32_32x32x16_bf16 v[64:79], a[140:143], a[100:103], v[64:79]
    s_add_u32 s66, s93, 0x1d000
    buffer_load_dwordx4 a[240:243], v1, s[8:11], s66 offen sc1
    s_waitcnt lgkmcnt(13)
    v_mfma_f32_32x32x16_bf16 v[48:63], a[148:151], a[108:111], v[48:63]
    s_waitcnt lgkmcnt(12)
    v_mfma_f32_32x32x16_bf16 v[64:79], a[156:159], a[108:111], v[64:79]
    buffer_load_dwordx4 a[248:251], v1, s[8:11], s66 offen offset:1024 sc1
    s_waitcnt lgkmcnt(11)
    v_mfma_f32_32x32x16_bf16 v[48:63], a[164:167], a[116:119], v[48:63]
    s_waitcnt lgkmcnt(10)
    v_mfma_f32_32x32x16_bf16 v[64:79], a[172:175], a[116:119], v[64:79]
    s_add_u32 s66, s93, 0x1e000
    buffer_load_dwordx4 a[4:7], v1, s[8:11], s66 offen sc1
    s_waitcnt lgkmcnt(9)
    v_mfma_f32_32x32x16_bf16 v[48:63], a[180:183], a[124:127], v[48:63]
    s_waitcnt lgkmcnt(8)
    v_mfma_f32_32x32x16_bf16 v[64:79], a[188:191], a[124:127], v[64:79]
    buffer_load_dwordx4 a[12:15], v1, s[8:11], s66 offen offset:1024 sc1
    s_waitcnt vmcnt(10)
    s_waitcnt lgkmcnt(7)
    v_mfma_f32_32x32x16_bf16 v[48:63], a[196:199], a[192:195], v[48:63]
    s_waitcnt lgkmcnt(6)
    v_mfma_f32_32x32x16_bf16 v[64:79], a[204:207], a[192:195], v[64:79]
    s_add_u32 s66, s93, 0x1f000
    buffer_load_dwordx4 a[20:23], v1, s[8:11], s66 offen sc1
    s_waitcnt vmcnt(10)
    s_waitcnt lgkmcnt(5)
    v_mfma_f32_32x32x16_bf16 v[48:63], a[212:215], a[200:203], v[48:63]
    s_waitcnt lgkmcnt(4)
    v_mfma_f32_32x32x16_bf16 v[64:79], a[220:223], a[200:203], v[64:79]
    buffer_load_dwordx4 a[28:31], v1, s[8:11], s66 offen offset:1024 sc1
    s_waitcnt vmcnt(10)
    s_waitcnt lgkmcnt(3)
    v_mfma_f32_32x32x16_bf16 v[48:63], a[228:231], a[208:211], v[48:63]
    s_waitcnt lgkmcnt(2)
    v_mfma_f32_32x32x16_bf16 v[64:79], a[236:239], a[208:211], v[64:79]
    buffer_load_dwordx4 a[36:39], v1, s[8:11], s66 offen offset:2048 sc1
    s_waitcnt vmcnt(10)
    s_waitcnt lgkmcnt(1)
    v_mfma_f32_32x32x16_bf16 v[48:63], a[244:247], a[216:219], v[48:63]
    s_waitcnt lgkmcnt(0)
    v_mfma_f32_32x32x16_bf16 v[64:79], a[252:255], a[216:219], v[64:79]
    buffer_load_dwordx4 a[44:47], v1, s[8:11], s66 offen offset:3072 sc1
    s_cmp_lg_u32 s57, 0
    s_cbranch_scc1 L_final
    s_waitcnt vmcnt(9)
    v_mfma_f32_32x32x16_bf16 v[80:95], v[112:115], a[224:227], v[80:95]
    v_mfma_f32_32x32x16_bf16 v[96:111], v[116:119], a[224:227], 0
    s_add_u32 s66, s93, 0x20000
    buffer_load_dwordx4 a[52:55], v1, s[8:11], s66 offen offset:2048 sc1
    ds_write_b128 v6, v[56:59] offset:0
    ds_write_b128 v6, v[60:63] offset:1024
    s_waitcnt vmcnt(9)
    v_mfma_f32_32x32x16_bf16 v[80:95], v[120:123], a[232:235], v[80:95]
    buffer_load_dwordx2 v[36:37], v46, s[8:11], s78 offen offset:56 sc1
    ds_write_b128 v6, v[64:67] offset:2048
    ds_write_b128 v6, v[68:71] offset:3072
    v_mfma_f32_32x32x16_bf16 v[96:111], v[124:127], a[232:235], v[96:111]
    buffer_load_dwordx4 a[60:63], v1, s[8:11], s66 offen offset:3072 sc1
    ds_write_b128 v6, v[72:75] offset:4096
    ds_write_b128 v6, v[76:79] offset:5120
    s_waitcnt vmcnt(10)
    v_mfma_f32_32x32x16_bf16 v[80:95], v[128:131], a[240:243], v[80:95]
    v_mfma_f32_32x32x16_bf16 v[96:111], v[132:135], a[240:243], v[96:111]
    s_add_u32 s66, s93, 0x21000
    buffer_load_dwordx4 a[68:71], v1, s[8:11], s66 offen offset:2048 sc1
    s_waitcnt vmcnt(10)
    v_mfma_f32_32x32x16_bf16 v[80:95], v[136:139], a[248:251], v[80:95]
    v_mfma_f32_32x32x16_bf16 v[96:111], v[140:143], a[248:251], v[96:111]
    buffer_load_dwordx4 a[76:79], v1, s[8:11], s66 offen offset:3072 sc1
    s_waitcnt lgkmcnt(0)
    s_barrier
    ds_read_b128 v[176:179], v7 offset:0
    ds_read_b128 v[180:183], v7 offset:1024
    ds_read_b128 v[184:187], v8 offset:0
    s_waitcnt vmcnt(10)
    v_mfma_f32_32x32x16_bf16 v[80:95], v[144:147], a[4:7], v[80:95]
    ds_read_b128 v[188:191], v8 offset:1024
    ds_read_b128 v[192:195], v9 offset:0
    ds_read_b128 v[196:199], v9 offset:1024
    v_mfma_f32_32x32x16_bf16 v[96:111], v[148:151], a[4:7], v[96:111]
    s_add_u32 s66, s93, 0x22000
    buffer_load_dwordx4 a[84:87], v1, s[8:11], s66 offen offset:2048 sc1
    s_waitcnt vmcnt(10)
    v_mfma_f32_32x32x16_bf16 v[80:95], v[152:155], a[12:15], v[80:95]
    s_waitcnt lgkmcnt(5)
    v_add_f32 v48, v48, v176
    v_add_f32 v49, v49, v177
    v_add_f32 v50, v50, v178
    v_add_f32 v51, v51, v179
    s_waitcnt lgkmcnt(4)
    v_add_f32 v52, v52, v180
    v_add_f32 v53, v53, v181
    v_mfma_f32_32x32x16_bf16 v[96:111], v[156:159], a[12:15], v[96:111]
    buffer_load_dwordx4 a[92:95], v1, s[8:11], s66 offen offset:3072 sc1
    v_add_f32 v54, v54, v182
    v_add_f32 v55, v55, v183
    s_waitcnt lgkmcnt(3)
    v_add_f32 v48, v48, v184
    v_add_f32 v49, v49, v185
    s_waitcnt vmcnt(10)
    v_mfma_f32_32x32x16_bf16 v[80:95], v[160:163], a[20:23], v[80:95]
    v_add_f32 v50, v50, v186
    v_add_f32 v51, v51, v187
    s_waitcnt lgkmcnt(2)
    v_add_f32 v52, v52, v188
    v_add_f32 v53, v53, v189
    v_add_f32 v54, v54, v190
    v_add_f32 v55, v55, v191
    v_mfma_f32_32x32x16_bf16 v[96:111], v[164:167], a[20:23], v[96:111]
    s_waitcnt vmcnt(5)
    v_cmp_ne_u64 vcc, s[60:61], v[36:37]
    s_cbranch_vccnz L_sp_77
L_sb_78:
    s_add_u32 s66, s93, 0x1c000
    buffer_load_dwordx4 a[100:103], v1, s[8:11], s66 offen offset:2048 sc1
    v_mfma_f32_32x32x16_bf16 v[80:95], v[168:171], a[28:31], v[80:95]
    s_waitcnt lgkmcnt(1)
    v_add_f32 v48, v48, v192
    v_add_f32 v49, v49, v193
    v_add_f32 v50, v50, v194
    v_add_f32 v51, v51, v195
    s_waitcnt lgkmcnt(0)
    v_add_f32 v52, v52, v196
    v_add_f32 v53, v53, v197
    v_mfma_f32_32x32x16_bf16 v[96:111], v[172:175], a[28:31], v[96:111]
    buffer_load_dwordx4 a[108:111], v1, s[8:11], s66 offen offset:3072 sc1
    v_add_f32 v54, v54, v198
    v_add_f32 v55, v55, v199
    v_cvt_pk_bf16_f32 v248, v48, v49
    v_cvt_pk_bf16_f32 v249, v50, v51
    v_mfma_f32_32x32x16_bf16 v[80:95], a[0:3], a[36:39], v[80:95]
    v_cvt_pk_bf16_f32 v250, v52, v53
    v_cvt_pk_bf16_f32 v251, v54, v55
    s_add_u32 s64, s74, 0x10000
    s_cmp_lg_u32 s58, 0
    s_cbranch_scc1 L_sl_79
    buffer_store_dwordx4 v[248:251], v1, s[8:11], s64 offen
L_bk_80:
    v_mfma_f32_32x32x16_bf16 v[96:111], a[8:11], a[36:39], v[96:111]
    s_add_u32 s66, s93, 0x1d000
    buffer_load_dwordx4 a[116:119], v1, s[8:11], s66 offen offset:2048 sc1
    v_mul_f32 v178, v48, v48
    v_add_f32 v176, v48, v49
    v_mfma_f32_32x32x16_bf16 v[80:95], a[16:19], a[44:47], v[80:95]
    v_fmac_f32 v178, v49, v49
    v_add_f32 v176, v176, v50
    v_fmac_f32 v178, v50, v50
    v_add_f32 v176, v176, v51
    v_fmac_f32 v178, v51, v51
    v_add_f32 v176, v176, v52
    v_fmac_f32 v178, v52, v52
    v_mfma_f32_32x32x16_bf16 v[96:111], a[24:27], a[44:47], v[96:111]
    buffer_load_dwordx4 a[124:127], v1, s[8:11], s66 offen offset:3072 sc1
    v_add_f32 v176, v176, v53
    v_fmac_f32 v178, v53, v53
    v_add_f32 v176, v176, v54
    v_mfma_f32_32x32x16_bf16 v[80:95], a[32:35], a[52:55], v[80:95]
    v_fmac_f32 v178, v54, v54
    v_add_f32 v176, v176, v55
    v_fmac_f32 v178, v55, v55
    s_add_u32 s64, s32, 0
    s_nop 0
    v_permlane32_swap_b32 v176, v178
    v_add_f32 v176, v176, v178
    v_mfma_f32_32x32x16_bf16 v[96:111], a[40:43], a[52:55], v[96:111]
    s_add_u32 s66, s93, 0x1e000
    buffer_load_dwordx4 a[192:195], v1, s[8:11], s66 offen offset:2048 sc1
    s_cmp_lg_u32 s58, 0
    s_cbranch_scc1 L_sl_81
    buffer_store_dword v176, v1, s[8:11], s64 offen
L_bk_82:
    s_waitcnt vmcnt(11)
    v_mfma_f32_32x32x16_bf16 v[80:95], a[48:51], a[60:63], v[80:95]
    v_mfma_f32_32x32x16_bf16 v[96:111], a[56:59], a[60:63], v[96:111]
    buffer_load_dwordx4 a[200:203], v1, s[8:11], s66 offen offset:3072 sc1
    v_lshrrev_b32 v79, 4, v0
    v_lshlrev_b32 v79, 8, v79
    v_and_b32 v40, 15, v0
    v_lshl_or_b32 v79, v40, 3, v79
    s_lshl_b32 s67, s56, 12
    s_add_u32 s67, s67, 0x24000
    v_add_u32 v79, s67, v79
    s_waitcnt vmcnt(11)
    v_mfma_f32_32x32x16_bf16 v[80:95], a[64:67], a[68:71], v[80:95]
    ds_read_b64_tr_b16 v[56:57], v79 offset:0
    ds_read_b64_tr_b16 v[58:59], v79 offset:128
    ds_read_b64_tr_b16 v[60:61], v79 offset:1024
    ds_read_b64_tr_b16 v[62:63], v79 offset:1152
    v_mfma_f32_32x32x16_bf16 v[96:111], a[72:75], a[68:71], v[96:111]
    s_add_u32 s66, s93, 0x20000
    buffer_load_dwordx4 a[208:211], v1, s[8:11], s66 offen sc1
    ds_read_b64_tr_b16 v[64:65], v79 offset:2048
    ds_read_b64_tr_b16 v[66:67], v79 offset:2176
    ds_read_b64_tr_b16 v[68:69], v79 offset:3072
    ds_read_b64_tr_b16 v[70:71], v79 offset:3200
    s_waitcnt vmcnt(11)
    v_mfma_f32_32x32x16_bf16 v[80:95], a[80:83], a[76:79], v[80:95]
    v_add_u32 v72, 0x4000, v1
    v_lshl_add_u32 v73, s56, 12, v72
    v_and_b32 v75, 15, v0
    v_lshrrev_b32 v76, 4, v0
    v_and_b32 v40, 3, v0
    v_lshrrev_b32 v78, 5, v0
    v_mfma_f32_32x32x16_bf16 v[96:111], a[88:91], a[76:79], v[96:111]
    buffer_load_dwordx4 a[216:219], v1, s[8:11], s66 offen offset:1024 sc1
    s_bitcmp1_b32 s55, 0
    s_cbranch_scc1 L_kvv_83
    v_lshrrev_b32 v74, 2, v75
    v_lshlrev_b32 v74, 8, v74
    v_lshl_or_b32 v74, v75, 4, v74
    v_lshl_or_b32 v74, v40, 2, v74
    s_mov_b32 s68, 0
    v_lshlrev_b32 v78, 9, v78
    v_lshl_or_b32 v78, v75, 4, v78
    s_branch L_kvj_84
L_kvv_83:
    v_mul_u32_u24 v74, 0x140, v76
    s_mov_b32 s68, 20
    v_lshlrev_b32 v78, 8, v78
    v_lshl_or_b32 v78, v40, 4, v78
    v_bfe_u32 v40, v75, 2, 1
    v_lshl_or_b32 v78, v40, 7, v78
    v_bfe_u32 v40, v75, 3, 1
    v_lshl_or_b32 v78, v40, 6, v78
L_kvj_84:
    v_and_b32 v40, 1, v76
    v_lshl_or_b32 v78, v40, 3, v78
    v_add_u32 v74, 0x4c00, v74
    v_add_u32 v75, s68, v74
    v_add_u32 v76, s68, v75
    v_add_u32 v77, s68, v76
    s_waitcnt vmcnt(11)
    v_mfma_f32_32x32x16_bf16 v[80:95], a[96:99], a[84:87], v[80:95]
    v_mfma_f32_32x32x16_bf16 v[96:111], a[104:107], a[84:87], v[96:111]
    s_add_u32 s66, s93, 0x21000
    buffer_load_dwordx4 a[224:227], v1, s[8:11], s66 offen sc1
    v_lshrrev_b32 v79, 4, v0
    v_lshlrev_b32 v79, 9, v79
    v_and_b32 v40, 0xf0, v1
    v_or_b32 v79, v79, v40
    s_waitcnt vmcnt(11)
    v_mfma_f32_32x32x16_bf16 v[80:95], a[112:115], a[92:95], v[80:95]
    s_waitcnt vmcnt(4)
    s_cmp_lg_u32 s58, 0
    s_cbranch_scc1 L_sl_85
    buffer_store_dwordx2 v[4:5], v45, s[8:11], s77 offen offset:64
L_bk_86:
    v_mfma_f32_32x32x16_bf16 v[96:111], a[120:123], a[92:95], v[96:111]
    buffer_load_dwordx4 a[232:235], v1, s[8:11], s66 offen offset:1024 sc1
    s_add_u32 s63, s96, 0x0
    buffer_load_dwordx4 v[112:115], v1, s[4:7], s63 offen sc1
    v_mfma_f32_32x32x16_bf16 v[80:95], a[128:131], a[100:103], v[80:95]
    buffer_load_dwordx4 v[116:119], v1, s[4:7], s63 offen offset:1024 sc1
    v_mfma_f32_32x32x16_bf16 v[96:111], a[136:139], a[100:103], v[96:111]
    s_add_u32 s66, s93, 0x22000
    buffer_load_dwordx4 a[240:243], v1, s[8:11], s66 offen sc1
    buffer_load_dwordx4 v[120:123], v1, s[4:7], s63 offen offset:2048 sc1
    v_mfma_f32_32x32x16_bf16 v[80:95], a[144:147], a[108:111], v[80:95]
    buffer_load_dwordx4 v[124:127], v1, s[4:7], s63 offen offset:3072 sc1
    v_mfma_f32_32x32x16_bf16 v[96:111], a[152:155], a[108:111], v[96:111]
    buffer_load_dwordx4 a[248:251], v1, s[8:11], s66 offen offset:1024 sc1
    s_add_u32 s63, s96, 0x1000
    buffer_load_dwordx4 v[128:131], v1, s[4:7], s63 offen sc1
    v_mfma_f32_32x32x16_bf16 v[80:95], a[160:163], a[116:119], v[80:95]
    buffer_load_dwordx4 v[132:135], v1, s[4:7], s63 offen offset:1024 sc1
    v_mfma_f32_32x32x16_bf16 v[96:111], a[168:171], a[116:119], v[96:111]
    buffer_load_dwordx4 v[136:139], v1, s[4:7], s63 offen offset:2048 sc1
    v_mfma_f32_32x32x16_bf16 v[80:95], a[176:179], a[124:127], v[80:95]
    buffer_load_dwordx4 v[140:143], v1, s[4:7], s63 offen offset:3072 sc1
    v_mfma_f32_32x32x16_bf16 v[96:111], a[184:187], a[124:127], v[96:111]
    v_mfma_f32_32x32x16_bf16 v[80:95], a[132:135], a[192:195], v[80:95]
    s_add_u32 s63, s96, 0x2000
    buffer_load_dwordx4 v[144:147], v1, s[4:7], s63 offen sc1
    v_mfma_f32_32x32x16_bf16 v[96:111], a[140:143], a[192:195], v[96:111]
    buffer_load_dwordx4 v[148:151], v1, s[4:7], s63 offen offset:1024 sc1
    buffer_load_dwordx2 v[36:37], v46, s[8:11], s78 offen offset:64 sc1
    s_waitcnt vmcnt(18)
    v_mfma_f32_32x32x16_bf16 v[80:95], a[148:151], a[200:203], v[80:95]
    buffer_load_dwordx4 v[152:155], v1, s[4:7], s63 offen offset:2048 sc1
    v_mfma_f32_32x32x16_bf16 v[96:111], a[156:159], a[200:203], v[96:111]
    buffer_load_dwordx4 v[156:159], v1, s[4:7], s63 offen offset:3072 sc1
    s_waitcnt vmcnt(19)
    v_mfma_f32_32x32x16_bf16 v[80:95], a[164:167], a[208:211], v[80:95]
    s_add_u32 s63, s96, 0x3000
    buffer_load_dwordx4 v[160:163], v1, s[4:7], s63 offen sc1
    v_mfma_f32_32x32x16_bf16 v[96:111], a[172:175], a[208:211], v[96:111]
    buffer_load_dwordx4 v[164:167], v1, s[4:7], s63 offen offset:1024 sc1
    s_waitcnt vmcnt(20)
    v_mfma_f32_32x32x16_bf16 v[80:95], a[180:183], a[216:219], v[80:95]
    buffer_load_dwordx4 v[168:171], v1, s[4:7], s63 offen offset:2048 sc1
    v_mfma_f32_32x32x16_bf16 v[96:111], a[188:191], a[216:219], v[96:111]
    buffer_load_dwordx4 v[172:175], v1, s[4:7], s63 offen offset:3072 sc1
    s_waitcnt vmcnt(21)
    v_mfma_f32_32x32x16_bf16 v[80:95], a[196:199], a[224:227], v[80:95]
    v_mfma_f32_32x32x16_bf16 v[96:111], a[204:207], a[224:227], v[96:111]
    s_waitcnt vmcnt(19)
    v_mfma_f32_32x32x16_bf16 v[80:95], a[212:215], a[232:235], v[80:95]
    v_mfma_f32_32x32x16_bf16 v[96:111], a[220:223], a[232:235], v[96:111]
    s_waitcnt vmcnt(6)
    v_cmp_ne_u64 vcc, s[60:61], v[36:37]
    s_cbranch_vccnz L_sp_87
L_sb_88:
    s_bfe_u32 s67, s55, 0x10001
    s_lshl_b32 s67, s67, 8
    s_add_u32 s62, s75, 0x10000
    s_add_u32 s67, s67, s62
    s_cmp_ge_u32 s55, 4
    s_cselect_b32 s67, 0x10000000, s67
    s_add_u32 s68, s67, 4096
    buffer_load_dwordx4 v[208:211], v79, s[8:11], s67 offen sc1
    buffer_load_dwordx4 v[212:215], v79, s[8:11], s67 offen offset:2048 sc1
    v_mfma_f32_32x32x16_bf16 v[80:95], a[228:231], a[240:243], v[80:95]
    buffer_load_dwordx4 v[216:219], v79, s[8:11], s68 offen sc1
    buffer_load_dwordx4 v[220:223], v79, s[8:11], s68 offen offset:2048 sc1
    v_mfma_f32_32x32x16_bf16 v[96:111], a[236:239], a[240:243], v[96:111]
    s_add_u32 s65, s33, 0
    buffer_load_dwordx4 v[200:203], v1, s[8:11], s65 offen sc1
    buffer_load_dwordx4 v[204:207], v1, s[8:11], s65 offen offset:1024 sc1
    v_mfma_f32_32x32x16_bf16 v[80:95], a[244:247], a[248:251], v[80:95]
    buffer_load_dwordx4 a[0:3], v1, s[8:11], s62 offen sc1
    buffer_load_dwordx4 a[8:11], v1, s[8:11], s62 offen offset:1024 sc1
    v_mfma_f32_32x32x16_bf16 v[96:111], a[252:255], a[248:251], v[96:111]
    buffer_load_dwordx4 a[16:19], v1, s[8:11], s62 offen offset:2048 sc1
    buffer_load_dwordx4 a[24:27], v1, s[8:11], s62 offen offset:3072 sc1
    s_add_u32 s62, s62, 4096
    buffer_load_dwordx4 a[32:35], v1, s[8:11], s62 offen sc1
    buffer_load_dwordx4 a[40:43], v1, s[8:11], s62 offen offset:1024 sc1
    ds_write_b128 v6, v[88:91] offset:32768
    ds_write_b128 v6, v[92:95] offset:33792
    s_nop 4
    ds_write_b128 v6, v[96:99] offset:34816
    ds_write_b128 v6, v[100:103] offset:35840
    ds_write_b128 v6, v[104:107] offset:36864
    ds_write_b128 v6, v[108:111] offset:37888
    buffer_load_dwordx4 a[48:51], v1, s[8:11], s62 offen offset:2048 sc1
    buffer_load_dwordx4 a[56:59], v1, s[8:11], s62 offen offset:3072 sc1
    s_waitcnt lgkmcnt(0)
    s_barrier
    ds_read_b128 v[176:179], v7 offset:32768
    ds_read_b128 v[180:183], v7 offset:33792
    ds_read_b128 v[184:187], v8 offset:32768
    ds_read_b128 v[188:191], v8 offset:33792
    ds_read_b128 v[192:195], v9 offset:32768
    ds_read_b128 v[196:199], v9 offset:33792
    s_waitcnt lgkmcnt(5)
    v_pk_add_f32 v[80:81], v[80:81], v[176:177]
    v_pk_add_f32 v[82:83], v[82:83], v[178:179]
    s_waitcnt lgkmcnt(4)
    v_pk_add_f32 v[84:85], v[84:85], v[180:181]
    v_pk_add_f32 v[86:87], v[86:87], v[182:183]
    s_waitcnt lgkmcnt(3)
    v_pk_add_f32 v[80:81], v[80:81], v[184:185]
    v_pk_add_f32 v[82:83], v[82:83], v[186:187]
    s_waitcnt lgkmcnt(2)
    v_pk_add_f32 v[84:85], v[84:85], v[188:189]
    v_pk_add_f32 v[86:87], v[86:87], v[190:191]
    s_waitcnt lgkmcnt(1)
    v_pk_add_f32 v[80:81], v[80:81], v[192:193]
    v_pk_add_f32 v[82:83], v[82:83], v[194:195]
    s_waitcnt lgkmcnt(0)
    v_pk_add_f32 v[84:85], v[84:85], v[196:197]
    v_pk_add_f32 v[86:87], v[86:87], v[198:199]
    v_cvt_pk_bf16_f32 v252, v80, v81
    v_cvt_pk_bf16_f32 v253, v82, v83
    v_cvt_pk_bf16_f32 v254, v84, v85
    v_cvt_pk_bf16_f32 v255, v86, v87
    s_add_u32 s64, s74, 0x18000
    s_cmp_lg_u32 s58, 0
    s_cbranch_scc1 L_sl_89
    buffer_store_dwordx4 v[252:255], v1, s[8:11], s64 offen
L_bk_90:
    v_pk_mul_f32 v[178:179], v[80:81], v[80:81]
    v_pk_add_f32 v[176:177], v[80:81], v[82:83]
    v_pk_fma_f32 v[178:179], v[82:83], v[82:83], v[178:179]
    v_pk_fma_f32 v[178:179], v[84:85], v[84:85], v[178:179]
    v_pk_add_f32 v[176:177], v[176:177], v[84:85]
    v_pk_fma_f32 v[178:179], v[86:87], v[86:87], v[178:179]
    v_pk_add_f32 v[176:177], v[176:177], v[86:87]
    v_add_f32 v176, v176, v177
    v_add_f32 v178, v178, v179
    s_add_u32 s64, s32, 8192
    s_nop 0
    v_permlane32_swap_b32 v176, v178
    v_add_f32 v176, v176, v178
    s_cmp_lg_u32 s58, 0
    s_cbranch_scc1 L_sl_91
    buffer_store_dword v176, v1, s[8:11], s64 offen
L_bk_92:
    v_mov_b32 v96, s71
    v_mov_b32 v97, s71
    v_mov_b32 v98, s71
    v_mov_b32 v99, s71
    s_add_u32 s12, s12, 0x20000
    s_addc_u32 s13, s13, 0
    s_add_u32 s79, s79, 0x8000
    s_add_u32 s80, s80, 0x8000
    s_mov_b32 s57, 1
    s_mov_b32 s96, 0x10000000
    s_waitcnt vmcnt(10)
    v_add_f32 v200, v200, v204
    v_add_f32 v201, v201, v205
    v_add_f32 v202, v202, v206
    v_add_f32 v203, v203, v207
    v_add_f32 v200, v200, v201
    v_add_f32 v202, v202, v203
    v_add_f32 v200, v200, v202
    ds_write_b32 v43, v200 offset:0
    s_cmp_lt_u32 s55, 4
    s_cbranch_scc0 L_sk_93
    s_bitcmp1_b32 s55, 0
    s_cbranch_scc1 L_kvv_94
    v_mfma_f32_16x16x32_bf16 v[100:103], v[208:211], v[208:211], 0
    v_mfma_f32_16x16x32_bf16 v[88:91], v[56:59], v[208:211], 0
    v_mfma_f32_16x16x32_bf16 v[92:95], v[96:99], v[208:211], 0
    v_mfma_f32_16x16x32_bf16 v[100:103], v[212:215], v[212:215], v[100:103]
    v_mfma_f32_16x16x32_bf16 v[88:91], v[60:63], v[212:215], v[88:91]
    v_mfma_f32_16x16x32_bf16 v[92:95], v[96:99], v[212:215], v[92:95]
    v_mfma_f32_16x16x32_bf16 v[100:103], v[216:219], v[216:219], v[100:103]
    v_mfma_f32_16x16x32_bf16 v[88:91], v[64:67], v[216:219], v[88:91]
    v_mfma_f32_16x16x32_bf16 v[92:95], v[96:99], v[216:219], v[92:95]
    v_mfma_f32_16x16x32_bf16 v[100:103], v[220:223], v[220:223], v[100:103]
    v_mfma_f32_16x16x32_bf16 v[88:91], v[68:71], v[220:223], v[88:91]
    v_mfma_f32_16x16x32_bf16 v[92:95], v[96:99], v[220:223], v[92:95]
    s_branch L_kvj_95
L_kvv_94:
    v_mfma_f32_16x16x32_bf16 v[100:103], v[208:211], v[208:211], 0
    v_mfma_f32_16x16x32_bf16 v[88:91], v[208:211], v[56:59], 0
    v_mfma_f32_16x16x32_bf16 v[92:95], v[208:211], v[96:99], 0
    v_mfma_f32_16x16x32_bf16 v[100:103], v[212:215], v[212:215], v[100:103]
    v_mfma_f32_16x16x32_bf16 v[88:91], v[212:215], v[60:63], v[88:91]
    v_mfma_f32_16x16x32_bf16 v[92:95], v[212:215], v[96:99], v[92:95]
    v_mfma_f32_16x16x32_bf16 v[100:103], v[216:219], v[216:219], v[100:103]
    v_mfma_f32_16x16x32_bf16 v[88:91], v[216:219], v[64:67], v[88:91]
    v_mfma_f32_16x16x32_bf16 v[92:95], v[216:219], v[96:99], v[92:95]
    v_mfma_f32_16x16x32_bf16 v[100:103], v[220:223], v[220:223], v[100:103]
    v_mfma_f32_16x16x32_bf16 v[88:91], v[220:223], v[68:71], v[88:91]
    v_mfma_f32_16x16x32_bf16 v[92:95], v[220:223], v[96:99], v[92:95]
L_kvj_95:
    s_nop 1
    ds_write_b128 v73, v[100:103] offset:3072
    s_cmp_lg_u32 s56, 0
    s_cbranch_scc0 L_sk_96
    ds_write_b128 v73, v[88:91]
    s_nop 1
    ds_write_b128 v73, v[92:95] offset:1024
L_sk_96:
L_sk_93:
    s_waitcnt lgkmcnt(0)
    s_barrier
    s_waitcnt vmcnt(0)
    s_cmp_lg_u32 s58, 0
    s_cbranch_scc1 L_sl_97
    buffer_store_dwordx2 v[4:5], v45, s[8:11], s77 offen offset:72
L_bk_98:
    s_cmp_lt_u32 s55, 4
    s_cbranch_scc0 L_sk_99
    s_cmp_eq_u32 s56, 0
    s_cbranch_scc0 L_sk_99
    ds_read_b32 v176, v74 offset:0
    ds_read_b32 v177, v75 offset:0
    ds_read_b32 v178, v76 offset:0
    ds_read_b32 v179, v77 offset:0
    ds_read_b32 v180, v74 offset:4096
    ds_read_b32 v181, v75 offset:4096
    ds_read_b32 v182, v76 offset:4096
    ds_read_b32 v183, v77 offset:4096
    ds_read_b128 v[192:195], v72 offset:5120
    ds_read_b32 v184, v74 offset:8192
    ds_read_b32 v185, v75 offset:8192
    ds_read_b32 v186, v76 offset:8192
    ds_read_b32 v187, v77 offset:8192
    ds_read_b128 v[196:199], v72 offset:9216
    ds_read_b32 v188, v74 offset:12288
    ds_read_b32 v189, v75 offset:12288
    ds_read_b32 v190, v76 offset:12288
    ds_read_b32 v191, v77 offset:12288
    ds_read_b128 v[200:203], v72 offset:13312
    ds_read_b128 v[204:207], v72 offset:4096
    ds_read_b128 v[208:211], v72 offset:8192
    ds_read_b128 v[212:215], v72 offset:12288
    s_waitcnt lgkmcnt(15)
    v_pk_add_f32 v[176:177], v[176:177], v[180:181]
    s_waitcnt lgkmcnt(14)
    v_pk_add_f32 v[178:179], v[178:179], v[182:183]
    s_waitcnt lgkmcnt(13)
    v_pk_add_f32 v[92:93], v[92:93], v[192:193]
    v_pk_add_f32 v[94:95], v[94:95], v[194:195]
    s_waitcnt lgkmcnt(11)
    v_pk_add_f32 v[176:177], v[176:177], v[184:185]
    s_waitcnt lgkmcnt(9)
    v_pk_add_f32 v[178:179], v[178:179], v[186:187]
    s_waitcnt lgkmcnt(8)
    v_pk_add_f32 v[92:93], v[92:93], v[196:197]
    v_pk_add_f32 v[94:95], v[94:95], v[198:199]
    s_waitcnt lgkmcnt(6)
    v_pk_add_f32 v[176:177], v[176:177], v[188:189]
    s_waitcnt lgkmcnt(4)
    v_pk_add_f32 v[178:179], v[178:179], v[190:191]
    s_waitcnt lgkmcnt(3)
    v_pk_add_f32 v[92:93], v[92:93], v[200:201]
    v_pk_add_f32 v[94:95], v[94:95], v[202:203]
    v_mul_f32 v92, 0x3b000000, v92
    v_mul_f32 v93, 0x3b000000, v93
    v_mul_f32 v94, 0x3b000000, v94
    v_mul_f32 v95, 0x3b000000, v95
    v_mul_f32 v176, 0x3b000000, v176
    v_mul_f32 v177, 0x3b000000, v177
    v_mul_f32 v178, 0x3b000000, v178
    v_mul_f32 v179, 0x3b000000, v179
    v_fma_f32 v176, -v92, v92, v176
    v_fma_f32 v177, -v93, v93, v177
    v_fma_f32 v178, -v94, v94, v178
    v_fma_f32 v179, -v95, v95, v179
    v_max_f32 v176, 0, v176
    v_max_f32 v177, 0, v177
    v_max_f32 v178, 0, v178
    v_max_f32 v179, 0, v179
    v_add_f32 v176, 0x3727c5ac, v176
    v_add_f32 v177, 0x3727c5ac, v177
    v_add_f32 v178, 0x3727c5ac, v178
    v_add_f32 v179, 0x3727c5ac, v179
    v_rsq_f32 v176, v176
    v_rsq_f32 v177, v177
    v_rsq_f32 v178, v178
    v_rsq_f32 v179, v179
    s_waitcnt lgkmcnt(2)
    v_pk_add_f32 v[88:89], v[88:89], v[204:205]
    v_pk_add_f32 v[90:91], v[90:91], v[206:207]
    s_waitcnt lgkmcnt(1)
    v_pk_add_f32 v[88:89], v[88:89], v[208:209]
    v_pk_add_f32 v[90:91], v[90:91], v[210:211]
    s_waitcnt lgkmcnt(0)
    v_pk_add_f32 v[88:89], v[88:89], v[212:213]
    v_pk_add_f32 v[90:91], v[90:91], v[214:215]
    v_fma_f32 v88, -v92, v12, v88
    v_fma_f32 v89, -v93, v13, v89
    v_fma_f32 v90, -v94, v14, v90
    v_fma_f32 v91, -v95, v15, v91
    v_mul_f32 v88, v88, v176
    v_mul_f32 v89, v89, v177
    v_mul_f32 v90, v90, v178
    v_mul_f32 v91, v91, v179
    v_cvt_pk_bf16_f32 v88, v88, v89
    v_cvt_pk_bf16_f32 v89, v90, v91
    buffer_store_dwordx2 v[88:89], v78, s[12:15], s95 offen sc1
L_sk_99:
    v_mfma_f32_32x32x16_bf16 v[224:239], v[112:115], a[0:3], 0
    ds_read_b128 v[200:203], v42 offset:0
    v_mfma_f32_32x32x16_bf16 v[240:255], v[116:119], a[0:3], 0
    v_mfma_f32_32x32x16_bf16 v[224:239], v[120:123], a[8:11], v[224:239]
    v_mfma_f32_32x32x16_bf16 v[240:255], v[124:127], a[8:11], v[240:255]
    s_waitcnt lgkmcnt(0)
    v_add_f32 v200, v200, v201
    v_add_f32 v202, v202, v203
    v_add_f32 v200, v200, v202
    v_mfma_f32_32x32x16_bf16 v[224:239], v[128:131], a[16:19], v[224:239]
    v_mul_f32 v204, 0x3b000000, v200
    v_mul_f32 v200, 0x3b000000, v200
    s_nop 1
    v_permlane32_swap_b32 v204, v200
    v_mfma_f32_32x32x16_bf16 v[240:255], v[132:135], a[16:19], v[240:255]
    v_fma_f32 v200, -v204, v204, v200
    v_max_f32 v200, 0, v200
    v_mfma_f32_32x32x16_bf16 v[224:239], v[136:139], a[24:27], v[224:239]
    v_add_f32 v200, 0x3727c5ac, v200
    v_rsq_f32 v205, v200
    v_mfma_f32_32x32x16_bf16 v[240:255], v[140:143], a[24:27], v[240:255]
    v_mfma_f32_32x32x16_bf16 v[224:239], v[144:147], a[32:35], v[224:239]
    v_mfma_f32_32x32x16_bf16 v[240:255], v[148:151], a[32:35], v[240:255]
    buffer_load_dwordx2 v[36:37], v46, s[8:11], s78 offen offset:72 sc1
    v_mfma_f32_32x32x16_bf16 v[224:239], v[152:155], a[40:43], v[224:239]
    v_mfma_f32_32x32x16_bf16 v[240:255], v[156:159], a[40:43], v[240:255]
    v_mfma_f32_32x32x16_bf16 v[224:239], v[160:163], a[48:51], v[224:239]
    v_mfma_f32_32x32x16_bf16 v[240:255], v[164:167], a[48:51], v[240:255]
    v_mfma_f32_32x32x16_bf16 v[224:239], v[168:171], a[56:59], v[224:239]
    v_mfma_f32_32x32x16_bf16 v[240:255], v[172:175], a[56:59], v[240:255]
    s_nop 4
    ds_write_b128 v6, v[232:235] offset:0
    ds_write_b128 v6, v[236:239] offset:1024
    s_nop 4
    ds_write_b128 v6, v[240:243] offset:2048
    ds_write_b128 v6, v[244:247] offset:3072
    ds_write_b128 v6, v[248:251] offset:4096
    ds_write_b128 v6, v[252:255] offset:5120
    s_waitcnt vmcnt(0)
    v_cmp_ne_u64 vcc, s[60:61], v[36:37]
    s_cbranch_vccnz L_sp_100
L_sb_101:
    s_cmp_lt_u32 s55, 4
    s_cbranch_scc0 L_sk_102
    s_cmp_eq_u32 s56, 0
    s_cbranch_scc0 L_sk_102
    v_mov_b32 v36, s59
    v_mov_b32 v37, s61
    s_mov_b64 exec, 1
    buffer_store_dwordx2 v[36:37], v3, s[4:7], s79 offen sc1
    s_mov_b64 exec, -1
L_sk_102:
    s_bfe_u32 s67, s55, 0x10001
    s_lshl_b32 s67, s67, 8
    s_add_u32 s62, s75, 0x18000
    s_add_u32 s67, s67, s62
    s_cmp_lt_u32 s55, 4
    s_cselect_b32 s67, 0x10000000, s67
    s_add_u32 s68, s67, 4096
    buffer_load_dwordx4 v[208:211], v79, s[8:11], s67 offen sc1
    buffer_load_dwordx4 v[212:215], v79, s[8:11], s67 offen offset:2048 sc1
    buffer_load_dwordx4 v[216:219], v79, s[8:11], s68 offen sc1
    buffer_load_dwordx4 v[220:223], v79, s[8:11], s68 offen offset:2048 sc1
    s_add_u32 s65, s33, 8192
    buffer_load_dwordx4 v[104:107], v1, s[8:11], s65 offen sc1
    buffer_load_dwordx4 v[108:111], v1, s[8:11], s65 offen offset:1024 sc1
    buffer_load_dwordx4 a[64:67], v1, s[8:11], s62 offen sc1
    buffer_load_dwordx4 a[72:75], v1, s[8:11], s62 offen offset:1024 sc1
    buffer_load_dwordx4 a[80:83], v1, s[8:11], s62 offen offset:2048 sc1
    buffer_load_dwordx4 a[88:91], v1, s[8:11], s62 offen offset:3072 sc1
    s_add_u32 s62, s62, 4096
    buffer_load_dwordx4 a[96:99], v1, s[8:11], s62 offen sc1
    buffer_load_dwordx4 a[104:107], v1, s[8:11], s62 offen offset:1024 sc1
    buffer_load_dwordx4 a[112:115], v1, s[8:11], s62 offen offset:2048 sc1
    buffer_load_dwordx4 a[120:123], v1, s[8:11], s62 offen offset:3072 sc1
    s_add_u32 s77, s77, 4096
    s_add_u32 s78, s78, 4096
    s_waitcnt lgkmcnt(0)
    s_barrier
    ds_read_b128 v[232:235], v7 offset:0
    ds_read_b128 v[236:239], v7 offset:1024
    ds_read_b128 v[240:243], v8 offset:0
    ds_read_b128 v[244:247], v8 offset:1024
    ds_read_b128 v[248:251], v9 offset:0
    ds_read_b128 v[252:255], v9 offset:1024
    v_mul_f32 v205, 0x3eb8aa3b, v205
    s_waitcnt lgkmcnt(5)
    v_pk_add_f32 v[224:225], v[224:225], v[232:233]
    v_pk_add_f32 v[226:227], v[226:227], v[234:235]
    s_waitcnt lgkmcnt(4)
    v_pk_add_f32 v[228:229], v[228:229], v[236:237]
    v_pk_add_f32 v[230:231], v[230:231], v[238:239]
    s_waitcnt lgkmcnt(3)
    v_pk_add_f32 v[224:225], v[224:225], v[240:241]
    v_pk_add_f32 v[226:227], v[226:227], v[242:243]
    s_waitcnt lgkmcnt(2)
    v_pk_add_f32 v[228:229], v[228:229], v[244:245]
    v_pk_add_f32 v[230:231], v[230:231], v[246:247]
    s_waitcnt lgkmcnt(1)
    v_pk_add_f32 v[224:225], v[224:225], v[248:249]
    v_pk_add_f32 v[226:227], v[226:227], v[250:251]
    s_waitcnt lgkmcnt(0)
    v_pk_add_f32 v[228:229], v[228:229], v[252:253]
    v_pk_add_f32 v[230:231], v[230:231], v[254:255]
    v_fma_f32 v224, -v204, v16, v224
    v_fma_f32 v225, -v204, v17, v225
    v_fma_f32 v226, -v204, v18, v226
    v_fma_f32 v227, -v204, v19, v227
    v_fma_f32 v228, -v204, v20, v228
    v_fma_f32 v229, -v204, v21, v229
    v_fma_f32 v230, -v204, v22, v230
    v_fma_f32 v231, -v204, v23, v231
    v_mul_f32 v224, v224, v205
    v_mul_f32 v225, v225, v205
    v_mul_f32 v226, v226, v205
    v_mul_f32 v227, v227, v205
    v_mul_f32 v228, v228, v205
    v_mul_f32 v229, v229, v205
    v_mul_f32 v230, v230, v205
    v_mul_f32 v231, v231, v205
    v_cvt_pk_bf16_f32 v240, v224, v225
    v_cvt_pk_bf16_f32 v241, v226, v227
    v_cvt_pk_bf16_f32 v242, v228, v229
    v_cvt_pk_bf16_f32 v243, v230, v231
    s_cmp_ge_u32 s55, 4
    s_cbranch_scc0 L_sk_103
    s_waitcnt vmcnt(10)
    s_bitcmp1_b32 s55, 0
    s_cbranch_scc1 L_kvv_104
    v_mfma_f32_16x16x32_bf16 v[100:103], v[208:211], v[208:211], 0
    v_mfma_f32_16x16x32_bf16 v[88:91], v[56:59], v[208:211], 0
    v_mfma_f32_16x16x32_bf16 v[92:95], v[96:99], v[208:211], 0
    v_mfma_f32_16x16x32_bf16 v[100:103], v[212:215], v[212:215], v[100:103]
    v_mfma_f32_16x16x32_bf16 v[88:91], v[60:63], v[212:215], v[88:91]
    v_mfma_f32_16x16x32_bf16 v[92:95], v[96:99], v[212:215], v[92:95]
    v_mfma_f32_16x16x32_bf16 v[100:103], v[216:219], v[216:219], v[100:103]
    v_mfma_f32_16x16x32_bf16 v[88:91], v[64:67], v[216:219], v[88:91]
    v_mfma_f32_16x16x32_bf16 v[92:95], v[96:99], v[216:219], v[92:95]
    v_mfma_f32_16x16x32_bf16 v[100:103], v[220:223], v[220:223], v[100:103]
    v_mfma_f32_16x16x32_bf16 v[88:91], v[68:71], v[220:223], v[88:91]
    v_mfma_f32_16x16x32_bf16 v[92:95], v[96:99], v[220:223], v[92:95]
    s_branch L_kvj_105
L_kvv_104:
    v_mfma_f32_16x16x32_bf16 v[100:103], v[208:211], v[208:211], 0
    v_mfma_f32_16x16x32_bf16 v[88:91], v[208:211], v[56:59], 0
    v_mfma_f32_16x16x32_bf16 v[92:95], v[208:211], v[96:99], 0
    v_mfma_f32_16x16x32_bf16 v[100:103], v[212:215], v[212:215], v[100:103]
    v_mfma_f32_16x16x32_bf16 v[88:91], v[212:215], v[60:63], v[88:91]
    v_mfma_f32_16x16x32_bf16 v[92:95], v[212:215], v[96:99], v[92:95]
    v_mfma_f32_16x16x32_bf16 v[100:103], v[216:219], v[216:219], v[100:103]
    v_mfma_f32_16x16x32_bf16 v[88:91], v[216:219], v[64:67], v[88:91]
    v_mfma_f32_16x16x32_bf16 v[92:95], v[216:219], v[96:99], v[92:95]
    v_mfma_f32_16x16x32_bf16 v[100:103], v[220:223], v[220:223], v[100:103]
    v_mfma_f32_16x16x32_bf16 v[88:91], v[220:223], v[68:71], v[88:91]
    v_mfma_f32_16x16x32_bf16 v[92:95], v[220:223], v[96:99], v[92:95]
L_kvj_105:
    s_nop 1
    ds_write_b128 v73, v[100:103] offset:3072
    s_cmp_lg_u32 s56, 0
    s_cbranch_scc0 L_sk_106
    ds_write_b128 v73, v[88:91]
    s_nop 1
    ds_write_b128 v73, v[92:95] offset:1024
L_sk_106:
L_sk_103:
    s_waitcnt vmcnt(7)
    v_mfma_f32_32x32x16_bf16 v[176:191], v[112:115], a[64:67], 0
    v_and_b32 v66, 0xf80, v3
    v_mfma_f32_32x32x16_bf16 v[192:207], v[116:119], a[64:67], 0
    v_add_f32 v104, v104, v108
    v_add_f32 v105, v105, v109
    v_add_f32 v106, v106, v110
    v_add_f32 v107, v107, v111
    v_add_f32 v104, v104, v105
    s_waitcnt vmcnt(6)
    v_mfma_f32_32x32x16_bf16 v[176:191], v[120:123], a[72:75], v[176:191]
    v_add_f32 v106, v106, v107
    v_add_f32 v104, v104, v106
    ds_write_b32 v43, v104 offset:1024
    v_mfma_f32_32x32x16_bf16 v[192:207], v[124:127], a[72:75], v[192:207]
    s_waitcnt vmcnt(5)
    v_mfma_f32_32x32x16_bf16 v[176:191], v[128:131], a[80:83], v[176:191]
    v_and_b32 v70, 16, v0
    v_cmp_eq_u32 vcc, 0, v70
    v_lshrrev_b32 v70, 5, v0
    v_lshlrev_b32 v70, 8, v70
    v_add_u32 v70, 0x8000, v70
    v_mov_b32 v71, 0x21000
    v_cndmask_b32 v11, v71, v70, vcc
    v_mov_b32 v70, 0x1000
    v_cndmask_b32 v38, 0, v70, vcc
    v_mfma_f32_32x32x16_bf16 v[192:207], v[132:135], a[80:83], v[192:207]
    v_and_b32 v70, 0xf0, v1
    v_or_b32 v11, v11, v70
    v_and_b32 v65, 0x180, v3
    v_bfe_u32 v70, v0, 2, 1
    v_lshl_or_b32 v65, v70, 12, v65
    s_waitcnt vmcnt(4)
    v_mfma_f32_32x32x16_bf16 v[176:191], v[136:139], a[88:91], v[176:191]
    v_add_u32 v39, 0x10000, v1
    v_mov_b32 v56, 0
    v_mov_b32 v57, 0
    v_mov_b32 v58, 0
    v_mov_b32 v59, 0
    v_mfma_f32_32x32x16_bf16 v[192:207], v[140:143], a[88:91], v[192:207]
    v_mov_b32 v60, 0
    v_mov_b32 v61, 0
    v_mov_b32 v62, 0
    v_mov_b32 v63, 0
    v_mov_b32 v208, 0
    s_waitcnt vmcnt(3)
    v_mfma_f32_32x32x16_bf16 v[176:191], v[144:147], a[96:99], v[176:191]
    s_add_u32 s65, s80, 0
    buffer_load_dwordx2 v[36:37], v66, s[4:7], s65 offen sc1
    v_mov_b32 v209, 0
    v_mfma_f32_32x32x16_bf16 v[192:207], v[148:151], a[96:99], v[192:207]
    v_mov_b32 v210, 0
    v_mov_b32 v211, 0
    v_mov_b32 v212, 0
    v_mov_b32 v213, 0
    v_mov_b32 v214, 0
    s_waitcnt vmcnt(3)
    v_mfma_f32_32x32x16_bf16 v[176:191], v[152:155], a[104:107], v[176:191]
    v_mov_b32 v215, 0
    v_mov_b32 v216, 0
    v_mov_b32 v217, 0
    v_mov_b32 v218, 0
    v_mov_b32 v219, 0
    v_mfma_f32_32x32x16_bf16 v[192:207], v[156:159], a[104:107], v[192:207]
    v_mov_b32 v220, 0
    v_mov_b32 v221, 0
    v_mov_b32 v222, 0
    v_mov_b32 v223, 0
    v_mov_b32 v224, 0
    s_waitcnt vmcnt(2)
    v_mfma_f32_32x32x16_bf16 v[176:191], v[160:163], a[112:115], v[176:191]
    v_mov_b32 v225, 0
    v_mov_b32 v226, 0
    v_mov_b32 v227, 0
    v_mov_b32 v228, 0
    v_mov_b32 v229, 0
    v_mfma_f32_32x32x16_bf16 v[192:207], v[164:167], a[112:115], v[192:207]
    v_mov_b32 v230, 0
    v_mov_b32 v231, 0
    v_mov_b32 v232, 0
    v_mov_b32 v233, 0
    v_mov_b32 v234, 0
    s_waitcnt vmcnt(1)
    v_mfma_f32_32x32x16_bf16 v[176:191], v[168:171], a[120:123], v[176:191]
    v_mov_b32 v235, 0
    v_mov_b32 v236, 0
    v_mov_b32 v237, 0
    v_mov_b32 v238, 0
    v_mov_b32 v239, 0
    v_mfma_f32_32x32x16_bf16 v[192:207], v[172:175], a[120:123], v[192:207]
    s_nop 4
    ds_write_b128 v6, v[184:187] offset:32768
    ds_write_b128 v6, v[188:191] offset:33792
    s_nop 4
    ds_write_b128 v6, v[192:195] offset:34816
    ds_write_b128 v6, v[196:199] offset:35840
    ds_write_b128 v6, v[200:203] offset:36864
    ds_write_b128 v6, v[204:207] offset:37888
    s_waitcnt lgkmcnt(0)
    s_barrier
    s_cmp_ge_u32 s55, 4
    s_cbranch_scc0 L_sk_107
    s_cmp_eq_u32 s56, 0
    s_cbranch_scc0 L_sk_107
    ds_read_b32 v112, v74 offset:0
    ds_read_b32 v113, v75 offset:0
    ds_read_b32 v114, v76 offset:0
    ds_read_b32 v115, v77 offset:0
    ds_read_b32 v116, v74 offset:4096
    ds_read_b32 v117, v75 offset:4096
    ds_read_b32 v118, v76 offset:4096
    ds_read_b32 v119, v77 offset:4096
    ds_read_b128 v[128:131], v72 offset:5120
    ds_read_b32 v120, v74 offset:8192
    ds_read_b32 v121, v75 offset:8192
    ds_read_b32 v122, v76 offset:8192
    ds_read_b32 v123, v77 offset:8192
    ds_read_b128 v[132:135], v72 offset:9216
    ds_read_b32 v124, v74 offset:12288
    ds_read_b32 v125, v75 offset:12288
    ds_read_b32 v126, v76 offset:12288
    ds_read_b32 v127, v77 offset:12288
    ds_read_b128 v[136:139], v72 offset:13312
    ds_read_b128 v[140:143], v72 offset:4096
    ds_read_b128 v[144:147], v72 offset:8192
    ds_read_b128 v[148:151], v72 offset:12288
    s_waitcnt lgkmcnt(15)
    v_pk_add_f32 v[112:113], v[112:113], v[116:117]
    s_waitcnt lgkmcnt(14)
    v_pk_add_f32 v[114:115], v[114:115], v[118:119]
    s_waitcnt lgkmcnt(13)
    v_pk_add_f32 v[92:93], v[92:93], v[128:129]
    v_pk_add_f32 v[94:95], v[94:95], v[130:131]
    s_waitcnt lgkmcnt(11)
    v_pk_add_f32 v[112:113], v[112:113], v[120:121]
    s_waitcnt lgkmcnt(9)
    v_pk_add_f32 v[114:115], v[114:115], v[122:123]
    s_waitcnt lgkmcnt(8)
    v_pk_add_f32 v[92:93], v[92:93], v[132:133]
    v_pk_add_f32 v[94:95], v[94:95], v[134:135]
    s_waitcnt lgkmcnt(6)
    v_pk_add_f32 v[112:113], v[112:113], v[124:125]
    s_waitcnt lgkmcnt(4)
    v_pk_add_f32 v[114:115], v[114:115], v[126:127]
    s_waitcnt lgkmcnt(3)
    v_pk_add_f32 v[92:93], v[92:93], v[136:137]
    v_pk_add_f32 v[94:95], v[94:95], v[138:139]
    v_mul_f32 v92, 0x3b000000, v92
    v_mul_f32 v93, 0x3b000000, v93
    v_mul_f32 v94, 0x3b000000, v94
    v_mul_f32 v95, 0x3b000000, v95
    v_mul_f32 v112, 0x3b000000, v112
    v_mul_f32 v113, 0x3b000000, v113
    v_mul_f32 v114, 0x3b000000, v114
    v_mul_f32 v115, 0x3b000000, v115
    v_fma_f32 v112, -v92, v92, v112
    v_fma_f32 v113, -v93, v93, v113
    v_fma_f32 v114, -v94, v94, v114
    v_fma_f32 v115, -v95, v95, v115
    v_max_f32 v112, 0, v112
    v_max_f32 v113, 0, v113
    v_max_f32 v114, 0, v114
    v_max_f32 v115, 0, v115
    v_add_f32 v112, 0x3727c5ac, v112
    v_add_f32 v113, 0x3727c5ac, v113
    v_add_f32 v114, 0x3727c5ac, v114
    v_add_f32 v115, 0x3727c5ac, v115
    v_rsq_f32 v112, v112
    v_rsq_f32 v113, v113
    v_rsq_f32 v114, v114
    v_rsq_f32 v115, v115
    s_waitcnt lgkmcnt(2)
    v_pk_add_f32 v[88:89], v[88:89], v[140:141]
    v_pk_add_f32 v[90:91], v[90:91], v[142:143]
    s_waitcnt lgkmcnt(1)
    v_pk_add_f32 v[88:89], v[88:89], v[144:145]
    v_pk_add_f32 v[90:91], v[90:91], v[146:147]
    s_waitcnt lgkmcnt(0)
    v_pk_add_f32 v[88:89], v[88:89], v[148:149]
    v_pk_add_f32 v[90:91], v[90:91], v[150:151]
    v_fma_f32 v88, -v92, v12, v88
    v_fma_f32 v89, -v93, v13, v89
    v_fma_f32 v90, -v94, v14, v90
    v_fma_f32 v91, -v95, v15, v91
    v_mul_f32 v88, v88, v112
    v_mul_f32 v89, v89, v113
    v_mul_f32 v90, v90, v114
    v_mul_f32 v91, v91, v115
    v_cvt_pk_bf16_f32 v88, v88, v89
    v_cvt_pk_bf16_f32 v89, v90, v91
    buffer_store_dwordx2 v[88:89], v78, s[12:15], s95 offen sc1
L_sk_107:
    ds_read_b128 v[104:107], v42 offset:1024
    ds_read_b128 v[184:187], v7 offset:32768
    ds_read_b128 v[188:191], v7 offset:33792
    ds_read_b128 v[192:195], v8 offset:32768
    ds_read_b128 v[196:199], v8 offset:33792
    ds_read_b128 v[200:203], v9 offset:32768
    ds_read_b128 v[204:207], v9 offset:33792
    s_waitcnt vmcnt(0)
    v_and_b32 v36, -16, v36
    v_cmp_ne_u64 vcc, s[60:61], v[36:37]
    s_cbranch_vccnz L_kp_108
L_kb_109:
    s_add_u32 m0, s76, 0x0
    s_nop 0
    buffer_load_dwordx4 v1, s[12:15], m0 offen sc1 lds
    s_add_u32 m0, s76, 0x8000
    s_nop 0
    buffer_load_dwordx4 v1, s[12:15], m0 offen sc1 lds
    s_add_u32 m0, s76, 0x1000
    s_nop 0
    buffer_load_dwordx4 v1, s[12:15], m0 offen sc1 lds
    s_add_u32 m0, s76, 0x9000
    s_nop 0
    buffer_load_dwordx4 v1, s[12:15], m0 offen sc1 lds
    s_waitcnt lgkmcnt(6)
    v_add_f32 v104, v104, v105
    v_add_f32 v106, v106, v107
    v_add_f32 v104, v104, v106
    v_mul_f32 v108, 0x3b000000, v104
    v_mul_f32 v104, 0x3b000000, v104
    s_nop 1
    v_permlane32_swap_b32 v108, v104
    v_fma_f32 v104, -v108, v108, v104
    v_max_f32 v104, 0, v104
    v_add_f32 v104, 0x3727c5ac, v104
    v_rsq_f32 v109, v104
    s_nop 0
    v_mul_f32 v109, 0x3eb8aa3b, v109
    s_waitcnt lgkmcnt(5)
    v_pk_add_f32 v[176:177], v[176:177], v[184:185]
    v_pk_add_f32 v[178:179], v[178:179], v[186:187]
    s_waitcnt lgkmcnt(4)
    v_pk_add_f32 v[180:181], v[180:181], v[188:189]
    v_pk_add_f32 v[182:183], v[182:183], v[190:191]
    s_waitcnt lgkmcnt(3)
    v_pk_add_f32 v[176:177], v[176:177], v[192:193]
    v_pk_add_f32 v[178:179], v[178:179], v[194:195]
    s_waitcnt lgkmcnt(2)
    v_pk_add_f32 v[180:181], v[180:181], v[196:197]
    v_pk_add_f32 v[182:183], v[182:183], v[198:199]
    s_waitcnt lgkmcnt(1)
    v_pk_add_f32 v[176:177], v[176:177], v[200:201]
    v_pk_add_f32 v[178:179], v[178:179], v[202:203]
    s_waitcnt lgkmcnt(0)
    v_pk_add_f32 v[180:181], v[180:181], v[204:205]
    v_pk_add_f32 v[182:183], v[182:183], v[206:207]
    v_fma_f32 v176, -v108, v16, v176
    v_fma_f32 v177, -v108, v17, v177
    v_fma_f32 v178, -v108, v18, v178
    v_fma_f32 v179, -v108, v19, v179
    v_fma_f32 v180, -v108, v20, v180
    v_fma_f32 v181, -v108, v21, v181
    v_fma_f32 v182, -v108, v22, v182
    v_fma_f32 v183, -v108, v23, v183
    v_mul_f32 v176, v176, v109
    v_mul_f32 v177, v177, v109
    v_mul_f32 v178, v178, v109
    v_mul_f32 v179, v179, v109
    v_mul_f32 v180, v180, v109
    v_mul_f32 v181, v181, v109
    v_mul_f32 v182, v182, v109
    v_mul_f32 v183, v183, v109
    v_cvt_pk_bf16_f32 v244, v176, v177
    v_cvt_pk_bf16_f32 v245, v178, v179
    v_cvt_pk_bf16_f32 v246, v180, v181
    v_cvt_pk_bf16_f32 v247, v182, v183
    s_waitcnt vmcnt(0)
    s_barrier
    s_nop 3
    s_branch L_loop
L_final:
    s_waitcnt vmcnt(9)
    v_mfma_f32_32x32x16_bf16 v[80:95], v[112:115], a[224:227], v[80:95]
    v_mfma_f32_32x32x16_bf16 v[96:111], v[116:119], a[224:227], 0
    s_add_u32 s66, s93, 0x20000
    buffer_load_dwordx4 a[52:55], v1, s[8:11], s66 offen offset:2048 sc1
    ds_write_b128 v6, v[56:59] offset:0
    ds_write_b128 v6, v[60:63] offset:1024
    s_waitcnt vmcnt(9)
    v_mfma_f32_32x32x16_bf16 v[80:95], v[120:123], a[232:235], v[80:95]
    buffer_load_dwordx2 v[36:37], v46, s[8:11], s78 offen offset:56 sc1
    ds_write_b128 v6, v[64:67] offset:2048
    ds_write_b128 v6, v[68:71] offset:3072
    v_mfma_f32_32x32x16_bf16 v[96:111], v[124:127], a[232:235], v[96:111]
    buffer_load_dwordx4 a[60:63], v1, s[8:11], s66 offen offset:3072 sc1
    ds_write_b128 v6, v[72:75] offset:4096
    ds_write_b128 v6, v[76:79] offset:5120
    s_waitcnt vmcnt(10)
    v_mfma_f32_32x32x16_bf16 v[80:95], v[128:131], a[240:243], v[80:95]
    s_mov_b32 s20, s48
    s_mov_b32 s21, s49
    s_mov_b32 s22, 0x200000
    s_mov_b32 s23, 0x20000
    s_add_u32 s68, s94, 0x8000
    v_mfma_f32_32x32x16_bf16 v[96:111], v[132:135], a[240:243], v[96:111]
    s_add_u32 s66, s93, 0x21000
    buffer_load_dwordx4 a[68:71], v1, s[8:11], s66 offen offset:2048 sc1
    v_lshrrev_b32 v40, 5, v0
    v_lshlrev_b32 v40, 4, v40
    v_and_b32 v41, 31, v0
    v_lshl_add_u32 v41, v41, 10, v40
    s_waitcnt vmcnt(10)
    v_mfma_f32_32x32x16_bf16 v[80:95], v[136:139], a[248:251], v[80:95]
    v_mfma_f32_32x32x16_bf16 v[96:111], v[140:143], a[248:251], v[96:111]
    buffer_load_dwordx4 a[76:79], v1, s[8:11], s66 offen offset:3072 sc1
    s_waitcnt lgkmcnt(0)
    s_barrier
    ds_read_b128 v[176:179], v7 offset:0
    ds_read_b128 v[180:183], v7 offset:1024
    ds_read_b128 v[184:187], v8 offset:0
    s_waitcnt vmcnt(10)
    v_mfma_f32_32x32x16_bf16 v[80:95], v[144:147], a[4:7], v[80:95]
    ds_read_b128 v[188:191], v8 offset:1024
    ds_read_b128 v[192:195], v9 offset:0
    ds_read_b128 v[196:199], v9 offset:1024
    v_mfma_f32_32x32x16_bf16 v[96:111], v[148:151], a[4:7], v[96:111]
    s_add_u32 s66, s93, 0x22000
    buffer_load_dwordx4 a[84:87], v1, s[8:11], s66 offen offset:2048 sc1
    s_waitcnt vmcnt(10)
    v_mfma_f32_32x32x16_bf16 v[80:95], v[152:155], a[12:15], v[80:95]
    s_waitcnt lgkmcnt(5)
    v_add_f32 v48, v48, v176
    v_add_f32 v49, v49, v177
    v_add_f32 v50, v50, v178
    v_add_f32 v51, v51, v179
    v_mfma_f32_32x32x16_bf16 v[96:111], v[156:159], a[12:15], v[96:111]
    buffer_load_dwordx4 a[92:95], v1, s[8:11], s66 offen offset:3072 sc1
    s_waitcnt lgkmcnt(4)
    v_add_f32 v52, v52, v180
    v_add_f32 v53, v53, v181
    s_waitcnt vmcnt(10)
    v_mfma_f32_32x32x16_bf16 v[80:95], v[160:163], a[20:23], v[80:95]
    v_add_f32 v54, v54, v182
    v_add_f32 v55, v55, v183
    s_waitcnt lgkmcnt(3)
    v_add_f32 v48, v48, v184
    v_add_f32 v49, v49, v185
    v_mfma_f32_32x32x16_bf16 v[96:111], v[164:167], a[20:23], v[96:111]
    s_waitcnt vmcnt(5)
    v_cmp_ne_u64 vcc, s[60:61], v[36:37]
    s_cbranch_vccnz L_sp_110
L_sb_111:
    s_add_u32 s66, s93, 0x1c000
    buffer_load_dwordx4 a[100:103], v1, s[8:11], s66 offen offset:2048 sc1
    v_mfma_f32_32x32x16_bf16 v[80:95], v[168:171], a[28:31], v[80:95]
    v_add_f32 v50, v50, v186
    v_add_f32 v51, v51, v187
    v_mfma_f32_32x32x16_bf16 v[96:111], v[172:175], a[28:31], v[96:111]
    buffer_load_dwordx4 a[108:111], v1, s[8:11], s66 offen offset:3072 sc1
    s_waitcnt lgkmcnt(2)
    v_add_f32 v52, v52, v188
    v_add_f32 v53, v53, v189
    v_mfma_f32_32x32x16_bf16 v[80:95], a[0:3], a[36:39], v[80:95]
    v_add_f32 v54, v54, v190
    v_add_f32 v55, v55, v191
    s_waitcnt lgkmcnt(1)
    v_add_f32 v48, v48, v192
    v_add_f32 v49, v49, v193
    v_mfma_f32_32x32x16_bf16 v[96:111], a[8:11], a[36:39], v[96:111]
    s_add_u32 s66, s93, 0x1d000
    buffer_load_dwordx4 a[116:119], v1, s[8:11], s66 offen offset:2048 sc1
    v_add_f32 v50, v50, v194
    v_mfma_f32_32x32x16_bf16 v[80:95], a[16:19], a[44:47], v[80:95]
    v_add_f32 v51, v51, v195
    s_waitcnt lgkmcnt(0)
    v_add_f32 v52, v52, v196
    v_add_f32 v53, v53, v197
    v_add_f32 v54, v54, v198
    v_mfma_f32_32x32x16_bf16 v[96:111], a[24:27], a[44:47], v[96:111]
    buffer_load_dwordx4 a[124:127], v1, s[8:11], s66 offen offset:3072 sc1
    v_add_f32 v55, v55, v199
    v_cvt_pk_bf16_f32 v248, v48, v49
    v_mfma_f32_32x32x16_bf16 v[80:95], a[32:35], a[52:55], v[80:95]
    v_cvt_pk_bf16_f32 v249, v50, v51
    v_cvt_pk_bf16_f32 v250, v52, v53
    v_cvt_pk_bf16_f32 v251, v54, v55
    buffer_store_dwordx4 v[248:251], v41, s[20:23], s94 offen
    v_mfma_f32_32x32x16_bf16 v[96:111], a[40:43], a[52:55], v[96:111]
    s_add_u32 s66, s93, 0x1e000
    buffer_load_dwordx4 a[192:195], v1, s[8:11], s66 offen offset:2048 sc1
    s_waitcnt vmcnt(10)
    v_mfma_f32_32x32x16_bf16 v[80:95], a[48:51], a[60:63], v[80:95]
    v_mfma_f32_32x32x16_bf16 v[96:111], a[56:59], a[60:63], v[96:111]
    buffer_load_dwordx4 a[200:203], v1, s[8:11], s66 offen offset:3072 sc1
    s_waitcnt vmcnt(10)
    v_mfma_f32_32x32x16_bf16 v[80:95], a[64:67], a[68:71], v[80:95]
    v_mfma_f32_32x32x16_bf16 v[96:111], a[72:75], a[68:71], v[96:111]
    s_add_u32 s66, s93, 0x20000
    buffer_load_dwordx4 a[208:211], v1, s[8:11], s66 offen sc1
    s_waitcnt vmcnt(10)
    v_mfma_f32_32x32x16_bf16 v[80:95], a[80:83], a[76:79], v[80:95]
    v_mfma_f32_32x32x16_bf16 v[96:111], a[88:91], a[76:79], v[96:111]
    buffer_load_dwordx4 a[216:219], v1, s[8:11], s66 offen offset:1024 sc1
    s_waitcnt vmcnt(10)
    v_mfma_f32_32x32x16_bf16 v[80:95], a[96:99], a[84:87], v[80:95]
    v_mfma_f32_32x32x16_bf16 v[96:111], a[104:107], a[84:87], v[96:111]
    s_add_u32 s66, s93, 0x21000
    buffer_load_dwordx4 a[224:227], v1, s[8:11], s66 offen sc1
    s_waitcnt vmcnt(10)
    v_mfma_f32_32x32x16_bf16 v[80:95], a[112:115], a[92:95], v[80:95]
    v_mfma_f32_32x32x16_bf16 v[96:111], a[120:123], a[92:95], v[96:111]
    buffer_load_dwordx4 a[232:235], v1, s[8:11], s66 offen offset:1024 sc1
    s_waitcnt vmcnt(10)
    v_mfma_f32_32x32x16_bf16 v[80:95], a[128:131], a[100:103], v[80:95]
    v_mfma_f32_32x32x16_bf16 v[96:111], a[136:139], a[100:103], v[96:111]
    s_add_u32 s66, s93, 0x22000
    buffer_load_dwordx4 a[240:243], v1, s[8:11], s66 offen sc1
    s_waitcnt vmcnt(10)
    v_mfma_f32_32x32x16_bf16 v[80:95], a[144:147], a[108:111], v[80:95]
    v_mfma_f32_32x32x16_bf16 v[96:111], a[152:155], a[108:111], v[96:111]
    buffer_load_dwordx4 a[248:251], v1, s[8:11], s66 offen offset:1024 sc1
    s_waitcnt vmcnt(10)
    v_mfma_f32_32x32x16_bf16 v[80:95], a[160:163], a[116:119], v[80:95]
    v_mfma_f32_32x32x16_bf16 v[96:111], a[168:171], a[116:119], v[96:111]
    s_waitcnt vmcnt(9)
    v_mfma_f32_32x32x16_bf16 v[80:95], a[176:179], a[124:127], v[80:95]
    v_mfma_f32_32x32x16_bf16 v[96:111], a[184:187], a[124:127], v[96:111]
    s_waitcnt vmcnt(7)
    v_mfma_f32_32x32x16_bf16 v[80:95], a[132:135], a[192:195], v[80:95]
    v_mfma_f32_32x32x16_bf16 v[96:111], a[140:143], a[192:195], v[96:111]
    s_waitcnt vmcnt(6)
    v_mfma_f32_32x32x16_bf16 v[80:95], a[148:151], a[200:203], v[80:95]
    v_mfma_f32_32x32x16_bf16 v[96:111], a[156:159], a[200:203], v[96:111]
    s_waitcnt vmcnt(5)
    v_mfma_f32_32x32x16_bf16 v[80:95], a[164:167], a[208:211], v[80:95]
    v_mfma_f32_32x32x16_bf16 v[96:111], a[172:175], a[208:211], v[96:111]
    s_waitcnt vmcnt(4)
    v_mfma_f32_32x32x16_bf16 v[80:95], a[180:183], a[216:219], v[80:95]
    v_mfma_f32_32x32x16_bf16 v[96:111], a[188:191], a[216:219], v[96:111]
    s_waitcnt vmcnt(3)
    v_mfma_f32_32x32x16_bf16 v[80:95], a[196:199], a[224:227], v[80:95]
    v_mfma_f32_32x32x16_bf16 v[96:111], a[204:207], a[224:227], v[96:111]
    s_waitcnt vmcnt(2)
    v_mfma_f32_32x32x16_bf16 v[80:95], a[212:215], a[232:235], v[80:95]
    v_mfma_f32_32x32x16_bf16 v[96:111], a[220:223], a[232:235], v[96:111]
    s_waitcnt vmcnt(1)
    v_mfma_f32_32x32x16_bf16 v[80:95], a[228:231], a[240:243], v[80:95]
    v_mfma_f32_32x32x16_bf16 v[96:111], a[236:239], a[240:243], v[96:111]
    s_waitcnt vmcnt(0)
    v_mfma_f32_32x32x16_bf16 v[80:95], a[244:247], a[248:251], v[80:95]
    v_mfma_f32_32x32x16_bf16 v[96:111], a[252:255], a[248:251], v[96:111]
    s_nop 4
    ds_write_b128 v6, v[88:91] offset:32768
    ds_write_b128 v6, v[92:95] offset:33792
    s_nop 4
    ds_write_b128 v6, v[96:99] offset:34816
    ds_write_b128 v6, v[100:103] offset:35840
    ds_write_b128 v6, v[104:107] offset:36864
    ds_write_b128 v6, v[108:111] offset:37888
    s_waitcnt lgkmcnt(0)
    s_barrier
    ds_read_b128 v[176:179], v7 offset:32768
    ds_read_b128 v[180:183], v7 offset:33792
    ds_read_b128 v[184:187], v8 offset:32768
    ds_read_b128 v[188:191], v8 offset:33792
    ds_read_b128 v[192:195], v9 offset:32768
    ds_read_b128 v[196:199], v9 offset:33792
    s_waitcnt lgkmcnt(5)
    v_pk_add_f32 v[80:81], v[80:81], v[176:177]
    v_pk_add_f32 v[82:83], v[82:83], v[178:179]
    s_waitcnt lgkmcnt(4)
    v_pk_add_f32 v[84:85], v[84:85], v[180:181]
    v_pk_add_f32 v[86:87], v[86:87], v[182:183]
    s_waitcnt lgkmcnt(3)
    v_pk_add_f32 v[80:81], v[80:81], v[184:185]
    v_pk_add_f32 v[82:83], v[82:83], v[186:187]
    s_waitcnt lgkmcnt(2)
    v_pk_add_f32 v[84:85], v[84:85], v[188:189]
    v_pk_add_f32 v[86:87], v[86:87], v[190:191]
    s_waitcnt lgkmcnt(1)
    v_pk_add_f32 v[80:81], v[80:81], v[192:193]
    v_pk_add_f32 v[82:83], v[82:83], v[194:195]
    s_waitcnt lgkmcnt(0)
    v_pk_add_f32 v[84:85], v[84:85], v[196:197]
    v_pk_add_f32 v[86:87], v[86:87], v[198:199]
    v_cvt_pk_bf16_f32 v252, v80, v81
    v_cvt_pk_bf16_f32 v253, v82, v83
    v_cvt_pk_bf16_f32 v254, v84, v85
    v_cvt_pk_bf16_f32 v255, v86, v87
    buffer_store_dwordx4 v[252:255], v41, s[20:23], s68 offen
    s_waitcnt vmcnt(0)
L_end:
    s_endpgm
L_kp_11:
    s_mov_b32 s70, 0
L_kp_11a:
    s_add_u32 s65, s80, 0
    buffer_load_dwordx2 v[36:37], v66, s[4:7], s65 offen sc1
    s_add_u32 s70, s70, 1
    s_cmp_gt_u32 s70, 131072
    s_cbranch_scc1 L_end
    s_waitcnt vmcnt(0)
    v_and_b32 v36, -16, v36
    v_cmp_ne_u64 vcc, s[60:61], v[36:37]
    s_cbranch_vccnz L_kp_11a
    s_branch L_kb_12
L_kp_16:
    s_mov_b32 s70, 0
L_kp_16a:
    s_add_u32 s65, s80, 4096
    buffer_load_dwordx2 v[36:37], v66, s[4:7], s65 offen sc1
    s_add_u32 s70, s70, 1
    s_cmp_gt_u32 s70, 131072
    s_cbranch_scc1 L_end
    s_waitcnt vmcnt(0)
    v_and_b32 v36, -16, v36
    v_cmp_ne_u64 vcc, s[60:61], v[36:37]
    s_cbranch_vccnz L_kp_16a
    s_branch L_kb_17
L_swpoll:
    s_mov_b32 s70, 0
L_swp2:
    buffer_load_dwordx2 v[68:69], v66, s[4:7], s101 offen sc1
    s_add_u32 s70, s70, 1
    s_cmp_gt_u32 s70, 131072
    s_cbranch_scc1 L_end
    s_waitcnt vmcnt(0)
    v_cmp_ne_u64 vcc, s[60:61], v[68:69]
    s_cbranch_vccnz L_swp2
    s_branch L_swback
L_sl_19:
    s_nop 7
    s_nop 7
    buffer_store_dwordx4 v[240:243], v1, s[8:11], s64 offen sc1
    s_branch L_bk_20
L_sl_21:
    s_nop 7
    s_nop 7
    buffer_store_dwordx2 v[4:5], v45, s[8:11], s77 offen sc1
    s_branch L_bk_22
L_sp_23:
    s_mov_b32 s70, 0
L_sp_23a:
    buffer_load_dwordx2 v[36:37], v46, s[8:11], s78 offen sc1
    s_add_u32 s70, s70, 1
    s_cmp_gt_u32 s70, 131072
    s_cbranch_scc1 L_end
    s_waitcnt vmcnt(0)
    v_cmp_ne_u64 vcc, s[60:61], v[36:37]
    s_cbranch_vccnz L_sp_23a
    s_branch L_sb_24
L_slow0:
    s_nop 15
    v_and_b32 v62, 0x1f0, v11
    ds_read_b128 v[248:251], v11
    ds_read_b128 v[252:255], v11
    v_mov_b32 v60, 0xff800000
    s_waitcnt lgkmcnt(0)
    s_mov_b32 s70, 0
L_sa0_0:
    s_and_b32 s64, s70, 32
    s_add_u32 s64, s64, s70
    s_lshl_b32 s64, s64, 10
    buffer_load_dwordx4 v[56:59], v1, s[12:15], s64 offen sc1
    s_waitcnt vmcnt(0)
    s_nop 3
    v_mfma_f32_32x32x16_bf16 v[64:79], v[56:59], v[240:243], 0
    s_nop 11
    v_max3_f32 v60, v64, v65, v60
    v_max3_f32 v60, v66, v67, v60
    v_max3_f32 v60, v68, v69, v60
    v_max3_f32 v60, v70, v71, v60
    v_max3_f32 v60, v72, v73, v60
    v_max3_f32 v60, v74, v75, v60
    v_max3_f32 v60, v76, v77, v60
    v_max3_f32 v60, v78, v79, v60
    s_add_u32 s70, s70, 1
    s_cmp_lt_u32 s70, 64
    s_cbranch_scc1 L_sa0_0
    v_mov_b32 v61, v60
    s_nop 1
    v_permlane32_swap_b32 v60, v61
    v_max_f32 v60, v60, v61
    v_mov_b32 v208, 0
    v_mov_b32 v209, 0
    v_mov_b32 v210, 0
    v_mov_b32 v211, 0
    v_mov_b32 v212, 0
    v_mov_b32 v213, 0
    v_mov_b32 v214, 0
    v_mov_b32 v215, 0
    v_mov_b32 v216, 0
    v_mov_b32 v217, 0
    v_mov_b32 v218, 0
    v_mov_b32 v219, 0
    v_mov_b32 v220, 0
    v_mov_b32 v221, 0
    v_mov_b32 v222, 0
    v_mov_b32 v223, 0
    s_mov_b32 s70, 0
L_sa1_0:
    s_and_b32 s64, s70, 32
    s_add_u32 s64, s64, s70
    s_lshl_b32 s64, s64, 10
    buffer_load_dwordx4 v[56:59], v1, s[12:15], s64 offen sc1
    s_add_u32 s64, s64, 0x8000
    s_mov_b32 exec_lo, 0xffff
    s_mov_b32 exec_hi, 0xffff
    buffer_load_dwordx4 v[248:251], v62, s[12:15], s64 offen sc1
    buffer_load_dwordx4 v[252:255], v62, s[12:15], s64 offen offset:512 sc1
    s_mov_b64 exec, -1
    s_waitcnt vmcnt(0)
    s_nop 3
    v_mfma_f32_32x32x16_bf16 v[64:79], v[56:59], v[240:243], 0
    s_nop 11
    v_sub_f32 v64, v64, v60
    v_sub_f32 v65, v65, v60
    v_sub_f32 v66, v66, v60
    v_sub_f32 v67, v67, v60
    v_sub_f32 v68, v68, v60
    v_sub_f32 v69, v69, v60
    v_sub_f32 v70, v70, v60
    v_sub_f32 v71, v71, v60
    v_sub_f32 v72, v72, v60
    v_sub_f32 v73, v73, v60
    v_sub_f32 v74, v74, v60
    v_sub_f32 v75, v75, v60
    v_sub_f32 v76, v76, v60
    v_sub_f32 v77, v77, v60
    v_sub_f32 v78, v78, v60
    v_sub_f32 v79, v79, v60
    v_exp_f32 v64, v64
    v_exp_f32 v65, v65
    v_exp_f32 v66, v66
    v_exp_f32 v67, v67
    v_exp_f32 v68, v68
    v_exp_f32 v69, v69
    v_exp_f32 v70, v70
    v_exp_f32 v71, v71
    v_exp_f32 v72, v72
    v_exp_f32 v73, v73
    v_exp_f32 v74, v74
    v_exp_f32 v75, v75
    v_exp_f32 v76, v76
    v_exp_f32 v77, v77
    v_exp_f32 v78, v78
    v_exp_f32 v79, v79
    v_smfmac_f32_32x32x32_bf16 v[208:223], v[248:251], v[64:71], v10
    s_nop 0
    v_smfmac_f32_32x32x32_bf16 v[208:223], v[252:255], v[72:79], v10
    s_nop 15
    s_add_u32 s70, s70, 1
    s_cmp_lt_u32 s70, 64
    s_cbranch_scc1 L_sa1_0
    v_mov_b32 v56, 0
    v_mov_b32 v57, 0
    v_mov_b32 v58, 0
    v_mov_b32 v59, 0
    v_mov_b32 v60, 0
    v_mov_b32 v61, 0
    v_mov_b32 v62, 0
    v_mov_b32 v63, 0
    s_nop 3
    s_branch L_slowb0
L_slow1:
    s_nop 15
    v_and_b32 v94, 0x1f0, v11
    ds_read_b128 v[96:99], v11
    ds_read_b128 v[100:103], v11
    v_mov_b32 v92, 0xff800000
    s_waitcnt lgkmcnt(0)
    s_mov_b32 s70, 0
L_sa0_1:
    s_and_b32 s64, s70, 32
    s_add_u32 s64, s64, s70
    s_lshl_b32 s64, s64, 10
    buffer_load_dwordx4 v[88:91], v1, s[12:15], s64 offen sc1
    s_waitcnt vmcnt(0)
    s_nop 3
    v_mfma_f32_32x32x16_bf16 v[176:191], v[88:91], v[244:247], 0
    s_nop 11
    v_max3_f32 v92, v176, v177, v92
    v_max3_f32 v92, v178, v179, v92
    v_max3_f32 v92, v180, v181, v92
    v_max3_f32 v92, v182, v183, v92
    v_max3_f32 v92, v184, v185, v92
    v_max3_f32 v92, v186, v187, v92
    v_max3_f32 v92, v188, v189, v92
    v_max3_f32 v92, v190, v191, v92
    s_add_u32 s70, s70, 1
    s_cmp_lt_u32 s70, 64
    s_cbranch_scc1 L_sa0_1
    v_mov_b32 v93, v92
    s_nop 1
    v_permlane32_swap_b32 v92, v93
    v_max_f32 v92, v92, v93
    v_mov_b32 v224, 0
    v_mov_b32 v225, 0
    v_mov_b32 v226, 0
    v_mov_b32 v227, 0
    v_mov_b32 v228, 0
    v_mov_b32 v229, 0
    v_mov_b32 v230, 0
    v_mov_b32 v231, 0
    v_mov_b32 v232, 0
    v_mov_b32 v233, 0
    v_mov_b32 v234, 0
    v_mov_b32 v235, 0
    v_mov_b32 v236, 0
    v_mov_b32 v237, 0
    v_mov_b32 v238, 0
    v_mov_b32 v239, 0
    s_mov_b32 s70, 0
L_sa1_1:
    s_and_b32 s64, s70, 32
    s_add_u32 s64, s64, s70
    s_lshl_b32 s64, s64, 10
    buffer_load_dwordx4 v[88:91], v1, s[12:15], s64 offen sc1
    s_add_u32 s64, s64, 0x8000
    s_mov_b32 exec_lo, 0xffff
    s_mov_b32 exec_hi, 0xffff
    buffer_load_dwordx4 v[96:99], v94, s[12:15], s64 offen sc1
    buffer_load_dwordx4 v[100:103], v94, s[12:15], s64 offen offset:512 sc1
    s_mov_b64 exec, -1
    s_waitcnt vmcnt(0)
    s_nop 3
    v_mfma_f32_32x32x16_bf16 v[176:191], v[88:91], v[244:247], 0
    s_nop 11
    v_sub_f32 v176, v176, v92
    v_sub_f32 v177, v177, v92
    v_sub_f32 v178, v178, v92
    v_sub_f32 v179, v179, v92
    v_sub_f32 v180, v180, v92
    v_sub_f32 v181, v181, v92
    v_sub_f32 v182, v182, v92
    v_sub_f32 v183, v183, v92
    v_sub_f32 v184, v184, v92
    v_sub_f32 v185, v185, v92
    v_sub_f32 v186, v186, v92
    v_sub_f32 v187, v187, v92
    v_sub_f32 v188, v188, v92
    v_sub_f32 v189, v189, v92
    v_sub_f32 v190, v190, v92
    v_sub_f32 v191, v191, v92
    v_exp_f32 v176, v176
    v_exp_f32 v177, v177
    v_exp_f32 v178, v178
    v_exp_f32 v179, v179
    v_exp_f32 v180, v180
    v_exp_f32 v181, v181
    v_exp_f32 v182, v182
    v_exp_f32 v183, v183
    v_exp_f32 v184, v184
    v_exp_f32 v185, v185
    v_exp_f32 v186, v186
    v_exp_f32 v187, v187
    v_exp_f32 v188, v188
    v_exp_f32 v189, v189
    v_exp_f32 v190, v190
    v_exp_f32 v191, v191
    v_smfmac_f32_32x32x32_bf16 v[224:239], v[96:99], v[176:183], v10
    s_nop 0
    v_smfmac_f32_32x32x32_bf16 v[224:239], v[100:103], v[184:191], v10
    s_nop 15
    s_add_u32 s70, s70, 1
    s_cmp_lt_u32 s70, 64
    s_cbranch_scc1 L_sa1_1
    s_nop 3
    s_branch L_slowb1
L_sl_25:
    s_nop 7
    s_nop 7
    buffer_store_dwordx4 v[244:247], v1, s[8:11], s64 offen sc1
    s_branch L_bk_26
L_sl_27:
    s_nop 7
    s_nop 7
    buffer_store_dwordx2 v[4:5], v45, s[8:11], s77 offen offset:8 sc1
    s_branch L_bk_28
L_sl_29:
    s_nop 7
    s_nop 7
    buffer_store_dwordx4 v[232:235], v1, s[8:11], s64 offen sc1
    s_branch L_bk_30
L_sl_31:
    s_nop 7
    s_nop 7
    buffer_store_dword v208, v1, s[8:11], s64 offen sc1
    s_branch L_bk_32
L_sp_33:
    s_mov_b32 s70, 0
L_sp_33a:
    buffer_load_dwordx2 v[36:37], v46, s[8:11], s78 offen offset:8 sc1
    s_add_u32 s70, s70, 1
    s_cmp_gt_u32 s70, 131072
    s_cbranch_scc1 L_end
    s_waitcnt vmcnt(0)
    v_cmp_ne_u64 vcc, s[60:61], v[36:37]
    s_cbranch_vccnz L_sp_33a
    s_branch L_sb_34
L_sl_35:
    s_nop 7
    s_nop 7
    buffer_store_dwordx2 v[4:5], v45, s[8:11], s77 offen offset:16 sc1
    s_branch L_bk_36
L_sp_37:
    s_mov_b32 s70, 0
L_sp_37a:
    buffer_load_dwordx2 v[36:37], v46, s[8:11], s78 offen offset:16 sc1
    s_add_u32 s70, s70, 1
    s_cmp_gt_u32 s70, 131072
    s_cbranch_scc1 L_end
    s_waitcnt vmcnt(0)
    v_cmp_ne_u64 vcc, s[60:61], v[36:37]
    s_cbranch_vccnz L_sp_37a
    s_branch L_sb_38
L_sl_39:
    s_nop 7
    s_nop 7
    buffer_store_dwordx4 v[236:239], v1, s[8:11], s64 offen sc1
    s_branch L_bk_40
L_sl_41:
    s_nop 7
    s_nop 7
    buffer_store_dword v208, v1, s[8:11], s64 offen sc1
    s_branch L_bk_42
L_sl_43:
    s_nop 7
    s_nop 7
    buffer_store_dwordx2 v[4:5], v45, s[8:11], s77 offen offset:24 sc1
    s_branch L_bk_44
L_sp_45:
    s_mov_b32 s70, 0
L_sp_45a:
    buffer_load_dwordx2 v[36:37], v46, s[8:11], s78 offen offset:24 sc1
    s_add_u32 s70, s70, 1
    s_cmp_gt_u32 s70, 131072
    s_cbranch_scc1 L_end
    s_waitcnt vmcnt(0)
    v_cmp_ne_u64 vcc, s[60:61], v[36:37]
    s_cbranch_vccnz L_sp_45a
    s_branch L_sb_46
L_sl_47:
    s_nop 7
    s_nop 7
    buffer_store_dwordx4 v[248:251], v1, s[8:11], s91 offen sc1
    s_branch L_bk_48
L_sl_49:
    s_nop 7
    s_nop 7
    buffer_store_dwordx4 v[252:255], v1, s[8:11], s91 offen offset:1024 sc1
    s_branch L_bk_50
L_sl_51:
    s_nop 7
    s_nop 7
    buffer_store_dwordx2 v[4:5], v45, s[8:11], s77 offen offset:32 sc1
    s_branch L_bk_52
L_sl_53:
    s_nop 7
    s_nop 7
    buffer_store_dwordx4 v[248:251], v1, s[8:11], s92 offen sc1
    s_branch L_bk_54
L_sl_55:
    s_nop 7
    s_nop 7
    buffer_store_dwordx4 v[252:255], v1, s[8:11], s92 offen offset:1024 sc1
    s_branch L_bk_56
L_sl_57:
    s_nop 7
    s_nop 7
    buffer_store_dwordx2 v[4:5], v45, s[8:11], s77 offen offset:40 sc1
    s_branch L_bk_58
L_sl_59:
    s_nop 7
    s_nop 7
    buffer_store_dwordx4 v[248:251], v1, s[8:11], s64 offen sc1
    s_branch L_bk_60
L_sp_61:
    s_mov_b32 s70, 0
L_sp_61a:
    buffer_load_dwordx2 v[36:37], v46, s[8:11], s78 offen offset:32 sc1
    s_add_u32 s70, s70, 1
    s_cmp_gt_u32 s70, 131072
    s_cbranch_scc1 L_end
    s_waitcnt vmcnt(0)
    v_cmp_ne_u64 vcc, s[60:61], v[36:37]
    s_cbranch_vccnz L_sp_61a
    s_branch L_sb_62
L_sl_63:
    s_nop 7
    s_nop 7
    buffer_store_dwordx4 v[252:255], v1, s[8:11], s64 offen offset:1024 sc1
    s_branch L_bk_64
L_sl_65:
    s_nop 7
    s_nop 7
    buffer_store_dwordx2 v[4:5], v45, s[8:11], s77 offen offset:48 sc1
    s_branch L_bk_66
L_sp_67:
    s_mov_b32 s70, 0
L_sp_67a:
    buffer_load_dwordx2 v[36:37], v46, s[8:11], s78 offen offset:40 sc1
    s_add_u32 s70, s70, 1
    s_cmp_gt_u32 s70, 131072
    s_cbranch_scc1 L_end
    s_waitcnt vmcnt(0)
    v_cmp_ne_u64 vcc, s[60:61], v[36:37]
    s_cbranch_vccnz L_sp_67a
    s_branch L_sb_68
L_sl_69:
    s_nop 7
    s_nop 7
    buffer_store_dwordx4 v[248:251], v1, s[8:11], s64 offen sc1
    s_branch L_bk_70
L_sl_71:
    s_nop 7
    s_nop 7
    buffer_store_dwordx4 v[252:255], v1, s[8:11], s64 offen offset:1024 sc1
    s_branch L_bk_72
L_sl_73:
    s_nop 7
    s_nop 7
    buffer_store_dwordx2 v[4:5], v45, s[8:11], s77 offen offset:56 sc1
    s_branch L_bk_74
L_sp_75:
    s_mov_b32 s70, 0
L_sp_75a:
    buffer_load_dwordx2 v[36:37], v46, s[8:11], s78 offen offset:48 sc1
    s_add_u32 s70, s70, 1
    s_cmp_gt_u32 s70, 131072
    s_cbranch_scc1 L_end
    s_waitcnt vmcnt(0)
    v_cmp_ne_u64 vcc, s[60:61], v[36:37]
    s_cbranch_vccnz L_sp_75a
    s_branch L_sb_76
L_sp_77:
    s_mov_b32 s70, 0
L_sp_77a:
    buffer_load_dwordx2 v[36:37], v46, s[8:11], s78 offen offset:56 sc1
    s_add_u32 s70, s70, 1
    s_cmp_gt_u32 s70, 131072
    s_cbranch_scc1 L_end
    s_waitcnt vmcnt(0)
    v_cmp_ne_u64 vcc, s[60:61], v[36:37]
    s_cbranch_vccnz L_sp_77a
    s_branch L_sb_78
L_sl_79:
    s_nop 7
    s_nop 7
    buffer_store_dwordx4 v[248:251], v1, s[8:11], s64 offen sc1
    s_branch L_bk_80
L_sl_81:
    s_nop 7
    s_nop 7
    buffer_store_dword v176, v1, s[8:11], s64 offen sc1
    s_branch L_bk_82
L_sl_85:
    s_nop 7
    s_nop 7
    buffer_store_dwordx2 v[4:5], v45, s[8:11], s77 offen offset:64 sc1
    s_branch L_bk_86
L_sp_87:
    s_mov_b32 s70, 0
L_sp_87a:
    buffer_load_dwordx2 v[36:37], v46, s[8:11], s78 offen offset:64 sc1
    s_add_u32 s70, s70, 1
    s_cmp_gt_u32 s70, 131072
    s_cbranch_scc1 L_end
    s_waitcnt vmcnt(0)
    v_cmp_ne_u64 vcc, s[60:61], v[36:37]
    s_cbranch_vccnz L_sp_87a
    s_branch L_sb_88
L_sl_89:
    s_nop 7
    s_nop 7
    buffer_store_dwordx4 v[252:255], v1, s[8:11], s64 offen sc1
    s_branch L_bk_90
L_sl_91:
    s_nop 7
    s_nop 7
    buffer_store_dword v176, v1, s[8:11], s64 offen sc1
    s_branch L_bk_92
L_sl_97:
    s_nop 7
    s_nop 7
    buffer_store_dwordx2 v[4:5], v45, s[8:11], s77 offen offset:72 sc1
    s_branch L_bk_98
L_sp_100:
    s_mov_b32 s70, 0
L_sp_100a:
    buffer_load_dwordx2 v[36:37], v46, s[8:11], s78 offen offset:72 sc1
    s_add_u32 s70, s70, 1
    s_cmp_gt_u32 s70, 131072
    s_cbranch_scc1 L_end
    s_waitcnt vmcnt(0)
    v_cmp_ne_u64 vcc, s[60:61], v[36:37]
    s_cbranch_vccnz L_sp_100a
    s_branch L_sb_101
L_kp_108:
    s_mov_b32 s70, 0
L_kp_108a:
    s_add_u32 s65, s80, 0
    buffer_load_dwordx2 v[36:37], v66, s[4:7], s65 offen sc1
    s_add_u32 s70, s70, 1
    s_cmp_gt_u32 s70, 131072
    s_cbranch_scc1 L_end
    s_waitcnt vmcnt(0)
    v_and_b32 v36, -16, v36
    v_cmp_ne_u64 vcc, s[60:61], v[36:37]
    s_cbranch_vccnz L_kp_108a
    s_branch L_kb_109
L_sp_110:
    s_mov_b32 s70, 0
L_sp_110a:
    buffer_load_dwordx2 v[36:37], v46, s[8:11], s78 offen offset:56 sc1
    s_add_u32 s70, s70, 1
    s_cmp_gt_u32 s70, 131072
    s_cbranch_scc1 L_end
    s_waitcnt vmcnt(0)
    v_cmp_ne_u64 vcc, s[60:61], v[36:37]
    s_cbranch_vccnz L_sp_110a
    s_branch L_sb_111
L_codeend:
    s_endpgm
.section .rodata,"a"
.p2align 6
.amdhsa_kernel interleave_layers__grouped_kv_mqa__dense_activation_gelu__prompt_kernel
  .amdhsa_next_free_vgpr 512
  .amdhsa_next_free_sgpr 102
  .amdhsa_accum_offset 256
  .amdhsa_group_segment_fixed_size 0
  .amdhsa_kernarg_size 104
  .amdhsa_user_sgpr_count 2
  .amdhsa_user_sgpr_kernarg_segment_ptr 1
  .amdhsa_system_sgpr_workgroup_id_x 1
.end_amdhsa_kernel
```
